```python
import torch

def _softmax(x, axis=-1):
    return torch.softmax(x, dim=axis)
def _gelu(x):
    return torch.nn.functional.gelu(x, approximate="tanh")
def _silu(x):
    return torch.nn.functional.silu(x)
def _sigmoid(x):
    return torch.sigmoid(x)
def _layernorm(x, axis=-1, eps=1e-5):
    m = x.mean(dim=axis, keepdim=True)
    v = x.var(dim=axis, keepdim=True, unbiased=False)
    return (x - m) / torch.sqrt(v + eps)
def _scatter_add(tgt, idx, src, axis=0):
    return tgt.clone().index_add_(axis, idx, src)
def _segment_sum(src, seg, n):
    out = torch.zeros((n,) + src.shape[1:], dtype=src.dtype)
    return out.index_add_(0, seg, src)
def _pad(x, pw):
    flat = tuple(v for pair in reversed(pw) for v in pair)
    return torch.nn.functional.pad(x, flat)

kernel_name = 'recurrent_scan__sliding_block_cached__dense_activation_relu__prompt'

def setup_inputs():

    _w = (lambda a: (lambda t: t.to(torch.bfloat16) if t.is_floating_point() else t)(torch.as_tensor(a)))
    def _A_setup():
        B, Sq, D = 1, 2048, 576
        Hq, Hkv, Sk, Dh = 32, 16, 2048, 128
        assert Hq % Hkv == 0, (Hq, Hkv)
        return {
            "x": _w((lambda *s: torch.randn(*s, dtype=torch.bfloat16) * 0.05)(B, Sq, D)),
            "k_cache": _w((lambda *s: torch.randn(*s, dtype=torch.bfloat16) * 0.8)(B, Hkv, Sk, Dh)),
            "v_cache": _w((lambda *s: torch.randn(*s, dtype=torch.bfloat16) * 0.2)(B, Hkv, Sk, Dh)),
            "wq": _w((lambda *s: torch.randn(*s, dtype=torch.bfloat16) * 0.8)(D, Hq * Dh) * (D ** -0.5)),
            "wo": _w((lambda *s: torch.randn(*s, dtype=torch.bfloat16) * 0.2)(Hq * Dh, D) * ((Hq * Dh) ** -0.5)),
        }
    _A_in = _A_setup()

    def _B_setup():
        B, S, D, Dff = 1, 2048, 576, 4608
        return {
            "x": _w((lambda *s: torch.randn(*s, dtype=torch.bfloat16) * 0.05)(B, S, D)),
            "w1": _w((lambda *s: torch.randn(*s, dtype=torch.bfloat16) * 0.1)(D, Dff)),
            "w2": _w((lambda *s: torch.randn(*s, dtype=torch.bfloat16) * 0.1)(Dff, D)),
        }
    _B_in = _B_setup()

    return {
        "A_x": _A_in["x"],
        "A_k_cache": _A_in["k_cache"],
        "A_v_cache": _A_in["v_cache"],
        "A_wq": _A_in["wq"],
        "A_wo": _A_in["wo"],
        "B_x": _B_in["x"],
        "B_w1": _B_in["w1"],
        "B_w2": _B_in["w2"],
    }

def reference(A_x, A_k_cache, A_v_cache, A_wq, A_wo, B_x, B_w1, B_w2):
    def _A_ref(x, k_cache, v_cache, wq, wo):
        B, Sq, D = x.shape
        Hq, Dh = 32, 128
        Hkv, Sk = k_cache.shape[1], k_cache.shape[2]
        W = min(4096, max(256, Sk // 4))
        rep = Hq // Hkv
        q = (lambda x, *d: x.permute(*d))((x @ wq).reshape(B, Sq, Hq, Dh), 0, 2, 1, 3)
        k = (lambda x, n, axis: torch.repeat_interleave(x, n, dim=axis))(k_cache[:, :, Sk - W:, :], rep, axis=1)
        v = (lambda x, n, axis: torch.repeat_interleave(x, n, dim=axis))(v_cache[:, :, Sk - W:, :], rep, axis=1)
        scores = torch.einsum("bhqd,bhkd->bhqk", q, k) * (Dh ** -0.5)
        p = _softmax(scores, axis=-1)
        o = torch.einsum("bhqk,bhkd->bhqd", p, v)
        return (lambda x, *d: x.permute(*d))(o, 0, 2, 1, 3).reshape(B, Sq, Hq * Dh) @ wo

    def _B_ref(x, w1, w2):
        h = torch.einsum("bsd,df->bsf", x, w1)
        zero = torch.zeros_like(h)
        h = torch.maximum(h, zero)
        return torch.einsum("bsf,fd->bsd", h, w2)

    x = A_x
    xn = _layernorm(x, axis=-1)
    s = _A_ref(xn, A_k_cache, A_v_cache, A_wq, A_wo)
    g = _silu(_B_ref(xn, B_w1, B_w2))
    return x + s * g
```

```asm
; @launch grid=(256,1,1) block=(256,1,1) lds=163840
.amdgcn_target "amdgcn-amd-amdhsa--gfx950"
.text
.globl recurrent_scan__sliding_block_cached__dense_activation_relu__prompt_kernel
.p2align 8
.type recurrent_scan__sliding_block_cached__dense_activation_relu__prompt_kernel,@function
recurrent_scan__sliding_block_cached__dense_activation_relu__prompt_kernel:
    s_cmp_ge_u32 s2, 256
    s_cbranch_scc1 KF_end
    s_load_dwordx16 s[40:55], s[0:1], 0
    s_load_dwordx4 s[56:59], s[0:1], 64
    s_load_dwordx2 s[60:61], s[0:1], 80
    s_memrealtime s[38:39]
    s_getpc_b64 s[96:97]
    s_mov_b32 s98, 8192
    s_mov_b32 s99, 0x20000
    v_lshlrev_b32 v27, 7, v0
    buffer_load_dword v31, v27, s[96:99], 0 offen
    v_lshrrev_b32 v20, 6, v0
    v_and_b32 v21, 63, v0
    v_readfirstlane_b32 s3, v20
    s_and_b32 s64, s2, 7
    s_bfe_u32 s65, s2, 0x20003
    s_and_b32 s62, s2, 3
    s_lshl_b32 s62, s62, 3
    s_and_b32 s63, s2, 4
    s_add_u32 s62, s62, s63
    s_add_u32 s62, s62, s65
    s_lshr_b32 s63, s2, 5
    s_lshl_b32 s66, s63, 5
    s_add_u32 s66, s66, s62
    v_lshrrev_b32 v22, 5, v0
    v_mul_u32_u24 v22, 1152, v22
    v_and_b32 v23, 31, v21
    v_lshl_add_u32 v22, v23, 4, v22
    s_mul_i32 s67, s66, 9216
    v_mov_b32 v56, 0
    v_mov_b32 v57, 0
    v_mov_b32 v58, 0
    v_mov_b32 v59, 0
    v_mov_b32 v6, 0
    v_lshlrev_b32 v1, 4, v21
    s_waitcnt lgkmcnt(0)
    s_mov_b32 s32, s40
    s_mov_b32 s33, s41
    s_mov_b32 s34, 2359296
    s_mov_b32 s35, 0x20000
    buffer_load_dwordx4 v[48:51], v22, s[32:35], s67 offen
    buffer_load_dwordx4 v[52:55], v22, s[32:35], s67 offen offset:512
    s_mov_b32 exec_lo, 0xff
    s_mov_b32 exec_hi, 0xff
    buffer_load_dwordx4 v[56:59], v22, s[32:35], s67 offen offset:1024
    s_mov_b64 exec, -1
    s_mov_b32 s8, s46
    s_mov_b32 s9, s47
    s_mov_b32 s10, 4718592
    s_mov_b32 s11, 0x20000
    s_mov_b32 s20, s58
    s_mov_b32 s21, s59
    s_mov_b32 s22, 256
    s_mov_b32 s23, 0x20000
    s_or_b32 s77, s2, s3
    s_cbranch_scc1 KF_w0
    s_or_b32 s38, s38, 1
    v_mov_b32 v28, s38
    s_mov_b64 exec, 1
    buffer_store_dword v28, v6, s[20:23], 0 offen sc1
    s_mov_b64 exec, -1
KF_w0:
    s_mov_b32 s16, s60
    s_mov_b32 s17, s61
    s_mov_b32 s18, 268435456
    s_mov_b32 s19, 0x20000
    s_lshl_b32 s92, s66, 2
    s_add_u32 s92, s92, s3
    s_lshl_b32 s92, s92, 7
    s_add_u32 s92, s92, 3538944
    v_mov_b32 v27, s92
    s_lshl_b32 s72, s63, 3
    s_add_u32 s72, s72, s64
    s_lshl_b32 s72, s72, 2
    s_add_u32 s72, s72, s65
    s_lshl_b32 s72, s72, 2
    s_add_u32 s72, s72, s3
    s_lshl_b32 s72, s72, 7
    s_add_u32 s72, s72, 3276800
    v_writelane_b32 v27, s72, 1
    s_add_u32 s72, s72, 131072
    v_writelane_b32 v27, s72, 2
    s_lshr_b32 s72, s62, 1
    s_lshl_b32 s72, s72, 7
    s_add_u32 s72, s72, 3211264
    v_writelane_b32 v27, s72, 3
    s_mov_b64 exec, 15
    buffer_load_dword v31, v27, s[16:19], 0 offen sc1
    s_mov_b64 exec, -1
    s_mov_b32 s12, s52
    s_mov_b32 s13, s53
    s_mov_b32 s14, 5308416
    s_mov_b32 s15, 0x20000
    s_mov_b32 s24, s42
    s_mov_b32 s25, s43
    s_mov_b32 s26, 8388608
    s_mov_b32 s27, 0x20000
    s_mov_b32 s28, s44
    s_mov_b32 s29, s45
    s_mov_b32 s30, 8388608
    s_mov_b32 s31, 0x20000
    v_lshrrev_b32 v28, 1, v21
    v_and_b32 v29, 1, v21
    v_lshlrev_b32 v29, 7, v29
    v_lshl_add_u32 v34, v28, 13, v29
    v_mul_u32_u24 v239, 9216, v21
    s_sub_u32 s77, s3, 1
    s_lshl_b32 s77, s77, 3
    s_add_u32 s77, s77, s63
    s_mul_i32 s4, s77, 196608
    s_lshl_b32 s5, s63, 2
    s_add_u32 s5, s5, s3
    s_mul_i32 s5, s5, 165888
    s_lshr_b32 s70, s62, 1
    s_and_b32 s71, s62, 1
    s_lshl_b32 s6, s70, 6
    s_add_u32 s6, s6, s5
    s_add_u32 s6, s6, 8192
    s_lshl_b32 s79, s62, 8
    s_add_u32 s4, s4, s79
    s_add_u32 s5, s5, s79
    v_and_b32 v24, 15, v21
    v_lshrrev_b32 v25, 4, v21
    v_lshlrev_b32 v254, 8, v24
    v_lshl_add_u32 v255, v25, 4, v254
    v_lshl_add_u32 v254, v25, 3, v254
    v_lshrrev_b32 v28, 5, v21
    v_lshlrev_b32 v29, 1, v28
    v_and_b32 v30, 3, v21
    v_xor_b32 v29, v29, v30
    v_lshlrev_b32 v29, 4, v29
    v_lshrrev_b32 v32, 2, v21
    v_mul_u32_u24 v3, 9216, v32
    v_add_u32 v3, v3, v29
    v_bfe_u32 v32, v21, 2, 2
    v_lshlrev_b32 v32, 6, v32
    v_lshl_add_u32 v32, v30, 3, v32
    v_and_b32 v26, 1, v25
    v_lshl_add_u32 v32, v26, 5, v32
    v_lshl_add_u32 v4, v25, 9, v32
    v_bfe_u32 v33, v21, 2, 2
    v_lshlrev_b32 v5, 10, v25
    v_lshl_add_u32 v5, v33, 7, v5
    v_lshl_add_u32 v5, v30, 3, v5
    v_lshrrev_b32 v33, 1, v33
    v_lshl_add_u32 v5, v33, 5, v5
    v_lshl_add_u32 v5, v26, 6, v5
    v_lshrrev_b32 v33, 3, v21
    v_mul_u32_u24 v238, 9216, v33
    v_and_b32 v33, 7, v21
    v_lshlrev_b32 v35, 1, v26
    v_xor_b32 v33, v33, v35
    v_lshrrev_b32 v2, 3, v21
    v_lshlrev_b32 v2, 13, v2
    v_lshl_add_u32 v2, v33, 4, v2
    v_xor_b32 v46, 64, v2
    v_add_u32 v46, 0x10000, v46
    v_and_b32 v35, 1, v20
    v_lshlrev_b32 v35, 2, v35
    v_xor_b32 v33, v33, v35
    v_lshl_add_u32 v238, v33, 4, v238
    v_lshl_add_u32 v248, v25, 10, v5
    v_xor_b32 v249, 32, v248
    v_xor_b32 v250, 64, v248
    v_xor_b32 v251, 96, v248
    v_add_u32 v252, 0x10000, v248
    v_add_u32 v253, 0x10000, v249
    v_add_u32 v236, 0x10000, v250
    v_add_u32 v237, 0x10000, v251
    s_lshl_b32 s69, s63, 4
    s_lshl_b32 s78, s3, 2
    s_add_u32 s69, s69, s78
    s_lshl_b32 s78, s71, 1
    s_xor_b32 s79, s78, 0
    s_add_u32 s79, s79, s69
    s_mul_i32 s80, s79, 18432
    v_add_u32 v232, s80, v1
    s_mul_i32 s80, s79, 278528
    v_add_u32 v10, s80, v1
    s_xor_b32 s79, s78, 1
    s_add_u32 s79, s79, s69
    s_mul_i32 s80, s79, 18432
    v_add_u32 v233, s80, v1
    s_mul_i32 s80, s79, 278528
    v_add_u32 v11, s80, v1
    s_xor_b32 s79, s78, 2
    s_add_u32 s79, s79, s69
    s_mul_i32 s80, s79, 18432
    v_add_u32 v234, s80, v1
    s_mul_i32 s80, s79, 278528
    v_add_u32 v12, s80, v1
    s_xor_b32 s79, s78, 3
    s_add_u32 s79, s79, s69
    s_mul_i32 s80, s79, 18432
    v_add_u32 v235, s80, v1
    s_mul_i32 s80, s79, 278528
    v_add_u32 v13, s80, v1
    v_lshrrev_b32 v36, 5, v0
    v_and_b32 v37, 7, v21
    v_xor_b32 v36, v36, v37
    v_lshlrev_b32 v36, 4, v36
    v_lshl_add_u32 v36, v23, 7, v36
    v_add_u32 v36, 147456, v36
    v_lshrrev_b32 v38, 3, v21
    v_xor_b32 v39, v38, v37
    v_lshlrev_b32 v39, 4, v39
    v_lshl_add_u32 v39, v38, 7, v39
    v_add_u32 v39, 147456, v39
    v_lshlrev_b32 v38, 8, v38
    v_lshl_add_u32 v38, v37, 4, v38
    s_lshl_b32 s72, s63, 1
    s_add_u32 s72, s72, s71
    s_lshl_b32 s73, s70, 19
    s_lshl_b32 s74, s72, 13
    s_add_u32 s73, s73, s74
    s_add_u32 s73, s73, 393216
    s_lshl_b32 s74, s3, 6
    s_add_u32 s87, s73, s74
    s_add_u32 s88, s87, 4096
    s_lshr_b32 s74, s3, 1
    s_lshl_b32 s74, s74, 12
    s_add_u32 s73, s73, s74
    s_and_b32 s74, s3, 1
    s_lshl_b32 s74, s74, 7
    s_add_u32 s89, s73, s74
    s_lshl_b32 s82, s70, 18
    s_add_u32 s82, s82, 4194304
    s_lshl_b32 s93, s72, 14
    s_add_u32 s93, s93, s82
    s_lshl_b32 s78, s3, 11
    s_add_u32 s93, s93, s78
    s_add_u32 s95, s93, 8192
    s_lshl_b32 s90, s70, 7
    s_add_u32 s90, s90, 3211264
    s_lshl_b32 s91, s72, 2
    s_add_u32 s91, s91, s90
    s_mul_i32 s77, s3, 73728
    s_lshl_b32 s79, s62, 8
    s_add_u32 s79, s79, s77
    s_mul_i32 s77, s3, 1327104
    s_lshl_b32 s80, s70, 6
    s_add_u32 s80, s80, s77
    s_add_u32 s80, s80, 8192
    s_mul_i32 s81, s3, 9216
    s_lshl_b32 s83, s62, 12
    s_add_u32 s83, s83, 16777216
    s_add_u32 s84, s83, 131072
    s_lshl_b32 s85, s70, 10
    s_add_u32 s85, s85, 17039360
    s_mov_b32 s86, 0x3e0293ee
    s_lshl_b32 s37, s62, 8
    s_lshl_b32 s67, s3, 6
    s_add_u32 s37, s37, s67
    s_lshl_b32 s67, s3, 10
    s_mov_b32 s74, 0
    s_mov_b32 s75, 4096
    s_mov_b32 s76, 8192
    s_mov_b32 s77, 12288
    s_mov_b32 s78, 16384
    s_lshr_b32 s7, s66, 1
    s_mul_i32 s7, s7, 18432
    s_lshl_b32 s72, s71, 7
    s_add_u32 s7, s7, s72
    s_lshl_b32 s36, s63, 14
    s_lshr_b32 s72, s62, 3
    s_lshl_b32 s72, s72, 7
    s_add_u32 s36, s36, s72
    s_and_b32 s72, s62, 7
    s_lshl_b32 s72, s72, 2
    s_add_u32 s36, s36, s72
    s_add_u32 s36, s36, 3538944
    s_waitcnt vmcnt(3)
    v_lshlrev_b32 v64, 16, v48
    v_and_b32 v65, 0xffff0000, v48
    v_lshlrev_b32 v66, 16, v49
    v_and_b32 v67, 0xffff0000, v49
    v_lshlrev_b32 v68, 16, v50
    v_and_b32 v69, 0xffff0000, v50
    v_lshlrev_b32 v70, 16, v51
    v_and_b32 v71, 0xffff0000, v51
    s_waitcnt vmcnt(2)
    v_lshlrev_b32 v72, 16, v52
    v_and_b32 v73, 0xffff0000, v52
    v_lshlrev_b32 v74, 16, v53
    v_and_b32 v75, 0xffff0000, v53
    v_lshlrev_b32 v76, 16, v54
    v_and_b32 v77, 0xffff0000, v54
    v_lshlrev_b32 v78, 16, v55
    v_and_b32 v79, 0xffff0000, v55
    s_waitcnt vmcnt(1)
    v_lshlrev_b32 v80, 16, v56
    v_and_b32 v81, 0xffff0000, v56
    v_lshlrev_b32 v82, 16, v57
    v_and_b32 v83, 0xffff0000, v57
    v_lshlrev_b32 v84, 16, v58
    v_and_b32 v85, 0xffff0000, v58
    v_lshlrev_b32 v86, 16, v59
    v_and_b32 v87, 0xffff0000, v59
    buffer_load_dword v7, v6, s[20:23], 0 offen sc1
    s_sub_u32 s72, s3, 1
    s_cmp_ge_u32 s72, 3
    s_cbranch_scc1 KF_nw1
    s_mov_b32 exec_hi, 0xffff
    buffer_load_dword v31, v34, s[8:11], s4 offen
    s_mov_b64 exec, -1
KF_nw1:
    s_getpc_b64 s[100:101]
KF_pc:
    s_sub_u32 s96, s100, KF_pc-recurrent_scan__sliding_block_cached__dense_activation_relu__prompt_kernel
    s_subb_u32 s97, s101, 0
    s_mov_b32 s98, KF_codeend-recurrent_scan__sliding_block_cached__dense_activation_relu__prompt_kernel
    s_mov_b32 s99, 0x20000
    s_lshr_b32 s94, s2, 3
    s_lshl_b32 s94, s94, 2
    s_add_u32 s94, s94, s3
    s_mul_i32 s94, s94, 640
    v_lshlrev_b32 v27, 7, v21
    s_mov_b64 exec, 31
    buffer_load_dword v31, v27, s[96:99], s94 offen
    s_mov_b64 exec, -1
    v_pk_add_f32 v[40:41], v[64:65], v[66:67]
    v_pk_add_f32 v[42:43], v[68:69], v[70:71]
    v_pk_add_f32 v[40:41], v[40:41], v[72:73]
    v_pk_add_f32 v[42:43], v[42:43], v[74:75]
    v_pk_add_f32 v[40:41], v[40:41], v[76:77]
    v_pk_add_f32 v[42:43], v[42:43], v[78:79]
    v_pk_add_f32 v[40:41], v[40:41], v[80:81]
    v_pk_add_f32 v[42:43], v[42:43], v[82:83]
    v_pk_add_f32 v[40:41], v[40:41], v[84:85]
    v_pk_add_f32 v[42:43], v[42:43], v[86:87]
    v_pk_add_f32 v[40:41], v[40:41], v[42:43]
    v_add_f32 v40, v40, v41
    s_nop 1
    v_add_f32_dpp v40, v40, v40 row_ror:8 row_mask:0xf bank_mask:0xf
    s_nop 1
    v_add_f32_dpp v40, v40, v40 row_ror:4 row_mask:0xf bank_mask:0xf
    s_nop 1
    v_add_f32_dpp v40, v40, v40 row_ror:2 row_mask:0xf bank_mask:0xf
    s_nop 1
    v_add_f32_dpp v40, v40, v40 row_ror:1 row_mask:0xf bank_mask:0xf
    v_mov_b32 v41, v40
    s_nop 1
    v_permlane16_swap_b32 v41, v40
    v_add_f32 v40, v40, v41
    v_mul_f32 v40, 0xbae38e39, v40
    v_mov_b32 v41, v40
    v_cvt_pk_bf16_f32 v44, v40, v40
    v_lshlrev_b32 v44, 16, v44
    v_mov_b32 v45, v44
    v_pk_add_f32 v[92:93], v[64:65], v[40:41]
    v_pk_mul_f32 v[88:89], v[92:93], v[92:93]
    v_pk_add_f32 v[94:95], v[66:67], v[40:41]
    v_pk_mul_f32 v[90:91], v[94:95], v[94:95]
    v_pk_add_f32 v[92:93], v[68:69], v[40:41]
    v_pk_fma_f32 v[88:89], v[92:93], v[92:93], v[88:89]
    v_pk_add_f32 v[94:95], v[70:71], v[40:41]
    v_pk_fma_f32 v[90:91], v[94:95], v[94:95], v[90:91]
    v_pk_add_f32 v[92:93], v[72:73], v[40:41]
    v_pk_fma_f32 v[88:89], v[92:93], v[92:93], v[88:89]
    v_pk_add_f32 v[94:95], v[74:75], v[40:41]
    v_pk_fma_f32 v[90:91], v[94:95], v[94:95], v[90:91]
    v_pk_add_f32 v[92:93], v[76:77], v[40:41]
    v_pk_fma_f32 v[88:89], v[92:93], v[92:93], v[88:89]
    v_pk_add_f32 v[94:95], v[78:79], v[40:41]
    v_pk_fma_f32 v[90:91], v[94:95], v[94:95], v[90:91]
    s_mov_b32 exec_lo, 0xff
    s_mov_b32 exec_hi, 0xff
    v_pk_add_f32 v[92:93], v[80:81], v[40:41]
    v_pk_fma_f32 v[88:89], v[92:93], v[92:93], v[88:89]
    v_pk_add_f32 v[94:95], v[82:83], v[40:41]
    v_pk_fma_f32 v[90:91], v[94:95], v[94:95], v[90:91]
    v_pk_add_f32 v[92:93], v[84:85], v[40:41]
    v_pk_fma_f32 v[88:89], v[92:93], v[92:93], v[88:89]
    v_pk_add_f32 v[94:95], v[86:87], v[40:41]
    v_pk_fma_f32 v[90:91], v[94:95], v[94:95], v[90:91]
    s_mov_b64 exec, -1
    v_pk_add_f32 v[64:65], v[64:65], v[44:45]
    v_cvt_pk_bf16_f32 v48, v64, v65
    v_pk_add_f32 v[66:67], v[66:67], v[44:45]
    v_cvt_pk_bf16_f32 v49, v66, v67
    v_pk_add_f32 v[68:69], v[68:69], v[44:45]
    v_cvt_pk_bf16_f32 v50, v68, v69
    v_pk_add_f32 v[70:71], v[70:71], v[44:45]
    v_cvt_pk_bf16_f32 v51, v70, v71
    v_pk_add_f32 v[72:73], v[72:73], v[44:45]
    v_cvt_pk_bf16_f32 v52, v72, v73
    v_pk_add_f32 v[74:75], v[74:75], v[44:45]
    v_cvt_pk_bf16_f32 v53, v74, v75
    v_pk_add_f32 v[76:77], v[76:77], v[44:45]
    v_cvt_pk_bf16_f32 v54, v76, v77
    v_pk_add_f32 v[78:79], v[78:79], v[44:45]
    v_cvt_pk_bf16_f32 v55, v78, v79
    v_pk_add_f32 v[80:81], v[80:81], v[44:45]
    v_cvt_pk_bf16_f32 v56, v80, v81
    v_pk_add_f32 v[82:83], v[82:83], v[44:45]
    v_cvt_pk_bf16_f32 v57, v82, v83
    v_pk_add_f32 v[84:85], v[84:85], v[44:45]
    v_cvt_pk_bf16_f32 v58, v84, v85
    v_pk_add_f32 v[86:87], v[86:87], v[44:45]
    v_cvt_pk_bf16_f32 v59, v86, v87
    v_pk_add_f32 v[88:89], v[88:89], v[90:91]
    v_add_f32 v88, v88, v89
    s_nop 1
    v_add_f32_dpp v88, v88, v88 row_ror:8 row_mask:0xf bank_mask:0xf
    s_nop 1
    v_add_f32_dpp v88, v88, v88 row_ror:4 row_mask:0xf bank_mask:0xf
    s_nop 1
    v_add_f32_dpp v88, v88, v88 row_ror:2 row_mask:0xf bank_mask:0xf
    s_nop 1
    v_add_f32_dpp v88, v88, v88 row_ror:1 row_mask:0xf bank_mask:0xf
    v_mov_b32 v89, v88
    s_nop 1
    v_permlane16_swap_b32 v89, v88
    v_add_f32 v88, v88, v89
    v_mul_f32 v88, 0x3ae38e39, v88
    v_cvt_pk_bf16_f32 v88, v88, v88
    v_lshlrev_b32 v88, 16, v88
    v_add_f32 v88, 0x3727c5ac, v88
    v_cvt_pk_bf16_f32 v88, v88, v88
    v_lshlrev_b32 v88, 16, v88
    v_sqrt_f32 v88, v88
    v_lshlrev_b32 v64, 16, v48
    v_and_b32 v65, 0xffff0000, v48
    v_cvt_pk_bf16_f32 v88, v88, v88
    v_lshlrev_b32 v88, 16, v88
    v_lshlrev_b32 v66, 16, v49
    v_and_b32 v67, 0xffff0000, v49
    v_rcp_f32 v90, v88
    v_lshlrev_b32 v68, 16, v50
    v_and_b32 v69, 0xffff0000, v50
    v_fma_f32 v91, -v88, v90, 2.0
    v_lshlrev_b32 v70, 16, v51
    v_and_b32 v71, 0xffff0000, v51
    v_mul_f32 v90, v90, v91
    v_mov_b32 v91, v90
    v_lshlrev_b32 v72, 16, v52
    v_and_b32 v73, 0xffff0000, v52
    v_lshlrev_b32 v74, 16, v53
    v_and_b32 v75, 0xffff0000, v53
    v_lshlrev_b32 v76, 16, v54
    v_and_b32 v77, 0xffff0000, v54
    v_lshlrev_b32 v78, 16, v55
    v_and_b32 v79, 0xffff0000, v55
    v_lshlrev_b32 v80, 16, v56
    v_and_b32 v81, 0xffff0000, v56
    v_lshlrev_b32 v82, 16, v57
    v_and_b32 v83, 0xffff0000, v57
    v_lshlrev_b32 v84, 16, v58
    v_and_b32 v85, 0xffff0000, v58
    v_lshlrev_b32 v86, 16, v59
    v_and_b32 v87, 0xffff0000, v59
    v_pk_mul_f32 v[64:65], v[64:65], v[90:91]
    v_cvt_pk_bf16_f32 v48, v64, v65
    v_pk_mul_f32 v[66:67], v[66:67], v[90:91]
    v_cvt_pk_bf16_f32 v49, v66, v67
    v_pk_mul_f32 v[68:69], v[68:69], v[90:91]
    v_cvt_pk_bf16_f32 v50, v68, v69
    v_pk_mul_f32 v[70:71], v[70:71], v[90:91]
    v_cvt_pk_bf16_f32 v51, v70, v71
    ds_write_b128 v36, v[48:51] offset:0
    v_pk_mul_f32 v[72:73], v[72:73], v[90:91]
    v_cvt_pk_bf16_f32 v52, v72, v73
    v_pk_mul_f32 v[74:75], v[74:75], v[90:91]
    v_cvt_pk_bf16_f32 v53, v74, v75
    v_pk_mul_f32 v[76:77], v[76:77], v[90:91]
    v_cvt_pk_bf16_f32 v54, v76, v77
    v_pk_mul_f32 v[78:79], v[78:79], v[90:91]
    v_cvt_pk_bf16_f32 v55, v78, v79
    ds_write_b128 v36, v[52:55] offset:4096
    v_pk_mul_f32 v[80:81], v[80:81], v[90:91]
    v_cvt_pk_bf16_f32 v56, v80, v81
    v_pk_mul_f32 v[82:83], v[82:83], v[90:91]
    v_cvt_pk_bf16_f32 v57, v82, v83
    v_pk_mul_f32 v[84:85], v[84:85], v[90:91]
    v_cvt_pk_bf16_f32 v58, v84, v85
    v_pk_mul_f32 v[86:87], v[86:87], v[90:91]
    v_cvt_pk_bf16_f32 v59, v86, v87
    s_mov_b32 exec_lo, 0xff
    s_mov_b32 exec_hi, 0xff
    ds_write_b128 v36, v[56:59] offset:8192
    s_mov_b64 exec, -1
    s_waitcnt lgkmcnt(0)
    s_barrier
    s_cmp_lg_u32 s3, 0
    s_cbranch_scc1 KF_x123
    ds_read_b128 v[136:139], v39 offset:0
    ds_read_b128 v[140:143], v39 offset:1024
    ds_read_b128 v[144:147], v39 offset:2048
    ds_read_b128 v[148:151], v39 offset:3072
    ds_read_b128 v[152:155], v39 offset:4096
    ds_read_b128 v[156:159], v39 offset:5120
    ds_read_b128 v[160:163], v39 offset:6144
    ds_read_b128 v[164:167], v39 offset:7168
    ds_read_b128 v[168:171], v39 offset:8192
    s_waitcnt lgkmcnt(8)
    buffer_store_dwordx4 v[136:139], v38, s[16:19], s7 offen offset:0 sc1
    s_waitcnt lgkmcnt(7)
    buffer_store_dwordx4 v[140:143], v38, s[16:19], s7 offen offset:2048 sc1
    s_add_u32 s7, s7, 4096
    s_waitcnt lgkmcnt(6)
    buffer_store_dwordx4 v[144:147], v38, s[16:19], s7 offen offset:0 sc1
    s_waitcnt lgkmcnt(5)
    buffer_store_dwordx4 v[148:151], v38, s[16:19], s7 offen offset:2048 sc1
    s_add_u32 s7, s7, 4096
    s_waitcnt lgkmcnt(4)
    buffer_store_dwordx4 v[152:155], v38, s[16:19], s7 offen offset:0 sc1
    s_waitcnt lgkmcnt(3)
    buffer_store_dwordx4 v[156:159], v38, s[16:19], s7 offen offset:2048 sc1
    s_add_u32 s7, s7, 4096
    s_waitcnt lgkmcnt(2)
    buffer_store_dwordx4 v[160:163], v38, s[16:19], s7 offen offset:0 sc1
    s_waitcnt lgkmcnt(1)
    buffer_store_dwordx4 v[164:167], v38, s[16:19], s7 offen offset:2048 sc1
    s_add_u32 s7, s7, 4096
    s_waitcnt lgkmcnt(0)
    buffer_store_dwordx4 v[168:171], v38, s[16:19], s7 offen offset:0 sc1
    v_lshlrev_b32 v38, 9, v21
    s_mov_b32 s73, 0
KF_tk:
    s_waitcnt vmcnt(0)
    v_cmp_eq_u32 vcc, 0, v7
    s_add_u32 s73, s73, 1
    s_cmp_ge_u32 s73, 100000
    s_cbranch_scc1 KF_tkd
    s_nop 0
    s_cbranch_vccz KF_tkd
    buffer_load_dword v7, v6, s[20:23], 0 offen sc1
    s_branch KF_tk
KF_tkd:
    s_mov_b32 exec_hi, 0
    buffer_store_dword v7, v38, s[16:19], s36 offen sc1
    s_mov_b64 exec, -1
    v_mov_b32 v39, 159744
    ds_write_b32 v39, v7
KF_x123:
    s_mov_b32 s20, s60
    s_mov_b32 s21, s61
    s_mov_b32 s22, 268435456
    s_mov_b32 s23, 0x20000
    s_cmp_lg_u32 s3, 0
    s_cbranch_scc1 KF_y123
    s_branch KF_y0
KF_y123:
    s_sub_u32 s72, s3, 1
    s_lshl_b32 s68, s72, 17
    s_lshl_b32 s73, s62, 8
    s_add_u32 s68, s68, s73
    s_lshl_b32 s72, s72, 12
KF_wql:
    s_add_u32 m0, s72, 0
    s_nop 0
    s_nop 0
    buffer_load_dwordx4 v2, s[8:11], s68 offen offset:0 lds
    s_add_u32 m0, s72, 896
    s_nop 0
    s_nop 0
    buffer_load_dwordx4 v2, s[8:11], s68 offen offset:128 lds
    s_add_u32 m0, s72, 2048
    s_nop 0
    s_nop 0
    buffer_load_dwordx4 v46, s[8:11], s68 offen offset:0 lds
    s_add_u32 m0, s72, 2944
    s_nop 0
    s_nop 0
    buffer_load_dwordx4 v46, s[8:11], s68 offen offset:128 lds
    s_add_u32 s68, s68, 393216
    s_add_u32 s72, s72, 12288
    s_cmp_lt_u32 s72, 147456
    s_cbranch_scc1 KF_wql
    s_waitcnt vmcnt(32)
KF_y0:
    s_waitcnt lgkmcnt(0)
    s_barrier
    v_mov_b32 v39, 159744
    ds_read_b32 v7, v39
    v_lshlrev_b32 v38, 2, v37
    s_mov_b32 s73, 0
KF_sp3:
    buffer_load_dword v39, v38, s[16:19], s92 offen sc1
    s_waitcnt vmcnt(0)
    s_waitcnt lgkmcnt(0)
    v_cmp_ne_u32 vcc, v39, v7
    s_add_u32 s73, s73, 1
    s_cmp_ge_u32 s73, 100000
    s_cbranch_scc1 KF_sd4
    s_cbranch_vccz KF_sd4
    s_sleep 2
    s_branch KF_sp3
KF_sd4:
    buffer_load_dwordx4 a[0:3], v232, s[16:19], s74 offen offset:0 sc1
    buffer_load_dwordx4 a[4:7], v233, s[16:19], s74 offen offset:0 sc1
    buffer_load_dwordx4 a[128:131], v234, s[16:19], s74 offen offset:0 sc1
    buffer_load_dwordx4 a[132:135], v235, s[16:19], s74 offen offset:0 sc1
    buffer_load_dwordx4 a[8:11], v232, s[16:19], s74 offen offset:1024 sc1
    buffer_load_dwordx4 a[12:15], v233, s[16:19], s74 offen offset:1024 sc1
    buffer_load_dwordx4 a[136:139], v234, s[16:19], s74 offen offset:1024 sc1
    buffer_load_dwordx4 a[140:143], v235, s[16:19], s74 offen offset:1024 sc1
    buffer_load_dwordx4 a[16:19], v232, s[16:19], s74 offen offset:2048 sc1
    buffer_load_dwordx4 a[20:23], v233, s[16:19], s74 offen offset:2048 sc1
    buffer_load_dwordx4 a[144:147], v234, s[16:19], s74 offen offset:2048 sc1
    buffer_load_dwordx4 a[148:151], v235, s[16:19], s74 offen offset:2048 sc1
    buffer_load_dwordx4 a[24:27], v232, s[16:19], s74 offen offset:3072 sc1
    buffer_load_dwordx4 a[28:31], v233, s[16:19], s74 offen offset:3072 sc1
    buffer_load_dwordx4 a[152:155], v234, s[16:19], s74 offen offset:3072 sc1
    buffer_load_dwordx4 a[156:159], v235, s[16:19], s74 offen offset:3072 sc1
    v_mov_b32 v2, v238
    ds_read_b64_tr_b16 v[176:177], v248 offset:0
    ds_read_b64_tr_b16 v[178:179], v248 offset:512
    ds_read_b64_tr_b16 v[180:181], v248 offset:8192
    ds_read_b64_tr_b16 v[182:183], v248 offset:8704
    ds_read_b64_tr_b16 v[184:185], v249 offset:0
    ds_read_b64_tr_b16 v[186:187], v249 offset:512
    ds_read_b64_tr_b16 v[188:189], v249 offset:8192
    ds_read_b64_tr_b16 v[190:191], v249 offset:8704
    s_waitcnt vmcnt(15) lgkmcnt(6)
    v_mfma_f32_16x16x32_bf16 v[48:51], v[176:179], a[0:3], 0
    ds_read_b64_tr_b16 v[192:193], v250 offset:0
    s_waitcnt vmcnt(11) lgkmcnt(5)
    v_mfma_f32_16x16x32_bf16 v[48:51], v[180:183], a[8:11], v[48:51]
    ds_read_b64_tr_b16 v[194:195], v250 offset:512
    v_mfma_f32_16x16x32_bf16 v[52:55], v[176:179], a[4:7], 0
    buffer_load_dwordx4 a[32:35], v232, s[16:19], s75 offen offset:0 sc1
    s_waitcnt vmcnt(11)
    v_mfma_f32_16x16x32_bf16 v[52:55], v[180:183], a[12:15], v[52:55]
    v_mfma_f32_16x16x32_bf16 v[56:59], v[176:179], a[128:131], 0
    ds_read_b64_tr_b16 v[196:197], v250 offset:8192
    s_waitcnt vmcnt(10)
    v_mfma_f32_16x16x32_bf16 v[56:59], v[180:183], a[136:139], v[56:59]
    ds_read_b64_tr_b16 v[198:199], v250 offset:8704
    s_waitcnt lgkmcnt(4)
    v_mfma_f32_16x16x32_bf16 v[60:63], v[176:179], a[132:135], 0
    buffer_load_dwordx4 a[36:39], v233, s[16:19], s75 offen offset:0 sc1
    s_waitcnt vmcnt(10)
    v_mfma_f32_16x16x32_bf16 v[60:63], v[180:183], a[140:143], v[60:63]
    v_mfma_f32_16x16x32_bf16 v[64:67], v[184:187], a[0:3], 0
    ds_read_b64_tr_b16 v[176:177], v251 offset:0
    v_mfma_f32_16x16x32_bf16 v[64:67], v[188:191], a[8:11], v[64:67]
    ds_read_b64_tr_b16 v[178:179], v251 offset:512
    v_mfma_f32_16x16x32_bf16 v[68:71], v[184:187], a[4:7], 0
    v_mfma_f32_16x16x32_bf16 v[68:71], v[188:191], a[12:15], v[68:71]
    buffer_load_dwordx4 a[160:163], v234, s[16:19], s75 offen offset:0 sc1
    v_mfma_f32_16x16x32_bf16 v[72:75], v[184:187], a[128:131], 0
    ds_read_b64_tr_b16 v[180:181], v251 offset:8192
    v_mfma_f32_16x16x32_bf16 v[72:75], v[188:191], a[136:139], v[72:75]
    ds_read_b64_tr_b16 v[182:183], v251 offset:8704
    s_waitcnt lgkmcnt(4)
    v_mfma_f32_16x16x32_bf16 v[76:79], v[184:187], a[132:135], 0
    v_mfma_f32_16x16x32_bf16 v[76:79], v[188:191], a[140:143], v[76:79]
    buffer_load_dwordx4 a[164:167], v235, s[16:19], s75 offen offset:0 sc1
    v_mfma_f32_16x16x32_bf16 v[80:83], v[192:195], a[0:3], 0
    ds_read_b64_tr_b16 v[184:185], v248 offset:1024
    v_mfma_f32_16x16x32_bf16 v[80:83], v[196:199], a[8:11], v[80:83]
    ds_read_b64_tr_b16 v[186:187], v248 offset:1536
    v_mfma_f32_16x16x32_bf16 v[84:87], v[192:195], a[4:7], 0
    v_mfma_f32_16x16x32_bf16 v[84:87], v[196:199], a[12:15], v[84:87]
    v_mfma_f32_16x16x32_bf16 v[88:91], v[192:195], a[128:131], 0
    ds_read_b64_tr_b16 v[188:189], v248 offset:9216
    v_mfma_f32_16x16x32_bf16 v[88:91], v[196:199], a[136:139], v[88:91]
    ds_read_b64_tr_b16 v[190:191], v248 offset:9728
    s_waitcnt lgkmcnt(4)
    v_mfma_f32_16x16x32_bf16 v[92:95], v[192:195], a[132:135], 0
    buffer_load_dwordx4 a[40:43], v232, s[16:19], s75 offen offset:1024 sc1
    v_mfma_f32_16x16x32_bf16 v[92:95], v[196:199], a[140:143], v[92:95]
    v_mfma_f32_16x16x32_bf16 v[96:99], v[176:179], a[0:3], 0
    ds_read_b64_tr_b16 v[192:193], v249 offset:1024
    v_mfma_f32_16x16x32_bf16 v[96:99], v[180:183], a[8:11], v[96:99]
    ds_read_b64_tr_b16 v[194:195], v249 offset:1536
    v_mfma_f32_16x16x32_bf16 v[100:103], v[176:179], a[4:7], 0
    buffer_load_dwordx4 a[44:47], v233, s[16:19], s75 offen offset:1024 sc1
    v_mfma_f32_16x16x32_bf16 v[100:103], v[180:183], a[12:15], v[100:103]
    v_mfma_f32_16x16x32_bf16 v[104:107], v[176:179], a[128:131], 0
    ds_read_b64_tr_b16 v[196:197], v249 offset:9216
    v_mfma_f32_16x16x32_bf16 v[104:107], v[180:183], a[136:139], v[104:107]
    ds_read_b64_tr_b16 v[198:199], v249 offset:9728
    s_waitcnt lgkmcnt(4)
    v_mfma_f32_16x16x32_bf16 v[108:111], v[176:179], a[132:135], 0
    buffer_load_dwordx4 a[168:171], v234, s[16:19], s75 offen offset:1024 sc1
    v_mfma_f32_16x16x32_bf16 v[108:111], v[180:183], a[140:143], v[108:111]
    v_mfma_f32_16x16x32_bf16 v[112:115], v[184:187], a[0:3], 0
    ds_read_b64_tr_b16 v[176:177], v250 offset:1024
    v_mfma_f32_16x16x32_bf16 v[112:115], v[188:191], a[8:11], v[112:115]
    ds_read_b64_tr_b16 v[178:179], v250 offset:1536
    v_mfma_f32_16x16x32_bf16 v[116:119], v[184:187], a[4:7], 0
    buffer_load_dwordx4 a[172:175], v235, s[16:19], s75 offen offset:1024 sc1
    v_mfma_f32_16x16x32_bf16 v[116:119], v[188:191], a[12:15], v[116:119]
    v_mfma_f32_16x16x32_bf16 v[120:123], v[184:187], a[128:131], 0
    ds_read_b64_tr_b16 v[180:181], v250 offset:9216
    v_mfma_f32_16x16x32_bf16 v[120:123], v[188:191], a[136:139], v[120:123]
    ds_read_b64_tr_b16 v[182:183], v250 offset:9728
    s_waitcnt lgkmcnt(4)
    v_mfma_f32_16x16x32_bf16 v[124:127], v[184:187], a[132:135], 0
    buffer_load_dwordx4 a[48:51], v232, s[16:19], s75 offen offset:2048 sc1
    v_mfma_f32_16x16x32_bf16 v[124:127], v[188:191], a[140:143], v[124:127]
    v_mfma_f32_16x16x32_bf16 v[128:131], v[192:195], a[0:3], 0
    ds_read_b64_tr_b16 v[184:185], v251 offset:1024
    v_mfma_f32_16x16x32_bf16 v[128:131], v[196:199], a[8:11], v[128:131]
    ds_read_b64_tr_b16 v[186:187], v251 offset:1536
    v_mfma_f32_16x16x32_bf16 v[132:135], v[192:195], a[4:7], 0
    buffer_load_dwordx4 a[52:55], v233, s[16:19], s75 offen offset:2048 sc1
    v_mfma_f32_16x16x32_bf16 v[132:135], v[196:199], a[12:15], v[132:135]
    v_mfma_f32_16x16x32_bf16 v[136:139], v[192:195], a[128:131], 0
    ds_read_b64_tr_b16 v[188:189], v251 offset:9216
    v_mfma_f32_16x16x32_bf16 v[136:139], v[196:199], a[136:139], v[136:139]
    ds_read_b64_tr_b16 v[190:191], v251 offset:9728
    s_waitcnt lgkmcnt(4)
    v_mfma_f32_16x16x32_bf16 v[140:143], v[192:195], a[132:135], 0
    v_mfma_f32_16x16x32_bf16 v[140:143], v[196:199], a[140:143], v[140:143]
    buffer_load_dwordx4 a[176:179], v234, s[16:19], s75 offen offset:2048 sc1
    v_mfma_f32_16x16x32_bf16 v[144:147], v[176:179], a[0:3], 0
    ds_read_b64_tr_b16 v[192:193], v248 offset:16384
    v_mfma_f32_16x16x32_bf16 v[144:147], v[180:183], a[8:11], v[144:147]
    ds_read_b64_tr_b16 v[194:195], v248 offset:16896
    v_mfma_f32_16x16x32_bf16 v[148:151], v[176:179], a[4:7], 0
    v_mfma_f32_16x16x32_bf16 v[148:151], v[180:183], a[12:15], v[148:151]
    buffer_load_dwordx4 a[180:183], v235, s[16:19], s75 offen offset:2048 sc1
    v_mfma_f32_16x16x32_bf16 v[152:155], v[176:179], a[128:131], 0
    ds_read_b64_tr_b16 v[196:197], v248 offset:24576
    v_mfma_f32_16x16x32_bf16 v[152:155], v[180:183], a[136:139], v[152:155]
    ds_read_b64_tr_b16 v[198:199], v248 offset:25088
    s_waitcnt lgkmcnt(4)
    v_mfma_f32_16x16x32_bf16 v[156:159], v[176:179], a[132:135], 0
    v_mfma_f32_16x16x32_bf16 v[156:159], v[180:183], a[140:143], v[156:159]
    v_mfma_f32_16x16x32_bf16 v[160:163], v[184:187], a[0:3], 0
    ds_read_b64_tr_b16 v[176:177], v249 offset:16384
    v_mfma_f32_16x16x32_bf16 v[160:163], v[188:191], a[8:11], v[160:163]
    ds_read_b64_tr_b16 v[178:179], v249 offset:16896
    v_mfma_f32_16x16x32_bf16 v[164:167], v[184:187], a[4:7], 0
    buffer_load_dwordx4 a[56:59], v232, s[16:19], s75 offen offset:3072 sc1
    v_mfma_f32_16x16x32_bf16 v[164:167], v[188:191], a[12:15], v[164:167]
    v_mfma_f32_16x16x32_bf16 v[168:171], v[184:187], a[128:131], 0
    ds_read_b64_tr_b16 v[180:181], v249 offset:24576
    s_waitcnt vmcnt(13)
    v_mfma_f32_16x16x32_bf16 v[168:171], v[188:191], a[136:139], v[168:171]
    ds_read_b64_tr_b16 v[182:183], v249 offset:25088
    s_waitcnt lgkmcnt(4)
    v_mfma_f32_16x16x32_bf16 v[172:175], v[184:187], a[132:135], 0
    buffer_load_dwordx4 a[60:63], v233, s[16:19], s75 offen offset:3072 sc1
    v_mfma_f32_16x16x32_bf16 v[172:175], v[188:191], a[140:143], v[172:175]
    v_mfma_f32_16x16x32_bf16 v[48:51], v[192:195], a[16:19], v[48:51]
    ds_read_b64_tr_b16 v[184:185], v250 offset:16384
    v_mfma_f32_16x16x32_bf16 v[48:51], v[196:199], a[24:27], v[48:51]
    ds_read_b64_tr_b16 v[186:187], v250 offset:16896
    v_mfma_f32_16x16x32_bf16 v[52:55], v[196:199], a[28:31], v[52:55]
    buffer_load_dwordx4 a[184:187], v234, s[16:19], s75 offen offset:3072 sc1
    v_mfma_f32_16x16x32_bf16 v[52:55], v[192:195], a[20:23], v[52:55]
    v_mfma_f32_16x16x32_bf16 v[56:59], v[192:195], a[144:147], v[56:59]
    ds_read_b64_tr_b16 v[188:189], v250 offset:24576
    v_mfma_f32_16x16x32_bf16 v[56:59], v[196:199], a[152:155], v[56:59]
    ds_read_b64_tr_b16 v[190:191], v250 offset:25088
    s_waitcnt lgkmcnt(4)
    v_mfma_f32_16x16x32_bf16 v[60:63], v[196:199], a[156:159], v[60:63]
    buffer_load_dwordx4 a[188:191], v235, s[16:19], s75 offen offset:3072 sc1
    v_mfma_f32_16x16x32_bf16 v[60:63], v[192:195], a[148:151], v[60:63]
    v_mfma_f32_16x16x32_bf16 v[64:67], v[176:179], a[16:19], v[64:67]
    ds_read_b64_tr_b16 v[192:193], v251 offset:16384
    v_mfma_f32_16x16x32_bf16 v[64:67], v[180:183], a[24:27], v[64:67]
    ds_read_b64_tr_b16 v[194:195], v251 offset:16896
    v_mfma_f32_16x16x32_bf16 v[68:71], v[180:183], a[28:31], v[68:71]
    buffer_load_dwordx4 a[64:67], v232, s[16:19], s76 offen offset:0 sc1
    v_mfma_f32_16x16x32_bf16 v[68:71], v[176:179], a[20:23], v[68:71]
    v_mfma_f32_16x16x32_bf16 v[72:75], v[176:179], a[144:147], v[72:75]
    ds_read_b64_tr_b16 v[196:197], v251 offset:24576
    v_mfma_f32_16x16x32_bf16 v[72:75], v[180:183], a[152:155], v[72:75]
    ds_read_b64_tr_b16 v[198:199], v251 offset:25088
    s_waitcnt lgkmcnt(4)
    v_mfma_f32_16x16x32_bf16 v[76:79], v[180:183], a[156:159], v[76:79]
    v_mfma_f32_16x16x32_bf16 v[76:79], v[176:179], a[148:151], v[76:79]
    buffer_load_dwordx4 a[68:71], v233, s[16:19], s76 offen offset:0 sc1
    v_mfma_f32_16x16x32_bf16 v[80:83], v[184:187], a[16:19], v[80:83]
    ds_read_b64_tr_b16 v[176:177], v248 offset:17408
    v_mfma_f32_16x16x32_bf16 v[80:83], v[188:191], a[24:27], v[80:83]
    ds_read_b64_tr_b16 v[178:179], v248 offset:17920
    v_mfma_f32_16x16x32_bf16 v[84:87], v[188:191], a[28:31], v[84:87]
    v_mfma_f32_16x16x32_bf16 v[84:87], v[184:187], a[20:23], v[84:87]
    buffer_load_dwordx4 a[192:195], v234, s[16:19], s76 offen offset:0 sc1
    v_mfma_f32_16x16x32_bf16 v[88:91], v[184:187], a[144:147], v[88:91]
    ds_read_b64_tr_b16 v[180:181], v248 offset:25600
    v_mfma_f32_16x16x32_bf16 v[88:91], v[188:191], a[152:155], v[88:91]
    ds_read_b64_tr_b16 v[182:183], v248 offset:26112
    s_waitcnt lgkmcnt(4)
    v_mfma_f32_16x16x32_bf16 v[92:95], v[188:191], a[156:159], v[92:95]
    v_mfma_f32_16x16x32_bf16 v[92:95], v[184:187], a[148:151], v[92:95]
    v_mfma_f32_16x16x32_bf16 v[96:99], v[192:195], a[16:19], v[96:99]
    ds_read_b64_tr_b16 v[184:185], v249 offset:17408
    v_mfma_f32_16x16x32_bf16 v[96:99], v[196:199], a[24:27], v[96:99]
    ds_read_b64_tr_b16 v[186:187], v249 offset:17920
    v_mfma_f32_16x16x32_bf16 v[100:103], v[196:199], a[28:31], v[100:103]
    buffer_load_dwordx4 a[196:199], v235, s[16:19], s76 offen offset:0 sc1
    v_mfma_f32_16x16x32_bf16 v[100:103], v[192:195], a[20:23], v[100:103]
    v_mfma_f32_16x16x32_bf16 v[104:107], v[192:195], a[144:147], v[104:107]
    ds_read_b64_tr_b16 v[188:189], v249 offset:25600
    v_mfma_f32_16x16x32_bf16 v[104:107], v[196:199], a[152:155], v[104:107]
    ds_read_b64_tr_b16 v[190:191], v249 offset:26112
    s_waitcnt lgkmcnt(4)
    v_mfma_f32_16x16x32_bf16 v[108:111], v[196:199], a[156:159], v[108:111]
    buffer_load_dwordx4 a[72:75], v232, s[16:19], s76 offen offset:1024 sc1
    v_mfma_f32_16x16x32_bf16 v[108:111], v[192:195], a[148:151], v[108:111]
    v_mfma_f32_16x16x32_bf16 v[112:115], v[176:179], a[16:19], v[112:115]
    ds_read_b64_tr_b16 v[192:193], v250 offset:17408
    v_mfma_f32_16x16x32_bf16 v[112:115], v[180:183], a[24:27], v[112:115]
    ds_read_b64_tr_b16 v[194:195], v250 offset:17920
    v_mfma_f32_16x16x32_bf16 v[116:119], v[180:183], a[28:31], v[116:119]
    buffer_load_dwordx4 a[76:79], v233, s[16:19], s76 offen offset:1024 sc1
    v_mfma_f32_16x16x32_bf16 v[116:119], v[176:179], a[20:23], v[116:119]
    v_mfma_f32_16x16x32_bf16 v[120:123], v[176:179], a[144:147], v[120:123]
    ds_read_b64_tr_b16 v[196:197], v250 offset:25600
    v_mfma_f32_16x16x32_bf16 v[120:123], v[180:183], a[152:155], v[120:123]
    ds_read_b64_tr_b16 v[198:199], v250 offset:26112
    s_waitcnt lgkmcnt(4)
    v_mfma_f32_16x16x32_bf16 v[124:127], v[180:183], a[156:159], v[124:127]
    buffer_load_dwordx4 a[200:203], v234, s[16:19], s76 offen offset:1024 sc1
    v_mfma_f32_16x16x32_bf16 v[124:127], v[176:179], a[148:151], v[124:127]
    v_mfma_f32_16x16x32_bf16 v[128:131], v[184:187], a[16:19], v[128:131]
    ds_read_b64_tr_b16 v[176:177], v251 offset:17408
    v_mfma_f32_16x16x32_bf16 v[128:131], v[188:191], a[24:27], v[128:131]
    ds_read_b64_tr_b16 v[178:179], v251 offset:17920
    v_mfma_f32_16x16x32_bf16 v[132:135], v[188:191], a[28:31], v[132:135]
    buffer_load_dwordx4 a[204:207], v235, s[16:19], s76 offen offset:1024 sc1
    v_mfma_f32_16x16x32_bf16 v[132:135], v[184:187], a[20:23], v[132:135]
    v_mfma_f32_16x16x32_bf16 v[136:139], v[184:187], a[144:147], v[136:139]
    ds_read_b64_tr_b16 v[180:181], v251 offset:25600
    v_mfma_f32_16x16x32_bf16 v[136:139], v[188:191], a[152:155], v[136:139]
    ds_read_b64_tr_b16 v[182:183], v251 offset:26112
    s_waitcnt lgkmcnt(4)
    v_mfma_f32_16x16x32_bf16 v[140:143], v[188:191], a[156:159], v[140:143]
    buffer_load_dwordx4 a[80:83], v232, s[16:19], s76 offen offset:2048 sc1
    v_mfma_f32_16x16x32_bf16 v[140:143], v[184:187], a[148:151], v[140:143]
    v_mfma_f32_16x16x32_bf16 v[144:147], v[192:195], a[16:19], v[144:147]
    ds_read_b64_tr_b16 v[184:185], v248 offset:32768
    v_mfma_f32_16x16x32_bf16 v[144:147], v[196:199], a[24:27], v[144:147]
    ds_read_b64_tr_b16 v[186:187], v248 offset:33280
    v_mfma_f32_16x16x32_bf16 v[148:151], v[196:199], a[28:31], v[148:151]
    v_mfma_f32_16x16x32_bf16 v[148:151], v[192:195], a[20:23], v[148:151]
    buffer_load_dwordx4 a[84:87], v233, s[16:19], s76 offen offset:2048 sc1
    v_mfma_f32_16x16x32_bf16 v[152:155], v[192:195], a[144:147], v[152:155]
    ds_read_b64_tr_b16 v[188:189], v248 offset:40960
    v_mfma_f32_16x16x32_bf16 v[152:155], v[196:199], a[152:155], v[152:155]
    ds_read_b64_tr_b16 v[190:191], v248 offset:41472
    s_waitcnt lgkmcnt(4)
    v_mfma_f32_16x16x32_bf16 v[156:159], v[196:199], a[156:159], v[156:159]
    v_mfma_f32_16x16x32_bf16 v[156:159], v[192:195], a[148:151], v[156:159]
    buffer_load_dwordx4 a[208:211], v234, s[16:19], s76 offen offset:2048 sc1
    v_mfma_f32_16x16x32_bf16 v[160:163], v[176:179], a[16:19], v[160:163]
    ds_read_b64_tr_b16 v[192:193], v249 offset:32768
    v_mfma_f32_16x16x32_bf16 v[160:163], v[180:183], a[24:27], v[160:163]
    ds_read_b64_tr_b16 v[194:195], v249 offset:33280
    v_mfma_f32_16x16x32_bf16 v[164:167], v[180:183], a[28:31], v[164:167]
    v_mfma_f32_16x16x32_bf16 v[164:167], v[176:179], a[20:23], v[164:167]
    v_mfma_f32_16x16x32_bf16 v[168:171], v[176:179], a[144:147], v[168:171]
    ds_read_b64_tr_b16 v[196:197], v249 offset:40960
    s_waitcnt vmcnt(19)
    v_mfma_f32_16x16x32_bf16 v[168:171], v[180:183], a[152:155], v[168:171]
    ds_read_b64_tr_b16 v[198:199], v249 offset:41472
    s_waitcnt lgkmcnt(4)
    v_mfma_f32_16x16x32_bf16 v[172:175], v[180:183], a[156:159], v[172:175]
    buffer_load_dwordx4 a[212:215], v235, s[16:19], s76 offen offset:2048 sc1
    v_mfma_f32_16x16x32_bf16 v[172:175], v[176:179], a[148:151], v[172:175]
    v_mfma_f32_16x16x32_bf16 v[48:51], v[184:187], a[32:35], v[48:51]
    ds_read_b64_tr_b16 v[176:177], v250 offset:32768
    v_mfma_f32_16x16x32_bf16 v[48:51], v[188:191], a[40:43], v[48:51]
    ds_read_b64_tr_b16 v[178:179], v250 offset:33280
    v_mfma_f32_16x16x32_bf16 v[52:55], v[188:191], a[44:47], v[52:55]
    buffer_load_dwordx4 a[88:91], v232, s[16:19], s76 offen offset:3072 sc1
    v_mfma_f32_16x16x32_bf16 v[52:55], v[184:187], a[36:39], v[52:55]
    v_mfma_f32_16x16x32_bf16 v[56:59], v[184:187], a[160:163], v[56:59]
    ds_read_b64_tr_b16 v[180:181], v250 offset:40960
    v_mfma_f32_16x16x32_bf16 v[56:59], v[188:191], a[168:171], v[56:59]
    ds_read_b64_tr_b16 v[182:183], v250 offset:41472
    s_waitcnt lgkmcnt(4)
    v_mfma_f32_16x16x32_bf16 v[60:63], v[188:191], a[172:175], v[60:63]
    buffer_load_dwordx4 a[92:95], v233, s[16:19], s76 offen offset:3072 sc1
    v_mfma_f32_16x16x32_bf16 v[60:63], v[184:187], a[164:167], v[60:63]
    v_mfma_f32_16x16x32_bf16 v[64:67], v[192:195], a[32:35], v[64:67]
    ds_read_b64_tr_b16 v[184:185], v251 offset:32768
    v_mfma_f32_16x16x32_bf16 v[64:67], v[196:199], a[40:43], v[64:67]
    ds_read_b64_tr_b16 v[186:187], v251 offset:33280
    v_mfma_f32_16x16x32_bf16 v[68:71], v[196:199], a[44:47], v[68:71]
    buffer_load_dwordx4 a[216:219], v234, s[16:19], s76 offen offset:3072 sc1
    v_mfma_f32_16x16x32_bf16 v[68:71], v[192:195], a[36:39], v[68:71]
    v_mfma_f32_16x16x32_bf16 v[72:75], v[192:195], a[160:163], v[72:75]
    ds_read_b64_tr_b16 v[188:189], v251 offset:40960
    v_mfma_f32_16x16x32_bf16 v[72:75], v[196:199], a[168:171], v[72:75]
    ds_read_b64_tr_b16 v[190:191], v251 offset:41472
    s_waitcnt lgkmcnt(4)
    v_mfma_f32_16x16x32_bf16 v[76:79], v[196:199], a[172:175], v[76:79]
    buffer_load_dwordx4 a[220:223], v235, s[16:19], s76 offen offset:3072 sc1
    v_mfma_f32_16x16x32_bf16 v[76:79], v[192:195], a[164:167], v[76:79]
    v_mfma_f32_16x16x32_bf16 v[80:83], v[176:179], a[32:35], v[80:83]
    ds_read_b64_tr_b16 v[192:193], v248 offset:33792
    v_mfma_f32_16x16x32_bf16 v[80:83], v[180:183], a[40:43], v[80:83]
    ds_read_b64_tr_b16 v[194:195], v248 offset:34304
    v_mfma_f32_16x16x32_bf16 v[84:87], v[180:183], a[44:47], v[84:87]
    v_mfma_f32_16x16x32_bf16 v[84:87], v[176:179], a[36:39], v[84:87]
    buffer_load_dwordx4 a[96:99], v232, s[16:19], s77 offen offset:0 sc1
    v_mfma_f32_16x16x32_bf16 v[88:91], v[176:179], a[160:163], v[88:91]
    ds_read_b64_tr_b16 v[196:197], v248 offset:41984
    v_mfma_f32_16x16x32_bf16 v[88:91], v[180:183], a[168:171], v[88:91]
    ds_read_b64_tr_b16 v[198:199], v248 offset:42496
    s_waitcnt lgkmcnt(4)
    v_mfma_f32_16x16x32_bf16 v[92:95], v[180:183], a[172:175], v[92:95]
    v_mfma_f32_16x16x32_bf16 v[92:95], v[176:179], a[164:167], v[92:95]
    buffer_load_dwordx4 a[100:103], v233, s[16:19], s77 offen offset:0 sc1
    v_mfma_f32_16x16x32_bf16 v[96:99], v[184:187], a[32:35], v[96:99]
    ds_read_b64_tr_b16 v[176:177], v249 offset:33792
    v_mfma_f32_16x16x32_bf16 v[96:99], v[188:191], a[40:43], v[96:99]
    ds_read_b64_tr_b16 v[178:179], v249 offset:34304
    v_mfma_f32_16x16x32_bf16 v[100:103], v[188:191], a[44:47], v[100:103]
    v_mfma_f32_16x16x32_bf16 v[100:103], v[184:187], a[36:39], v[100:103]
    v_mfma_f32_16x16x32_bf16 v[104:107], v[184:187], a[160:163], v[104:107]
    ds_read_b64_tr_b16 v[180:181], v249 offset:41984
    v_mfma_f32_16x16x32_bf16 v[104:107], v[188:191], a[168:171], v[104:107]
    ds_read_b64_tr_b16 v[182:183], v249 offset:42496
    s_waitcnt lgkmcnt(4)
    v_mfma_f32_16x16x32_bf16 v[108:111], v[188:191], a[172:175], v[108:111]
    buffer_load_dwordx4 a[224:227], v234, s[16:19], s77 offen offset:0 sc1
    v_mfma_f32_16x16x32_bf16 v[108:111], v[184:187], a[164:167], v[108:111]
    v_mfma_f32_16x16x32_bf16 v[112:115], v[192:195], a[32:35], v[112:115]
    ds_read_b64_tr_b16 v[184:185], v250 offset:33792
    v_mfma_f32_16x16x32_bf16 v[112:115], v[196:199], a[40:43], v[112:115]
    ds_read_b64_tr_b16 v[186:187], v250 offset:34304
    v_mfma_f32_16x16x32_bf16 v[116:119], v[196:199], a[44:47], v[116:119]
    s_barrier
    v_mfma_f32_16x16x32_bf16 v[116:119], v[192:195], a[36:39], v[116:119]
    buffer_load_dwordx4 a[228:231], v235, s[16:19], s77 offen offset:0 sc1
    v_mfma_f32_16x16x32_bf16 v[120:123], v[192:195], a[160:163], v[120:123]
    ds_read_b64_tr_b16 v[188:189], v250 offset:41984
    v_mfma_f32_16x16x32_bf16 v[120:123], v[196:199], a[168:171], v[120:123]
    ds_read_b64_tr_b16 v[190:191], v250 offset:42496
    s_waitcnt lgkmcnt(4)
    v_mfma_f32_16x16x32_bf16 v[124:127], v[196:199], a[172:175], v[124:127]
    buffer_load_dwordx4 a[104:107], v232, s[16:19], s77 offen offset:1024 sc1
    v_mfma_f32_16x16x32_bf16 v[124:127], v[192:195], a[164:167], v[124:127]
    v_mfma_f32_16x16x32_bf16 v[128:131], v[176:179], a[32:35], v[128:131]
    ds_read_b64_tr_b16 v[192:193], v251 offset:33792
    v_mfma_f32_16x16x32_bf16 v[128:131], v[180:183], a[40:43], v[128:131]
    ds_read_b64_tr_b16 v[194:195], v251 offset:34304
    v_mfma_f32_16x16x32_bf16 v[132:135], v[180:183], a[44:47], v[132:135]
    buffer_load_dwordx4 a[108:111], v233, s[16:19], s77 offen offset:1024 sc1
    v_mfma_f32_16x16x32_bf16 v[132:135], v[176:179], a[36:39], v[132:135]
    v_mfma_f32_16x16x32_bf16 v[136:139], v[176:179], a[160:163], v[136:139]
    ds_read_b64_tr_b16 v[196:197], v251 offset:41984
    v_mfma_f32_16x16x32_bf16 v[136:139], v[180:183], a[168:171], v[136:139]
    ds_read_b64_tr_b16 v[198:199], v251 offset:42496
    s_waitcnt lgkmcnt(4)
    v_mfma_f32_16x16x32_bf16 v[140:143], v[180:183], a[172:175], v[140:143]
    buffer_load_dwordx4 a[232:235], v234, s[16:19], s77 offen offset:1024 sc1
    v_mfma_f32_16x16x32_bf16 v[140:143], v[176:179], a[164:167], v[140:143]
    v_mfma_f32_16x16x32_bf16 v[144:147], v[184:187], a[32:35], v[144:147]
    ds_read_b64_tr_b16 v[176:177], v248 offset:49152
    v_mfma_f32_16x16x32_bf16 v[144:147], v[188:191], a[40:43], v[144:147]
    ds_read_b64_tr_b16 v[178:179], v248 offset:49664
    v_mfma_f32_16x16x32_bf16 v[148:151], v[188:191], a[44:47], v[148:151]
    buffer_load_dwordx4 a[236:239], v235, s[16:19], s77 offen offset:1024 sc1
    v_mfma_f32_16x16x32_bf16 v[148:151], v[184:187], a[36:39], v[148:151]
    v_mfma_f32_16x16x32_bf16 v[152:155], v[184:187], a[160:163], v[152:155]
    ds_read_b64_tr_b16 v[180:181], v248 offset:57344
    v_mfma_f32_16x16x32_bf16 v[152:155], v[188:191], a[168:171], v[152:155]
    ds_read_b64_tr_b16 v[182:183], v248 offset:57856
    s_waitcnt lgkmcnt(4)
    v_mfma_f32_16x16x32_bf16 v[156:159], v[188:191], a[172:175], v[156:159]
    v_mfma_f32_16x16x32_bf16 v[156:159], v[184:187], a[164:167], v[156:159]
    buffer_load_dwordx4 a[112:115], v232, s[16:19], s77 offen offset:2048 sc1
    v_mfma_f32_16x16x32_bf16 v[160:163], v[192:195], a[32:35], v[160:163]
    ds_read_b64_tr_b16 v[184:185], v249 offset:49152
    v_mfma_f32_16x16x32_bf16 v[160:163], v[196:199], a[40:43], v[160:163]
    ds_read_b64_tr_b16 v[186:187], v249 offset:49664
    v_mfma_f32_16x16x32_bf16 v[164:167], v[196:199], a[44:47], v[164:167]
    v_mfma_f32_16x16x32_bf16 v[164:167], v[192:195], a[36:39], v[164:167]
    buffer_load_dwordx4 a[116:119], v233, s[16:19], s77 offen offset:2048 sc1
    v_mfma_f32_16x16x32_bf16 v[168:171], v[192:195], a[160:163], v[168:171]
    ds_read_b64_tr_b16 v[188:189], v249 offset:57344
    s_waitcnt vmcnt(26)
    v_mfma_f32_16x16x32_bf16 v[168:171], v[196:199], a[168:171], v[168:171]
    ds_read_b64_tr_b16 v[190:191], v249 offset:57856
    s_waitcnt lgkmcnt(4)
    v_mfma_f32_16x16x32_bf16 v[172:175], v[196:199], a[172:175], v[172:175]
    v_mfma_f32_16x16x32_bf16 v[172:175], v[192:195], a[164:167], v[172:175]
    v_mfma_f32_16x16x32_bf16 v[48:51], v[176:179], a[48:51], v[48:51]
    ds_read_b64_tr_b16 v[192:193], v250 offset:49152
    v_mfma_f32_16x16x32_bf16 v[48:51], v[180:183], a[56:59], v[48:51]
    ds_read_b64_tr_b16 v[194:195], v250 offset:49664
    v_mfma_f32_16x16x32_bf16 v[52:55], v[180:183], a[60:63], v[52:55]
    buffer_load_dwordx4 a[240:243], v234, s[16:19], s77 offen offset:2048 sc1
    v_mfma_f32_16x16x32_bf16 v[52:55], v[176:179], a[52:55], v[52:55]
    v_mfma_f32_16x16x32_bf16 v[56:59], v[176:179], a[176:179], v[56:59]
    ds_read_b64_tr_b16 v[196:197], v250 offset:57344
    v_mfma_f32_16x16x32_bf16 v[56:59], v[180:183], a[184:187], v[56:59]
    ds_read_b64_tr_b16 v[198:199], v250 offset:57856
    s_waitcnt lgkmcnt(4)
    v_mfma_f32_16x16x32_bf16 v[60:63], v[180:183], a[188:191], v[60:63]
    buffer_load_dwordx4 a[244:247], v235, s[16:19], s77 offen offset:2048 sc1
    v_mfma_f32_16x16x32_bf16 v[60:63], v[176:179], a[180:183], v[60:63]
    v_mfma_f32_16x16x32_bf16 v[64:67], v[184:187], a[48:51], v[64:67]
    ds_read_b64_tr_b16 v[176:177], v251 offset:49152
    v_mfma_f32_16x16x32_bf16 v[64:67], v[188:191], a[56:59], v[64:67]
    ds_read_b64_tr_b16 v[178:179], v251 offset:49664
    v_mfma_f32_16x16x32_bf16 v[68:71], v[188:191], a[60:63], v[68:71]
    buffer_load_dwordx4 a[120:123], v232, s[16:19], s77 offen offset:3072 sc1
    v_mfma_f32_16x16x32_bf16 v[68:71], v[184:187], a[52:55], v[68:71]
    v_mfma_f32_16x16x32_bf16 v[72:75], v[184:187], a[176:179], v[72:75]
    ds_read_b64_tr_b16 v[180:181], v251 offset:57344
    v_mfma_f32_16x16x32_bf16 v[72:75], v[188:191], a[184:187], v[72:75]
    ds_read_b64_tr_b16 v[182:183], v251 offset:57856
    s_waitcnt lgkmcnt(4)
    v_mfma_f32_16x16x32_bf16 v[76:79], v[188:191], a[188:191], v[76:79]
    buffer_load_dwordx4 a[124:127], v233, s[16:19], s77 offen offset:3072 sc1
    v_mfma_f32_16x16x32_bf16 v[76:79], v[184:187], a[180:183], v[76:79]
    v_mfma_f32_16x16x32_bf16 v[80:83], v[192:195], a[48:51], v[80:83]
    ds_read_b64_tr_b16 v[184:185], v248 offset:50176
    v_mfma_f32_16x16x32_bf16 v[80:83], v[196:199], a[56:59], v[80:83]
    ds_read_b64_tr_b16 v[186:187], v248 offset:50688
    v_mfma_f32_16x16x32_bf16 v[84:87], v[196:199], a[60:63], v[84:87]
    buffer_load_dwordx4 a[248:251], v234, s[16:19], s77 offen offset:3072 sc1
    v_mfma_f32_16x16x32_bf16 v[84:87], v[192:195], a[52:55], v[84:87]
    v_mfma_f32_16x16x32_bf16 v[88:91], v[192:195], a[176:179], v[88:91]
    ds_read_b64_tr_b16 v[188:189], v248 offset:58368
    v_mfma_f32_16x16x32_bf16 v[88:91], v[196:199], a[184:187], v[88:91]
    ds_read_b64_tr_b16 v[190:191], v248 offset:58880
    s_waitcnt lgkmcnt(4)
    v_mfma_f32_16x16x32_bf16 v[92:95], v[196:199], a[188:191], v[92:95]
    v_mfma_f32_16x16x32_bf16 v[92:95], v[192:195], a[180:183], v[92:95]
    buffer_load_dwordx4 a[252:255], v235, s[16:19], s77 offen offset:3072 sc1
    v_mfma_f32_16x16x32_bf16 v[96:99], v[176:179], a[48:51], v[96:99]
    ds_read_b64_tr_b16 v[192:193], v249 offset:50176
    v_mfma_f32_16x16x32_bf16 v[96:99], v[180:183], a[56:59], v[96:99]
    ds_read_b64_tr_b16 v[194:195], v249 offset:50688
    v_mfma_f32_16x16x32_bf16 v[100:103], v[180:183], a[60:63], v[100:103]
    v_mfma_f32_16x16x32_bf16 v[100:103], v[176:179], a[52:55], v[100:103]
    buffer_load_dwordx4 v[16:19], v232, s[16:19], s78 offen offset:0 sc1
    v_mfma_f32_16x16x32_bf16 v[104:107], v[176:179], a[176:179], v[104:107]
    ds_read_b64_tr_b16 v[196:197], v249 offset:58368
    v_mfma_f32_16x16x32_bf16 v[104:107], v[180:183], a[184:187], v[104:107]
    ds_read_b64_tr_b16 v[198:199], v249 offset:58880
    s_waitcnt lgkmcnt(4)
    v_mfma_f32_16x16x32_bf16 v[108:111], v[180:183], a[188:191], v[108:111]
    v_mfma_f32_16x16x32_bf16 v[108:111], v[176:179], a[180:183], v[108:111]
    v_mfma_f32_16x16x32_bf16 v[112:115], v[184:187], a[48:51], v[112:115]
    ds_read_b64_tr_b16 v[176:177], v250 offset:50176
    v_mfma_f32_16x16x32_bf16 v[112:115], v[188:191], a[56:59], v[112:115]
    ds_read_b64_tr_b16 v[178:179], v250 offset:50688
    v_mfma_f32_16x16x32_bf16 v[116:119], v[188:191], a[60:63], v[116:119]
    buffer_load_dwordx4 v[20:23], v233, s[16:19], s78 offen offset:0 sc1
    v_mfma_f32_16x16x32_bf16 v[116:119], v[184:187], a[52:55], v[116:119]
    v_mfma_f32_16x16x32_bf16 v[120:123], v[184:187], a[176:179], v[120:123]
    ds_read_b64_tr_b16 v[180:181], v250 offset:58368
    v_mfma_f32_16x16x32_bf16 v[120:123], v[188:191], a[184:187], v[120:123]
    ds_read_b64_tr_b16 v[182:183], v250 offset:58880
    s_waitcnt lgkmcnt(4)
    v_mfma_f32_16x16x32_bf16 v[124:127], v[188:191], a[188:191], v[124:127]
    buffer_load_dwordx4 v[32:35], v234, s[16:19], s78 offen offset:0 sc1
    v_mfma_f32_16x16x32_bf16 v[124:127], v[184:187], a[180:183], v[124:127]
    v_mfma_f32_16x16x32_bf16 v[128:131], v[192:195], a[48:51], v[128:131]
    ds_read_b64_tr_b16 v[184:185], v251 offset:50176
    v_mfma_f32_16x16x32_bf16 v[128:131], v[196:199], a[56:59], v[128:131]
    ds_read_b64_tr_b16 v[186:187], v251 offset:50688
    v_mfma_f32_16x16x32_bf16 v[132:135], v[196:199], a[60:63], v[132:135]
    buffer_load_dwordx4 v[36:39], v235, s[16:19], s78 offen offset:0 sc1
    v_mfma_f32_16x16x32_bf16 v[132:135], v[192:195], a[52:55], v[132:135]
    v_mfma_f32_16x16x32_bf16 v[136:139], v[192:195], a[176:179], v[136:139]
    ds_read_b64_tr_b16 v[188:189], v251 offset:58368
    v_mfma_f32_16x16x32_bf16 v[136:139], v[196:199], a[184:187], v[136:139]
    ds_read_b64_tr_b16 v[190:191], v251 offset:58880
    s_waitcnt lgkmcnt(4)
    v_mfma_f32_16x16x32_bf16 v[140:143], v[196:199], a[188:191], v[140:143]
    buffer_load_dwordx4 v[24:27], v232, s[16:19], s78 offen offset:1024 sc1
    v_mfma_f32_16x16x32_bf16 v[140:143], v[192:195], a[180:183], v[140:143]
    v_mfma_f32_16x16x32_bf16 v[144:147], v[176:179], a[48:51], v[144:147]
    ds_read_b64_tr_b16 v[192:193], v252 offset:0
    v_mfma_f32_16x16x32_bf16 v[144:147], v[180:183], a[56:59], v[144:147]
    ds_read_b64_tr_b16 v[194:195], v252 offset:512
    v_mfma_f32_16x16x32_bf16 v[148:151], v[180:183], a[60:63], v[148:151]
    buffer_load_dwordx4 v[28:31], v233, s[16:19], s78 offen offset:1024 sc1
    v_mfma_f32_16x16x32_bf16 v[148:151], v[176:179], a[52:55], v[148:151]
    v_mfma_f32_16x16x32_bf16 v[152:155], v[176:179], a[176:179], v[152:155]
    ds_read_b64_tr_b16 v[196:197], v252 offset:8192
    v_mfma_f32_16x16x32_bf16 v[152:155], v[180:183], a[184:187], v[152:155]
    ds_read_b64_tr_b16 v[198:199], v252 offset:8704
    s_waitcnt lgkmcnt(4)
    v_mfma_f32_16x16x32_bf16 v[156:159], v[180:183], a[188:191], v[156:159]
    buffer_load_dwordx4 v[40:43], v234, s[16:19], s78 offen offset:1024 sc1
    v_mfma_f32_16x16x32_bf16 v[156:159], v[176:179], a[180:183], v[156:159]
    v_mfma_f32_16x16x32_bf16 v[160:163], v[184:187], a[48:51], v[160:163]
    ds_read_b64_tr_b16 v[176:177], v253 offset:0
    v_mfma_f32_16x16x32_bf16 v[160:163], v[188:191], a[56:59], v[160:163]
    ds_read_b64_tr_b16 v[178:179], v253 offset:512
    v_mfma_f32_16x16x32_bf16 v[164:167], v[188:191], a[60:63], v[164:167]
    v_mfma_f32_16x16x32_bf16 v[164:167], v[184:187], a[52:55], v[164:167]
    buffer_load_dwordx4 v[44:47], v235, s[16:19], s78 offen offset:1024 sc1
    v_mfma_f32_16x16x32_bf16 v[168:171], v[184:187], a[176:179], v[168:171]
    ds_read_b64_tr_b16 v[180:181], v253 offset:8192
    s_waitcnt vmcnt(32)
    v_mfma_f32_16x16x32_bf16 v[168:171], v[188:191], a[184:187], v[168:171]
    ds_read_b64_tr_b16 v[182:183], v253 offset:8704
    s_waitcnt lgkmcnt(4)
    v_mfma_f32_16x16x32_bf16 v[172:175], v[188:191], a[188:191], v[172:175]
    v_mfma_f32_16x16x32_bf16 v[172:175], v[184:187], a[180:183], v[172:175]
    v_mfma_f32_16x16x32_bf16 v[48:51], v[192:195], a[64:67], v[48:51]
    ds_read_b64_tr_b16 v[184:185], v236 offset:0
    v_mfma_f32_16x16x32_bf16 v[48:51], v[196:199], a[72:75], v[48:51]
    ds_read_b64_tr_b16 v[186:187], v236 offset:512
    v_mfma_f32_16x16x32_bf16 v[52:55], v[196:199], a[76:79], v[52:55]
    s_mov_b64 exec, 0x3ffff
    buffer_load_dword v0, v239, s[12:15], s5 offen offset:0
    s_mov_b64 exec, -1
    v_mfma_f32_16x16x32_bf16 v[52:55], v[192:195], a[68:71], v[52:55]
    v_mfma_f32_16x16x32_bf16 v[56:59], v[192:195], a[192:195], v[56:59]
    ds_read_b64_tr_b16 v[188:189], v236 offset:8192
    v_mfma_f32_16x16x32_bf16 v[56:59], v[196:199], a[200:203], v[56:59]
    ds_read_b64_tr_b16 v[190:191], v236 offset:8704
    s_waitcnt lgkmcnt(4)
    v_mfma_f32_16x16x32_bf16 v[60:63], v[196:199], a[204:207], v[60:63]
    v_mfma_f32_16x16x32_bf16 v[60:63], v[192:195], a[196:199], v[60:63]
    v_mfma_f32_16x16x32_bf16 v[64:67], v[176:179], a[64:67], v[64:67]
    ds_read_b64_tr_b16 v[192:193], v237 offset:0
    v_mfma_f32_16x16x32_bf16 v[64:67], v[180:183], a[72:75], v[64:67]
    ds_read_b64_tr_b16 v[194:195], v237 offset:512
    v_mfma_f32_16x16x32_bf16 v[68:71], v[180:183], a[76:79], v[68:71]
    s_mov_b64 exec, 0xffff
    buffer_load_dword v0, v254, s[24:27], s89 offen
    buffer_load_dword v0, v254, s[28:31], s89 offen
    s_mov_b64 exec, -1
    v_mfma_f32_16x16x32_bf16 v[68:71], v[176:179], a[68:71], v[68:71]
    v_mfma_f32_16x16x32_bf16 v[72:75], v[176:179], a[192:195], v[72:75]
    ds_read_b64_tr_b16 v[196:197], v237 offset:8192
    v_mfma_f32_16x16x32_bf16 v[72:75], v[180:183], a[200:203], v[72:75]
    ds_read_b64_tr_b16 v[198:199], v237 offset:8704
    s_waitcnt lgkmcnt(4)
    v_mfma_f32_16x16x32_bf16 v[76:79], v[180:183], a[204:207], v[76:79]
    v_mfma_f32_16x16x32_bf16 v[76:79], v[176:179], a[196:199], v[76:79]
    v_mfma_f32_16x16x32_bf16 v[80:83], v[184:187], a[64:67], v[80:83]
    ds_read_b64_tr_b16 v[176:177], v252 offset:1024
    v_mfma_f32_16x16x32_bf16 v[80:83], v[188:191], a[72:75], v[80:83]
    ds_read_b64_tr_b16 v[178:179], v252 offset:1536
    v_mfma_f32_16x16x32_bf16 v[84:87], v[188:191], a[76:79], v[84:87]
    v_mfma_f32_16x16x32_bf16 v[84:87], v[184:187], a[68:71], v[84:87]
    v_mfma_f32_16x16x32_bf16 v[88:91], v[184:187], a[192:195], v[88:91]
    ds_read_b64_tr_b16 v[180:181], v252 offset:9216
    v_mfma_f32_16x16x32_bf16 v[88:91], v[188:191], a[200:203], v[88:91]
    ds_read_b64_tr_b16 v[182:183], v252 offset:9728
    s_waitcnt lgkmcnt(4)
    v_mfma_f32_16x16x32_bf16 v[92:95], v[188:191], a[204:207], v[92:95]
    v_mfma_f32_16x16x32_bf16 v[92:95], v[184:187], a[196:199], v[92:95]
    v_mfma_f32_16x16x32_bf16 v[96:99], v[192:195], a[64:67], v[96:99]
    ds_read_b64_tr_b16 v[184:185], v253 offset:1024
    v_mfma_f32_16x16x32_bf16 v[96:99], v[196:199], a[72:75], v[96:99]
    ds_read_b64_tr_b16 v[186:187], v253 offset:1536
    v_mfma_f32_16x16x32_bf16 v[100:103], v[196:199], a[76:79], v[100:103]
    v_mfma_f32_16x16x32_bf16 v[100:103], v[192:195], a[68:71], v[100:103]
    v_mfma_f32_16x16x32_bf16 v[104:107], v[192:195], a[192:195], v[104:107]
    ds_read_b64_tr_b16 v[188:189], v253 offset:9216
    v_mfma_f32_16x16x32_bf16 v[104:107], v[196:199], a[200:203], v[104:107]
    ds_read_b64_tr_b16 v[190:191], v253 offset:9728
    s_waitcnt lgkmcnt(4)
    v_mfma_f32_16x16x32_bf16 v[108:111], v[196:199], a[204:207], v[108:111]
    v_mfma_f32_16x16x32_bf16 v[108:111], v[192:195], a[196:199], v[108:111]
    v_mfma_f32_16x16x32_bf16 v[112:115], v[176:179], a[64:67], v[112:115]
    ds_read_b64_tr_b16 v[192:193], v236 offset:1024
    v_add_u32 v248, 0x20000, v248
    v_mfma_f32_16x16x32_bf16 v[112:115], v[180:183], a[72:75], v[112:115]
    ds_read_b64_tr_b16 v[194:195], v236 offset:1536
    v_mfma_f32_16x16x32_bf16 v[116:119], v[180:183], a[76:79], v[116:119]
    v_mfma_f32_16x16x32_bf16 v[116:119], v[176:179], a[68:71], v[116:119]
    v_mfma_f32_16x16x32_bf16 v[120:123], v[176:179], a[192:195], v[120:123]
    ds_read_b64_tr_b16 v[196:197], v236 offset:9216
    v_mfma_f32_16x16x32_bf16 v[120:123], v[180:183], a[200:203], v[120:123]
    ds_read_b64_tr_b16 v[198:199], v236 offset:9728
    s_waitcnt lgkmcnt(4)
    v_mfma_f32_16x16x32_bf16 v[124:127], v[180:183], a[204:207], v[124:127]
    v_mfma_f32_16x16x32_bf16 v[124:127], v[176:179], a[196:199], v[124:127]
    v_mfma_f32_16x16x32_bf16 v[128:131], v[184:187], a[64:67], v[128:131]
    ds_read_b64_tr_b16 v[176:177], v237 offset:1024
    v_mfma_f32_16x16x32_bf16 v[128:131], v[188:191], a[72:75], v[128:131]
    ds_read_b64_tr_b16 v[178:179], v237 offset:1536
    v_mfma_f32_16x16x32_bf16 v[132:135], v[188:191], a[76:79], v[132:135]
    v_mfma_f32_16x16x32_bf16 v[132:135], v[184:187], a[68:71], v[132:135]
    v_mfma_f32_16x16x32_bf16 v[136:139], v[184:187], a[192:195], v[136:139]
    ds_read_b64_tr_b16 v[180:181], v237 offset:9216
    v_mfma_f32_16x16x32_bf16 v[136:139], v[188:191], a[200:203], v[136:139]
    ds_read_b64_tr_b16 v[182:183], v237 offset:9728
    s_waitcnt lgkmcnt(4)
    v_mfma_f32_16x16x32_bf16 v[140:143], v[188:191], a[204:207], v[140:143]
    v_mfma_f32_16x16x32_bf16 v[140:143], v[184:187], a[196:199], v[140:143]
    v_mfma_f32_16x16x32_bf16 v[144:147], v[192:195], a[64:67], v[144:147]
    ds_read_b64_tr_b16 v[184:185], v252 offset:16384
    v_mfma_f32_16x16x32_bf16 v[144:147], v[196:199], a[72:75], v[144:147]
    ds_read_b64_tr_b16 v[186:187], v252 offset:16896
    v_mfma_f32_16x16x32_bf16 v[148:151], v[196:199], a[76:79], v[148:151]
    v_mfma_f32_16x16x32_bf16 v[148:151], v[192:195], a[68:71], v[148:151]
    v_mfma_f32_16x16x32_bf16 v[152:155], v[192:195], a[192:195], v[152:155]
    ds_read_b64_tr_b16 v[188:189], v252 offset:24576
    v_mfma_f32_16x16x32_bf16 v[152:155], v[196:199], a[200:203], v[152:155]
    ds_read_b64_tr_b16 v[190:191], v252 offset:25088
    s_waitcnt lgkmcnt(4)
    v_mfma_f32_16x16x32_bf16 v[156:159], v[196:199], a[204:207], v[156:159]
    v_mfma_f32_16x16x32_bf16 v[156:159], v[192:195], a[196:199], v[156:159]
    v_mfma_f32_16x16x32_bf16 v[160:163], v[176:179], a[64:67], v[160:163]
    ds_read_b64_tr_b16 v[192:193], v253 offset:16384
    v_add_u32 v249, 0x20000, v249
    v_mfma_f32_16x16x32_bf16 v[160:163], v[180:183], a[72:75], v[160:163]
    ds_read_b64_tr_b16 v[194:195], v253 offset:16896
    v_mfma_f32_16x16x32_bf16 v[164:167], v[180:183], a[76:79], v[164:167]
    v_mfma_f32_16x16x32_bf16 v[164:167], v[176:179], a[68:71], v[164:167]
    v_mfma_f32_16x16x32_bf16 v[168:171], v[176:179], a[192:195], v[168:171]
    ds_read_b64_tr_b16 v[196:197], v253 offset:24576
    s_waitcnt vmcnt(27)
    v_mfma_f32_16x16x32_bf16 v[168:171], v[180:183], a[200:203], v[168:171]
    ds_read_b64_tr_b16 v[198:199], v253 offset:25088
    s_waitcnt lgkmcnt(4)
    v_mfma_f32_16x16x32_bf16 v[172:175], v[180:183], a[204:207], v[172:175]
    v_mfma_f32_16x16x32_bf16 v[172:175], v[176:179], a[196:199], v[172:175]
    v_mfma_f32_16x16x32_bf16 v[48:51], v[184:187], a[80:83], v[48:51]
    ds_read_b64_tr_b16 v[176:177], v236 offset:16384
    v_lshrrev_b32 v9, 4, v1
    v_mfma_f32_16x16x32_bf16 v[48:51], v[188:191], a[88:91], v[48:51]
    ds_read_b64_tr_b16 v[178:179], v236 offset:16896
    v_mfma_f32_16x16x32_bf16 v[52:55], v[188:191], a[92:95], v[52:55]
    s_barrier
    v_mfma_f32_16x16x32_bf16 v[52:55], v[184:187], a[84:87], v[52:55]
    v_mfma_f32_16x16x32_bf16 v[56:59], v[184:187], a[208:211], v[56:59]
    ds_read_b64_tr_b16 v[180:181], v236 offset:24576
    v_mfma_f32_16x16x32_bf16 v[56:59], v[188:191], a[216:219], v[56:59]
    ds_read_b64_tr_b16 v[182:183], v236 offset:25088
    s_waitcnt lgkmcnt(4)
    v_mfma_f32_16x16x32_bf16 v[60:63], v[188:191], a[220:223], v[60:63]
    v_mfma_f32_16x16x32_bf16 v[60:63], v[184:187], a[212:215], v[60:63]
    v_and_b32 v8, 15, v9
    v_mfma_f32_16x16x32_bf16 v[64:67], v[192:195], a[80:83], v[64:67]
    ds_read_b64_tr_b16 v[184:185], v237 offset:16384
    v_mfma_f32_16x16x32_bf16 v[64:67], v[196:199], a[88:91], v[64:67]
    ds_read_b64_tr_b16 v[186:187], v237 offset:16896
    v_mfma_f32_16x16x32_bf16 v[68:71], v[196:199], a[92:95], v[68:71]
    v_mfma_f32_16x16x32_bf16 v[68:71], v[192:195], a[84:87], v[68:71]
    v_mfma_f32_16x16x32_bf16 v[72:75], v[192:195], a[208:211], v[72:75]
    ds_read_b64_tr_b16 v[188:189], v237 offset:24576
    v_mfma_f32_16x16x32_bf16 v[72:75], v[196:199], a[216:219], v[72:75]
    ds_read_b64_tr_b16 v[190:191], v237 offset:25088
    s_waitcnt lgkmcnt(4)
    v_mfma_f32_16x16x32_bf16 v[76:79], v[196:199], a[220:223], v[76:79]
    v_lshrrev_b32 v9, 4, v9
    v_mfma_f32_16x16x32_bf16 v[76:79], v[192:195], a[212:215], v[76:79]
    v_mfma_f32_16x16x32_bf16 v[80:83], v[176:179], a[80:83], v[80:83]
    ds_read_b64_tr_b16 v[192:193], v252 offset:17408
    v_add_u32 v250, 0x20000, v250
    v_mfma_f32_16x16x32_bf16 v[80:83], v[180:183], a[88:91], v[80:83]
    ds_read_b64_tr_b16 v[194:195], v252 offset:17920
    v_mfma_f32_16x16x32_bf16 v[84:87], v[180:183], a[92:95], v[84:87]
    v_mfma_f32_16x16x32_bf16 v[84:87], v[176:179], a[84:87], v[84:87]
    v_mfma_f32_16x16x32_bf16 v[88:91], v[176:179], a[208:211], v[88:91]
    ds_read_b64_tr_b16 v[196:197], v252 offset:25600
    v_mfma_f32_16x16x32_bf16 v[88:91], v[180:183], a[216:219], v[88:91]
    ds_read_b64_tr_b16 v[198:199], v252 offset:26112
    s_waitcnt lgkmcnt(4)
    v_mfma_f32_16x16x32_bf16 v[92:95], v[180:183], a[220:223], v[92:95]
    v_lshlrev_b32 v9, 3, v9
    v_mfma_f32_16x16x32_bf16 v[92:95], v[176:179], a[212:215], v[92:95]
    v_mfma_f32_16x16x32_bf16 v[96:99], v[184:187], a[80:83], v[96:99]
    ds_read_b64_tr_b16 v[176:177], v253 offset:17408
    v_mfma_f32_16x16x32_bf16 v[96:99], v[188:191], a[88:91], v[96:99]
    ds_read_b64_tr_b16 v[178:179], v253 offset:17920
    v_mfma_f32_16x16x32_bf16 v[100:103], v[188:191], a[92:95], v[100:103]
    v_mfma_f32_16x16x32_bf16 v[100:103], v[184:187], a[84:87], v[100:103]
    v_mfma_f32_16x16x32_bf16 v[104:107], v[184:187], a[208:211], v[104:107]
    ds_read_b64_tr_b16 v[180:181], v253 offset:25600
    v_sub_u32 v9, v8, v9
    v_mfma_f32_16x16x32_bf16 v[104:107], v[188:191], a[216:219], v[104:107]
    ds_read_b64_tr_b16 v[182:183], v253 offset:26112
    s_waitcnt lgkmcnt(4)
    v_mfma_f32_16x16x32_bf16 v[108:111], v[188:191], a[220:223], v[108:111]
    v_mfma_f32_16x16x32_bf16 v[108:111], v[184:187], a[212:215], v[108:111]
    v_mfma_f32_16x16x32_bf16 v[112:115], v[192:195], a[80:83], v[112:115]
    ds_read_b64_tr_b16 v[184:185], v236 offset:17408
    v_mfma_f32_16x16x32_bf16 v[112:115], v[196:199], a[88:91], v[112:115]
    ds_read_b64_tr_b16 v[186:187], v236 offset:17920
    v_mfma_f32_16x16x32_bf16 v[116:119], v[196:199], a[92:95], v[116:119]
    v_mfma_f32_16x16x32_bf16 v[116:119], v[192:195], a[84:87], v[116:119]
    v_and_b32 v8, 1, v9
    v_mfma_f32_16x16x32_bf16 v[120:123], v[192:195], a[208:211], v[120:123]
    ds_read_b64_tr_b16 v[188:189], v236 offset:25600
    v_mfma_f32_16x16x32_bf16 v[120:123], v[196:199], a[216:219], v[120:123]
    ds_read_b64_tr_b16 v[190:191], v236 offset:26112
    s_waitcnt lgkmcnt(4)
    v_mfma_f32_16x16x32_bf16 v[124:127], v[196:199], a[220:223], v[124:127]
    v_mfma_f32_16x16x32_bf16 v[124:127], v[192:195], a[212:215], v[124:127]
    v_mfma_f32_16x16x32_bf16 v[128:131], v[176:179], a[80:83], v[128:131]
    ds_read_b64_tr_b16 v[192:193], v237 offset:17408
    v_add_u32 v251, 0x20000, v251
    v_mfma_f32_16x16x32_bf16 v[128:131], v[180:183], a[88:91], v[128:131]
    ds_read_b64_tr_b16 v[194:195], v237 offset:17920
    v_mfma_f32_16x16x32_bf16 v[132:135], v[180:183], a[92:95], v[132:135]
    v_lshlrev_b32 v8, 4, v8
    v_mfma_f32_16x16x32_bf16 v[132:135], v[176:179], a[84:87], v[132:135]
    v_mfma_f32_16x16x32_bf16 v[136:139], v[176:179], a[208:211], v[136:139]
    ds_read_b64_tr_b16 v[196:197], v237 offset:25600
    v_mfma_f32_16x16x32_bf16 v[136:139], v[180:183], a[216:219], v[136:139]
    ds_read_b64_tr_b16 v[198:199], v237 offset:26112
    s_waitcnt lgkmcnt(4)
    v_mfma_f32_16x16x32_bf16 v[140:143], v[180:183], a[220:223], v[140:143]
    v_mfma_f32_16x16x32_bf16 v[140:143], v[176:179], a[212:215], v[140:143]
    v_mfma_f32_16x16x32_bf16 v[144:147], v[184:187], a[80:83], v[144:147]
    ds_read_b64_tr_b16 v[176:177], v252 offset:32768
    v_mfma_f32_16x16x32_bf16 v[144:147], v[188:191], a[88:91], v[144:147]
    ds_read_b64_tr_b16 v[178:179], v252 offset:33280
    v_mov_b32 v240, 0x3f80
    v_mfma_f32_16x16x32_bf16 v[148:151], v[188:191], a[92:95], v[148:151]
    v_mfma_f32_16x16x32_bf16 v[148:151], v[184:187], a[84:87], v[148:151]
    v_mfma_f32_16x16x32_bf16 v[152:155], v[184:187], a[208:211], v[152:155]
    ds_read_b64_tr_b16 v[180:181], v252 offset:40960
    v_mfma_f32_16x16x32_bf16 v[152:155], v[188:191], a[216:219], v[152:155]
    ds_read_b64_tr_b16 v[182:183], v252 offset:41472
    s_waitcnt lgkmcnt(4)
    v_mfma_f32_16x16x32_bf16 v[156:159], v[188:191], a[220:223], v[156:159]
    v_mfma_f32_16x16x32_bf16 v[156:159], v[184:187], a[212:215], v[156:159]
    v_mfma_f32_16x16x32_bf16 v[160:163], v[192:195], a[80:83], v[160:163]
    ds_read_b64_tr_b16 v[184:185], v253 offset:32768
    v_lshlrev_b32 v8, v8, v240
    v_mfma_f32_16x16x32_bf16 v[160:163], v[196:199], a[88:91], v[160:163]
    ds_read_b64_tr_b16 v[186:187], v253 offset:33280
    v_mfma_f32_16x16x32_bf16 v[164:167], v[196:199], a[92:95], v[164:167]
    v_mfma_f32_16x16x32_bf16 v[164:167], v[192:195], a[84:87], v[164:167]
    v_mfma_f32_16x16x32_bf16 v[168:171], v[192:195], a[208:211], v[168:171]
    ds_read_b64_tr_b16 v[188:189], v253 offset:40960
    s_waitcnt vmcnt(19)
    v_mfma_f32_16x16x32_bf16 v[168:171], v[196:199], a[216:219], v[168:171]
    ds_read_b64_tr_b16 v[190:191], v253 offset:41472
    s_waitcnt lgkmcnt(4)
    v_mfma_f32_16x16x32_bf16 v[172:175], v[196:199], a[220:223], v[172:175]
    v_mfma_f32_16x16x32_bf16 v[172:175], v[192:195], a[212:215], v[172:175]
    v_mfma_f32_16x16x32_bf16 v[48:51], v[176:179], a[96:99], v[48:51]
    ds_read_b64_tr_b16 v[192:193], v236 offset:32768
    buffer_load_dwordx4 v[208:211], v255, s[28:31], s87 offen
    v_mfma_f32_16x16x32_bf16 v[48:51], v[180:183], a[104:107], v[48:51]
    ds_read_b64_tr_b16 v[194:195], v236 offset:33280
    v_ashrrev_i32 v9, 1, v9
    v_mfma_f32_16x16x32_bf16 v[52:55], v[180:183], a[108:111], v[52:55]
    s_add_u32 m0, s67, 0
    s_add_u32 s68, s79, 0
    v_mfma_f32_16x16x32_bf16 v[52:55], v[176:179], a[100:103], v[52:55]
    buffer_load_dwordx4 v2, s[12:15], s68 offen lds
    v_mfma_f32_16x16x32_bf16 v[56:59], v[176:179], a[224:227], v[56:59]
    ds_read_b64_tr_b16 v[196:197], v236 offset:40960
    v_mfma_f32_16x16x32_bf16 v[56:59], v[180:183], a[232:235], v[56:59]
    ds_read_b64_tr_b16 v[198:199], v236 offset:41472
    s_waitcnt lgkmcnt(4)
    v_mfma_f32_16x16x32_bf16 v[60:63], v[180:183], a[236:239], v[60:63]
    buffer_load_dwordx4 v[212:215], v255, s[28:31], s88 offen
    v_mfma_f32_16x16x32_bf16 v[60:63], v[176:179], a[228:231], v[60:63]
    s_add_u32 m0, s67, 4096
    s_add_u32 s68, s79, 294912
    v_cmp_eq_i32 vcc, 0, v9
    s_nop 1
    v_cndmask_b32 v240, 0, v8, vcc
    v_mfma_f32_16x16x32_bf16 v[64:67], v[184:187], a[96:99], v[64:67]
    ds_read_b64_tr_b16 v[176:177], v237 offset:32768
    v_mfma_f32_16x16x32_bf16 v[64:67], v[188:191], a[104:107], v[64:67]
    ds_read_b64_tr_b16 v[178:179], v237 offset:33280
    v_mfma_f32_16x16x32_bf16 v[68:71], v[188:191], a[108:111], v[68:71]
    buffer_load_dwordx2 v[200:201], v254, s[24:27], s89 offen offset:0
    v_mfma_f32_16x16x32_bf16 v[68:71], v[184:187], a[100:103], v[68:71]
    buffer_load_dwordx4 v2, s[12:15], s68 offen lds
    v_mfma_f32_16x16x32_bf16 v[72:75], v[184:187], a[224:227], v[72:75]
    ds_read_b64_tr_b16 v[180:181], v237 offset:40960
    v_mfma_f32_16x16x32_bf16 v[72:75], v[188:191], a[232:235], v[72:75]
    ds_read_b64_tr_b16 v[182:183], v237 offset:41472
    s_waitcnt lgkmcnt(4)
    v_mfma_f32_16x16x32_bf16 v[76:79], v[188:191], a[236:239], v[76:79]
    s_add_u32 m0, s67, 8192
    s_add_u32 s68, s79, 589824
    v_mfma_f32_16x16x32_bf16 v[76:79], v[184:187], a[228:231], v[76:79]
    buffer_load_dwordx2 v[202:203], v254, s[24:27], s89 offen offset:32
    v_mfma_f32_16x16x32_bf16 v[80:83], v[192:195], a[96:99], v[80:83]
    ds_read_b64_tr_b16 v[184:185], v252 offset:33792
    v_mfma_f32_16x16x32_bf16 v[80:83], v[196:199], a[104:107], v[80:83]
    ds_read_b64_tr_b16 v[186:187], v252 offset:34304
    v_mfma_f32_16x16x32_bf16 v[84:87], v[196:199], a[108:111], v[84:87]
    buffer_load_dwordx4 v2, s[12:15], s68 offen lds
    v_mfma_f32_16x16x32_bf16 v[84:87], v[192:195], a[100:103], v[84:87]
    v_cmp_eq_i32 vcc, 1, v9
    s_nop 1
    v_cndmask_b32 v241, 0, v8, vcc
    v_mfma_f32_16x16x32_bf16 v[88:91], v[192:195], a[224:227], v[88:91]
    ds_read_b64_tr_b16 v[188:189], v252 offset:41984
    v_mfma_f32_16x16x32_bf16 v[88:91], v[196:199], a[232:235], v[88:91]
    ds_read_b64_tr_b16 v[190:191], v252 offset:42496
    s_waitcnt lgkmcnt(4)
    v_mfma_f32_16x16x32_bf16 v[92:95], v[196:199], a[236:239], v[92:95]
    s_add_u32 m0, s67, 12288
    s_add_u32 s68, s79, 884736
    v_cmp_eq_i32 vcc, 2, v9
    s_nop 1
    v_cndmask_b32 v242, 0, v8, vcc
    v_mfma_f32_16x16x32_bf16 v[92:95], v[192:195], a[228:231], v[92:95]
    buffer_load_dwordx2 v[204:205], v254, s[24:27], s89 offen offset:64
    v_mfma_f32_16x16x32_bf16 v[96:99], v[176:179], a[96:99], v[96:99]
    ds_read_b64_tr_b16 v[192:193], v253 offset:33792
    v_mfma_f32_16x16x32_bf16 v[96:99], v[180:183], a[104:107], v[96:99]
    ds_read_b64_tr_b16 v[194:195], v253 offset:34304
    v_mfma_f32_16x16x32_bf16 v[100:103], v[180:183], a[108:111], v[100:103]
    buffer_load_dwordx4 v2, s[12:15], s68 offen lds
    v_mfma_f32_16x16x32_bf16 v[100:103], v[176:179], a[100:103], v[100:103]
    buffer_load_dwordx2 v[206:207], v254, s[24:27], s89 offen offset:96
    v_mfma_f32_16x16x32_bf16 v[104:107], v[176:179], a[224:227], v[104:107]
    ds_read_b64_tr_b16 v[196:197], v253 offset:41984
    v_mfma_f32_16x16x32_bf16 v[104:107], v[180:183], a[232:235], v[104:107]
    ds_read_b64_tr_b16 v[198:199], v253 offset:42496
    s_waitcnt lgkmcnt(4)
    v_mfma_f32_16x16x32_bf16 v[108:111], v[180:183], a[236:239], v[108:111]
    s_add_u32 m0, s67, 16384
    s_add_u32 s68, s79, 1179648
    v_mfma_f32_16x16x32_bf16 v[108:111], v[176:179], a[228:231], v[108:111]
    v_cmp_eq_i32 vcc, 3, v9
    s_nop 1
    v_cndmask_b32 v243, 0, v8, vcc
    v_mfma_f32_16x16x32_bf16 v[112:115], v[184:187], a[96:99], v[112:115]
    ds_read_b64_tr_b16 v[176:177], v236 offset:33792
    v_mfma_f32_16x16x32_bf16 v[112:115], v[188:191], a[104:107], v[112:115]
    ds_read_b64_tr_b16 v[178:179], v236 offset:34304
    v_mfma_f32_16x16x32_bf16 v[116:119], v[188:191], a[108:111], v[116:119]
    buffer_load_dwordx4 v2, s[12:15], s68 offen lds
    v_mfma_f32_16x16x32_bf16 v[116:119], v[184:187], a[100:103], v[116:119]
    v_cmp_eq_i32 vcc, -8, v9
    s_nop 1
    v_cndmask_b32 v244, 0, v8, vcc
    v_mfma_f32_16x16x32_bf16 v[120:123], v[184:187], a[224:227], v[120:123]
    ds_read_b64_tr_b16 v[180:181], v236 offset:41984
    v_mfma_f32_16x16x32_bf16 v[120:123], v[188:191], a[232:235], v[120:123]
    ds_read_b64_tr_b16 v[182:183], v236 offset:42496
    s_waitcnt lgkmcnt(4)
    v_mfma_f32_16x16x32_bf16 v[124:127], v[188:191], a[236:239], v[124:127]
    s_add_u32 m0, s67, 20480
    s_add_u32 s68, s79, 1474560
    v_mfma_f32_16x16x32_bf16 v[124:127], v[184:187], a[228:231], v[124:127]
    v_mfma_f32_16x16x32_bf16 v[128:131], v[192:195], a[96:99], v[128:131]
    ds_read_b64_tr_b16 v[184:185], v237 offset:33792
    v_mfma_f32_16x16x32_bf16 v[128:131], v[196:199], a[104:107], v[128:131]
    ds_read_b64_tr_b16 v[186:187], v237 offset:34304
    v_mfma_f32_16x16x32_bf16 v[132:135], v[196:199], a[108:111], v[132:135]
    buffer_load_dwordx4 v2, s[12:15], s68 offen lds
    v_mfma_f32_16x16x32_bf16 v[132:135], v[192:195], a[100:103], v[132:135]
    v_cmp_eq_i32 vcc, -7, v9
    s_nop 1
    v_cndmask_b32 v245, 0, v8, vcc
    v_mfma_f32_16x16x32_bf16 v[136:139], v[192:195], a[224:227], v[136:139]
    ds_read_b64_tr_b16 v[188:189], v237 offset:41984
    v_mfma_f32_16x16x32_bf16 v[136:139], v[196:199], a[232:235], v[136:139]
    ds_read_b64_tr_b16 v[190:191], v237 offset:42496
    s_waitcnt lgkmcnt(4)
    v_mfma_f32_16x16x32_bf16 v[140:143], v[196:199], a[236:239], v[140:143]
    s_add_u32 m0, s67, 24576
    s_add_u32 s68, s79, 1769472
    v_mfma_f32_16x16x32_bf16 v[140:143], v[192:195], a[228:231], v[140:143]
    buffer_load_dwordx4 v2, s[12:15], s68 offen lds
    v_mfma_f32_16x16x32_bf16 v[144:147], v[176:179], a[96:99], v[144:147]
    ds_read_b64_tr_b16 v[192:193], v252 offset:49152
    v_mfma_f32_16x16x32_bf16 v[144:147], v[180:183], a[104:107], v[144:147]
    ds_read_b64_tr_b16 v[194:195], v252 offset:49664
    v_mfma_f32_16x16x32_bf16 v[148:151], v[180:183], a[108:111], v[148:151]
    v_cmp_eq_i32 vcc, -6, v9
    s_nop 1
    v_cndmask_b32 v246, 0, v8, vcc
    v_mfma_f32_16x16x32_bf16 v[148:151], v[176:179], a[100:103], v[148:151]
    s_add_u32 m0, s67, 28672
    s_add_u32 s68, s79, 2064384
    v_mfma_f32_16x16x32_bf16 v[152:155], v[176:179], a[224:227], v[152:155]
    ds_read_b64_tr_b16 v[196:197], v252 offset:57344
    v_mfma_f32_16x16x32_bf16 v[152:155], v[180:183], a[232:235], v[152:155]
    ds_read_b64_tr_b16 v[198:199], v252 offset:57856
    s_waitcnt lgkmcnt(4)
    v_mfma_f32_16x16x32_bf16 v[156:159], v[180:183], a[236:239], v[156:159]
    v_mfma_f32_16x16x32_bf16 v[156:159], v[176:179], a[228:231], v[156:159]
    buffer_load_dwordx4 v2, s[12:15], s68 offen lds
    v_mfma_f32_16x16x32_bf16 v[160:163], v[184:187], a[96:99], v[160:163]
    ds_read_b64_tr_b16 v[176:177], v253 offset:49152
    v_mfma_f32_16x16x32_bf16 v[160:163], v[188:191], a[104:107], v[160:163]
    ds_read_b64_tr_b16 v[178:179], v253 offset:49664
    v_mfma_f32_16x16x32_bf16 v[164:167], v[188:191], a[108:111], v[164:167]
    s_add_u32 m0, s67, 32768
    s_add_u32 s68, s79, 2359296
    v_mfma_f32_16x16x32_bf16 v[164:167], v[184:187], a[100:103], v[164:167]
    v_cmp_eq_i32 vcc, -5, v9
    s_nop 1
    v_cndmask_b32 v247, 0, v8, vcc
    v_mfma_f32_16x16x32_bf16 v[168:171], v[184:187], a[224:227], v[168:171]
    ds_read_b64_tr_b16 v[180:181], v253 offset:57344
    s_waitcnt vmcnt(25)
    v_mfma_f32_16x16x32_bf16 v[168:171], v[188:191], a[232:235], v[168:171]
    ds_read_b64_tr_b16 v[182:183], v253 offset:57856
    s_waitcnt lgkmcnt(4)
    v_mfma_f32_16x16x32_bf16 v[172:175], v[188:191], a[236:239], v[172:175]
    buffer_load_dwordx4 v2, s[12:15], s68 offen lds
    v_mfma_f32_16x16x32_bf16 v[172:175], v[184:187], a[228:231], v[172:175]
    v_mfma_f32_16x16x32_bf16 v[48:51], v[192:195], a[112:115], v[48:51]
    ds_read_b64_tr_b16 v[184:185], v236 offset:49152
    v_mfma_f32_16x16x32_bf16 v[48:51], v[196:199], a[120:123], v[48:51]
    ds_read_b64_tr_b16 v[186:187], v236 offset:49664
    v_mfma_f32_16x16x32_bf16 v[52:55], v[196:199], a[124:127], v[52:55]
    s_add_u32 m0, s67, 36864
    s_add_u32 s68, s79, 2654208
    v_mfma_f32_16x16x32_bf16 v[52:55], v[192:195], a[116:119], v[52:55]
    v_mfma_f32_16x16x32_bf16 v[56:59], v[192:195], a[240:243], v[56:59]
    ds_read_b64_tr_b16 v[188:189], v236 offset:57344
    v_mfma_f32_16x16x32_bf16 v[56:59], v[196:199], a[248:251], v[56:59]
    ds_read_b64_tr_b16 v[190:191], v236 offset:57856
    s_waitcnt lgkmcnt(4)
    v_mfma_f32_16x16x32_bf16 v[60:63], v[196:199], a[252:255], v[60:63]
    buffer_load_dwordx4 v2, s[12:15], s68 offen lds
    v_mfma_f32_16x16x32_bf16 v[60:63], v[192:195], a[244:247], v[60:63]
    v_mfma_f32_16x16x32_bf16 v[64:67], v[176:179], a[112:115], v[64:67]
    ds_read_b64_tr_b16 v[192:193], v237 offset:49152
    v_mfma_f32_16x16x32_bf16 v[64:67], v[180:183], a[120:123], v[64:67]
    ds_read_b64_tr_b16 v[194:195], v237 offset:49664
    v_mfma_f32_16x16x32_bf16 v[68:71], v[180:183], a[124:127], v[68:71]
    s_add_u32 m0, s67, 40960
    s_add_u32 s68, s79, 2949120
    v_mfma_f32_16x16x32_bf16 v[68:71], v[176:179], a[116:119], v[68:71]
    v_mfma_f32_16x16x32_bf16 v[72:75], v[176:179], a[240:243], v[72:75]
    ds_read_b64_tr_b16 v[196:197], v237 offset:57344
    v_mfma_f32_16x16x32_bf16 v[72:75], v[180:183], a[248:251], v[72:75]
    ds_read_b64_tr_b16 v[198:199], v237 offset:57856
    s_waitcnt lgkmcnt(4)
    v_mfma_f32_16x16x32_bf16 v[76:79], v[180:183], a[252:255], v[76:79]
    buffer_load_dwordx4 v2, s[12:15], s68 offen lds
    v_mfma_f32_16x16x32_bf16 v[76:79], v[176:179], a[244:247], v[76:79]
    v_mfma_f32_16x16x32_bf16 v[80:83], v[184:187], a[112:115], v[80:83]
    ds_read_b64_tr_b16 v[176:177], v252 offset:50176
    v_mfma_f32_16x16x32_bf16 v[80:83], v[188:191], a[120:123], v[80:83]
    ds_read_b64_tr_b16 v[178:179], v252 offset:50688
    v_mfma_f32_16x16x32_bf16 v[84:87], v[188:191], a[124:127], v[84:87]
    s_add_u32 m0, s67, 45056
    s_add_u32 s68, s79, 3244032
    v_mfma_f32_16x16x32_bf16 v[84:87], v[184:187], a[116:119], v[84:87]
    v_mfma_f32_16x16x32_bf16 v[88:91], v[184:187], a[240:243], v[88:91]
    ds_read_b64_tr_b16 v[180:181], v252 offset:58368
    v_mfma_f32_16x16x32_bf16 v[88:91], v[188:191], a[248:251], v[88:91]
    ds_read_b64_tr_b16 v[182:183], v252 offset:58880
    s_waitcnt lgkmcnt(4)
    v_mfma_f32_16x16x32_bf16 v[92:95], v[188:191], a[252:255], v[92:95]
    buffer_load_dwordx4 v2, s[12:15], s68 offen lds
    v_mfma_f32_16x16x32_bf16 v[92:95], v[184:187], a[244:247], v[92:95]
    v_mfma_f32_16x16x32_bf16 v[96:99], v[192:195], a[112:115], v[96:99]
    ds_read_b64_tr_b16 v[184:185], v253 offset:50176
    v_mfma_f32_16x16x32_bf16 v[96:99], v[196:199], a[120:123], v[96:99]
    ds_read_b64_tr_b16 v[186:187], v253 offset:50688
    v_mfma_f32_16x16x32_bf16 v[100:103], v[196:199], a[124:127], v[100:103]
    s_add_u32 m0, s67, 49152
    s_add_u32 s68, s79, 3538944
    v_mfma_f32_16x16x32_bf16 v[100:103], v[192:195], a[116:119], v[100:103]
    buffer_load_dwordx4 v2, s[12:15], s68 offen lds
    v_mfma_f32_16x16x32_bf16 v[104:107], v[192:195], a[240:243], v[104:107]
    ds_read_b64_tr_b16 v[188:189], v253 offset:58368
    v_mfma_f32_16x16x32_bf16 v[104:107], v[196:199], a[248:251], v[104:107]
    ds_read_b64_tr_b16 v[190:191], v253 offset:58880
    s_waitcnt lgkmcnt(4)
    v_mfma_f32_16x16x32_bf16 v[108:111], v[196:199], a[252:255], v[108:111]
    s_waitcnt vmcnt(16)
    v_mfma_f32_16x16x32_bf16 v[108:111], v[192:195], a[244:247], v[108:111]
    s_add_u32 m0, s67, 53248
    s_add_u32 s68, s79, 3833856
    v_mfma_f32_16x16x32_bf16 v[216:219], v[208:211], v[240:243], 0
    v_mfma_f32_16x16x32_bf16 v[220:223], v[212:215], v[240:243], 0
    v_mfma_f32_16x16x32_bf16 v[224:227], v[208:211], v[244:247], 0
    v_mfma_f32_16x16x32_bf16 v[228:231], v[212:215], v[244:247], 0
    buffer_load_dwordx4 v2, s[12:15], s68 offen lds
    v_mfma_f32_16x16x32_bf16 v[112:115], v[176:179], a[112:115], v[112:115]
    ds_read_b64_tr_b16 v[192:193], v236 offset:50176
    v_mfma_f32_16x16x32_bf16 v[112:115], v[180:183], a[120:123], v[112:115]
    ds_read_b64_tr_b16 v[194:195], v236 offset:50688
    v_mfma_f32_16x16x32_bf16 v[116:119], v[180:183], a[124:127], v[116:119]
    s_add_u32 m0, s67, 57344
    s_add_u32 s68, s79, 4128768
    v_mfma_f32_16x16x32_bf16 v[116:119], v[176:179], a[116:119], v[116:119]
    s_waitcnt vmcnt(14)
    buffer_store_dwordx4 v[200:203], v1, s[16:19], s93 offen offset:0 sc1
    v_mfma_f32_16x16x32_bf16 v[120:123], v[176:179], a[240:243], v[120:123]
    ds_read_b64_tr_b16 v[196:197], v236 offset:58368
    s_waitcnt vmcnt(11)
    buffer_store_dwordx4 v[204:207], v1, s[16:19], s93 offen offset:1024 sc1
    v_mfma_f32_16x16x32_bf16 v[120:123], v[180:183], a[248:251], v[120:123]
    ds_read_b64_tr_b16 v[198:199], v236 offset:58880
    s_waitcnt lgkmcnt(4)
    v_mfma_f32_16x16x32_bf16 v[124:127], v[180:183], a[252:255], v[124:127]
    buffer_load_dwordx4 v2, s[12:15], s68 offen lds
    v_mfma_f32_16x16x32_bf16 v[124:127], v[176:179], a[244:247], v[124:127]
    v_cvt_pk_bf16_f32 v208, v216, v217
    v_mfma_f32_16x16x32_bf16 v[128:131], v[184:187], a[112:115], v[128:131]
    ds_read_b64_tr_b16 v[176:177], v237 offset:50176
    v_mfma_f32_16x16x32_bf16 v[128:131], v[188:191], a[120:123], v[128:131]
    ds_read_b64_tr_b16 v[178:179], v237 offset:50688
    v_cvt_pk_bf16_f32 v209, v218, v219
    v_mfma_f32_16x16x32_bf16 v[132:135], v[188:191], a[124:127], v[132:135]
    s_add_u32 m0, s67, 61440
    s_add_u32 s68, s79, 4423680
    v_mfma_f32_16x16x32_bf16 v[132:135], v[184:187], a[116:119], v[132:135]
    v_cvt_pk_bf16_f32 v210, v220, v221
    v_mfma_f32_16x16x32_bf16 v[136:139], v[184:187], a[240:243], v[136:139]
    ds_read_b64_tr_b16 v[180:181], v237 offset:58368
    v_mfma_f32_16x16x32_bf16 v[136:139], v[188:191], a[248:251], v[136:139]
    ds_read_b64_tr_b16 v[182:183], v237 offset:58880
    s_waitcnt lgkmcnt(4)
    v_mfma_f32_16x16x32_bf16 v[140:143], v[188:191], a[252:255], v[140:143]
    buffer_load_dwordx4 v2, s[12:15], s68 offen lds
    v_mfma_f32_16x16x32_bf16 v[140:143], v[184:187], a[244:247], v[140:143]
    v_cvt_pk_bf16_f32 v211, v222, v223
    v_mfma_f32_16x16x32_bf16 v[144:147], v[192:195], a[112:115], v[144:147]
    ds_read_b64_tr_b16 v[184:185], v248 offset:0
    buffer_store_dwordx4 v[208:211], v1, s[16:19], s95 offen offset:0 sc1
    v_mfma_f32_16x16x32_bf16 v[144:147], v[196:199], a[120:123], v[144:147]
    ds_read_b64_tr_b16 v[186:187], v248 offset:512
    v_mfma_f32_16x16x32_bf16 v[148:151], v[196:199], a[124:127], v[148:151]
    s_add_u32 m0, s67, 65536
    s_add_u32 s68, s79, 4718592
    v_cvt_pk_bf16_f32 v212, v224, v225
    v_mfma_f32_16x16x32_bf16 v[148:151], v[192:195], a[116:119], v[148:151]
    v_mfma_f32_16x16x32_bf16 v[152:155], v[192:195], a[240:243], v[152:155]
    ds_read_b64_tr_b16 v[188:189], v248 offset:8192
    v_cvt_pk_bf16_f32 v213, v226, v227
    v_mfma_f32_16x16x32_bf16 v[152:155], v[196:199], a[248:251], v[152:155]
    ds_read_b64_tr_b16 v[190:191], v248 offset:8704
    s_waitcnt lgkmcnt(4)
    v_mfma_f32_16x16x32_bf16 v[156:159], v[196:199], a[252:255], v[156:159]
    buffer_load_dwordx4 v2, s[12:15], s68 offen lds
    v_mfma_f32_16x16x32_bf16 v[156:159], v[192:195], a[244:247], v[156:159]
    v_cvt_pk_bf16_f32 v214, v228, v229
    v_mfma_f32_16x16x32_bf16 v[160:163], v[176:179], a[112:115], v[160:163]
    ds_read_b64_tr_b16 v[192:193], v249 offset:0
    v_mfma_f32_16x16x32_bf16 v[160:163], v[180:183], a[120:123], v[160:163]
    ds_read_b64_tr_b16 v[194:195], v249 offset:512
    v_cvt_pk_bf16_f32 v215, v230, v231
    v_mfma_f32_16x16x32_bf16 v[164:167], v[180:183], a[124:127], v[164:167]
    s_add_u32 m0, s67, 69632
    s_add_u32 s68, s79, 5013504
    v_mfma_f32_16x16x32_bf16 v[164:167], v[176:179], a[116:119], v[164:167]
    buffer_store_dwordx4 v[212:215], v1, s[16:19], s95 offen offset:1024 sc1
    v_mfma_f32_16x16x32_bf16 v[168:171], v[176:179], a[240:243], v[168:171]
    ds_read_b64_tr_b16 v[196:197], v249 offset:8192
    v_mfma_f32_16x16x32_bf16 v[168:171], v[180:183], a[248:251], v[168:171]
    ds_read_b64_tr_b16 v[198:199], v249 offset:8704
    s_waitcnt lgkmcnt(4)
    v_mfma_f32_16x16x32_bf16 v[172:175], v[180:183], a[252:255], v[172:175]
    buffer_load_dwordx4 v2, s[12:15], s68 offen lds
    v_mfma_f32_16x16x32_bf16 v[172:175], v[176:179], a[244:247], v[172:175]
    v_mfma_f32_16x16x32_bf16 v[48:51], v[184:187], v[16:19], v[48:51]
    ds_read_b64_tr_b16 v[176:177], v250 offset:0
    v_xor_b32 v252, 0, v5
    v_mfma_f32_16x16x32_bf16 v[48:51], v[188:191], v[24:27], v[48:51]
    ds_read_b64_tr_b16 v[178:179], v250 offset:512
    v_mfma_f32_16x16x32_bf16 v[52:55], v[188:191], v[28:31], v[52:55]
    v_mfma_f32_16x16x32_bf16 v[52:55], v[184:187], v[20:23], v[52:55]
    v_mfma_f32_16x16x32_bf16 v[56:59], v[184:187], v[32:35], v[56:59]
    ds_read_b64_tr_b16 v[180:181], v250 offset:8192
    v_mfma_f32_16x16x32_bf16 v[56:59], v[188:191], v[40:43], v[56:59]
    ds_read_b64_tr_b16 v[182:183], v250 offset:8704
    s_waitcnt lgkmcnt(4)
    v_mfma_f32_16x16x32_bf16 v[60:63], v[188:191], v[44:47], v[60:63]
    v_mfma_f32_16x16x32_bf16 v[60:63], v[184:187], v[36:39], v[60:63]
    v_mfma_f32_16x16x32_bf16 v[64:67], v[192:195], v[16:19], v[64:67]
    ds_read_b64_tr_b16 v[184:185], v251 offset:0
    v_mfma_f32_16x16x32_bf16 v[64:67], v[196:199], v[24:27], v[64:67]
    ds_read_b64_tr_b16 v[186:187], v251 offset:512
    v_mfma_f32_16x16x32_bf16 v[68:71], v[196:199], v[28:31], v[68:71]
    s_mov_b64 exec, 0x3ffff
    buffer_load_dword v0, v239, s[12:15], s5 offen offset:128
    s_mov_b64 exec, -1
    v_mfma_f32_16x16x32_bf16 v[68:71], v[192:195], v[20:23], v[68:71]
    v_add_u32 v252, 0, v252
    v_mfma_f32_16x16x32_bf16 v[72:75], v[192:195], v[32:35], v[72:75]
    ds_read_b64_tr_b16 v[188:189], v251 offset:8192
    v_mfma_f32_16x16x32_bf16 v[72:75], v[196:199], v[40:43], v[72:75]
    ds_read_b64_tr_b16 v[190:191], v251 offset:8704
    s_waitcnt lgkmcnt(4)
    v_mfma_f32_16x16x32_bf16 v[76:79], v[196:199], v[44:47], v[76:79]
    v_mfma_f32_16x16x32_bf16 v[76:79], v[192:195], v[36:39], v[76:79]
    v_mfma_f32_16x16x32_bf16 v[80:83], v[176:179], v[16:19], v[80:83]
    ds_read_b64_tr_b16 v[192:193], v248 offset:1024
    v_mfma_f32_16x16x32_bf16 v[80:83], v[180:183], v[24:27], v[80:83]
    ds_read_b64_tr_b16 v[194:195], v248 offset:1536
    v_mfma_f32_16x16x32_bf16 v[84:87], v[180:183], v[28:31], v[84:87]
    s_mov_b64 exec, 0x3ffff
    buffer_load_dword v0, v239, s[12:15], s6 offen offset:0
    s_mov_b64 exec, -1
    v_mfma_f32_16x16x32_bf16 v[84:87], v[176:179], v[20:23], v[84:87]
    v_mfma_f32_16x16x32_bf16 v[88:91], v[176:179], v[32:35], v[88:91]
    ds_read_b64_tr_b16 v[196:197], v248 offset:9216
    v_mfma_f32_16x16x32_bf16 v[88:91], v[180:183], v[40:43], v[88:91]
    ds_read_b64_tr_b16 v[198:199], v248 offset:9728
    s_waitcnt lgkmcnt(4)
    v_mfma_f32_16x16x32_bf16 v[92:95], v[180:183], v[44:47], v[92:95]
    v_add_u32 v253, 36864, v252
    v_mfma_f32_16x16x32_bf16 v[92:95], v[176:179], v[36:39], v[92:95]
    v_mfma_f32_16x16x32_bf16 v[96:99], v[184:187], v[16:19], v[96:99]
    ds_read_b64_tr_b16 v[176:177], v249 offset:1024
    v_mfma_f32_16x16x32_bf16 v[96:99], v[188:191], v[24:27], v[96:99]
    ds_read_b64_tr_b16 v[178:179], v249 offset:1536
    v_mfma_f32_16x16x32_bf16 v[100:103], v[188:191], v[28:31], v[100:103]
    v_mfma_f32_16x16x32_bf16 v[100:103], v[184:187], v[20:23], v[100:103]
    v_mfma_f32_16x16x32_bf16 v[104:107], v[184:187], v[32:35], v[104:107]
    ds_read_b64_tr_b16 v[180:181], v249 offset:9216
    v_mfma_f32_16x16x32_bf16 v[104:107], v[188:191], v[40:43], v[104:107]
    ds_read_b64_tr_b16 v[182:183], v249 offset:9728
    s_waitcnt lgkmcnt(4)
    v_mfma_f32_16x16x32_bf16 v[108:111], v[188:191], v[44:47], v[108:111]
    v_mfma_f32_16x16x32_bf16 v[108:111], v[184:187], v[36:39], v[108:111]
    v_mfma_f32_16x16x32_bf16 v[112:115], v[192:195], v[16:19], v[112:115]
    ds_read_b64_tr_b16 v[184:185], v250 offset:1024
    v_mfma_f32_16x16x32_bf16 v[112:115], v[196:199], v[24:27], v[112:115]
    ds_read_b64_tr_b16 v[186:187], v250 offset:1536
    v_mfma_f32_16x16x32_bf16 v[116:119], v[196:199], v[28:31], v[116:119]
    s_waitcnt vmcnt(2)
    s_barrier
    v_mfma_f32_16x16x32_bf16 v[116:119], v[192:195], v[20:23], v[116:119]
    v_mfma_f32_16x16x32_bf16 v[120:123], v[192:195], v[32:35], v[120:123]
    ds_read_b64_tr_b16 v[188:189], v250 offset:9216
    v_mfma_f32_16x16x32_bf16 v[120:123], v[196:199], v[40:43], v[120:123]
    ds_read_b64_tr_b16 v[190:191], v250 offset:9728
    s_waitcnt lgkmcnt(4)
    v_mfma_f32_16x16x32_bf16 v[124:127], v[196:199], v[44:47], v[124:127]
    v_mfma_f32_16x16x32_bf16 v[124:127], v[192:195], v[36:39], v[124:127]
    v_mfma_f32_16x16x32_bf16 v[128:131], v[176:179], v[16:19], v[128:131]
    ds_read_b64_tr_b16 v[192:193], v251 offset:1024
    v_mfma_f32_16x16x32_bf16 v[128:131], v[180:183], v[24:27], v[128:131]
    ds_read_b64_tr_b16 v[194:195], v251 offset:1536
    v_mfma_f32_16x16x32_bf16 v[132:135], v[180:183], v[28:31], v[132:135]
    v_mfma_f32_16x16x32_bf16 v[132:135], v[176:179], v[20:23], v[132:135]
    v_mfma_f32_16x16x32_bf16 v[136:139], v[176:179], v[32:35], v[136:139]
    ds_read_b64_tr_b16 v[196:197], v251 offset:9216
    v_mfma_f32_16x16x32_bf16 v[136:139], v[180:183], v[40:43], v[136:139]
    ds_read_b64_tr_b16 v[198:199], v251 offset:9728
    s_waitcnt lgkmcnt(4)
    v_mfma_f32_16x16x32_bf16 v[140:143], v[180:183], v[44:47], v[140:143]
    v_mfma_f32_16x16x32_bf16 v[140:143], v[176:179], v[36:39], v[140:143]
    v_mfma_f32_16x16x32_bf16 v[144:147], v[184:187], v[16:19], v[144:147]
    ds_read_b64_tr_b16 v[176:177], v252 offset:0
    v_mfma_f32_16x16x32_bf16 v[144:147], v[188:191], v[24:27], v[144:147]
    ds_read_b64_tr_b16 v[178:179], v252 offset:512
    v_mfma_f32_16x16x32_bf16 v[148:151], v[188:191], v[28:31], v[148:151]
    v_mfma_f32_16x16x32_bf16 v[148:151], v[184:187], v[20:23], v[148:151]
    v_mfma_f32_16x16x32_bf16 v[152:155], v[184:187], v[32:35], v[152:155]
    ds_read_b64_tr_b16 v[180:181], v252 offset:4096
    v_mfma_f32_16x16x32_bf16 v[152:155], v[188:191], v[40:43], v[152:155]
    ds_read_b64_tr_b16 v[182:183], v252 offset:4608
    s_waitcnt lgkmcnt(4)
    v_mfma_f32_16x16x32_bf16 v[156:159], v[188:191], v[44:47], v[156:159]
    v_mfma_f32_16x16x32_bf16 v[156:159], v[184:187], v[36:39], v[156:159]
    v_mfma_f32_16x16x32_bf16 v[160:163], v[192:195], v[16:19], v[160:163]
    ds_read_b64_tr_b16 v[184:185], v252 offset:8192
    v_mfma_f32_16x16x32_bf16 v[160:163], v[196:199], v[24:27], v[160:163]
    ds_read_b64_tr_b16 v[186:187], v252 offset:8704
    v_mfma_f32_16x16x32_bf16 v[164:167], v[196:199], v[28:31], v[164:167]
    v_mfma_f32_16x16x32_bf16 v[164:167], v[192:195], v[20:23], v[164:167]
    v_mfma_f32_16x16x32_bf16 v[168:171], v[192:195], v[32:35], v[168:171]
    ds_read_b64_tr_b16 v[188:189], v252 offset:12288
    v_mfma_f32_16x16x32_bf16 v[168:171], v[196:199], v[40:43], v[168:171]
    ds_read_b64_tr_b16 v[190:191], v252 offset:12800
    s_waitcnt lgkmcnt(4)
    v_mfma_f32_16x16x32_bf16 v[172:175], v[196:199], v[44:47], v[172:175]
    v_mfma_f32_16x16x32_bf16 v[172:175], v[192:195], v[36:39], v[172:175]
    v_mfma_f32_16x16x32_bf16 v[200:203], v[176:179], a[0:3], 0
    ds_read_b64_tr_b16 v[192:193], v252 offset:16384
    v_xor_b32 v250, 32, v5
    v_mfma_f32_16x16x32_bf16 v[200:203], v[180:183], a[8:11], v[200:203]
    ds_read_b64_tr_b16 v[194:195], v252 offset:16896
    v_mfma_f32_16x16x32_bf16 v[204:207], v[176:179], a[4:7], 0
    v_mfma_f32_16x16x32_bf16 v[204:207], v[180:183], a[12:15], v[204:207]
    v_mfma_f32_16x16x32_bf16 v[208:211], v[176:179], a[128:131], 0
    ds_read_b64_tr_b16 v[196:197], v252 offset:20480
    v_mul_f32 v48, s86, v48
    v_mfma_f32_16x16x32_bf16 v[208:211], v[180:183], a[136:139], v[208:211]
    ds_read_b64_tr_b16 v[198:199], v252 offset:20992
    s_waitcnt lgkmcnt(4)
    v_mfma_f32_16x16x32_bf16 v[212:215], v[176:179], a[132:135], 0
    v_mul_f32 v49, s86, v49
    v_mul_f32 v50, s86, v50
    v_mfma_f32_16x16x32_bf16 v[212:215], v[180:183], a[140:143], v[212:215]
    v_mul_f32 v51, s86, v51
    v_mul_f32 v64, s86, v64
    v_mfma_f32_16x16x32_bf16 v[212:215], v[184:187], a[148:151], v[212:215]
    ds_read_b64_tr_b16 v[176:177], v252 offset:24576
    v_mul_f32 v65, s86, v65
    v_mfma_f32_16x16x32_bf16 v[212:215], v[188:191], a[156:159], v[212:215]
    ds_read_b64_tr_b16 v[178:179], v252 offset:25088
    v_mul_f32 v66, s86, v66
    v_mfma_f32_16x16x32_bf16 v[208:211], v[188:191], a[152:155], v[208:211]
    v_mul_f32 v67, s86, v67
    v_cvt_pk_bf16_f32 v48, v48, v49
    v_mfma_f32_16x16x32_bf16 v[208:211], v[184:187], a[144:147], v[208:211]
    v_cvt_pk_bf16_f32 v49, v50, v51
    v_cvt_pk_bf16_f32 v50, v64, v65
    v_mfma_f32_16x16x32_bf16 v[204:207], v[184:187], a[20:23], v[204:207]
    ds_read_b64_tr_b16 v[180:181], v252 offset:28672
    v_cvt_pk_bf16_f32 v51, v66, v67
    v_mfma_f32_16x16x32_bf16 v[204:207], v[188:191], a[28:31], v[204:207]
    ds_read_b64_tr_b16 v[182:183], v252 offset:29184
    s_waitcnt lgkmcnt(4)
    v_mfma_f32_16x16x32_bf16 v[200:203], v[188:191], a[24:27], v[200:203]
    v_mul_f32 v52, s86, v52
    v_mul_f32 v53, s86, v53
    v_mfma_f32_16x16x32_bf16 v[200:203], v[184:187], a[16:19], v[200:203]
    v_mul_f32 v54, s86, v54
    v_mul_f32 v55, s86, v55
    v_mfma_f32_16x16x32_bf16 v[200:203], v[192:195], a[32:35], v[200:203]
    ds_read_b64_tr_b16 v[184:185], v252 offset:32768
    v_add_u32 v250, 0, v250
    v_mfma_f32_16x16x32_bf16 v[200:203], v[196:199], a[40:43], v[200:203]
    ds_read_b64_tr_b16 v[186:187], v252 offset:33280
    v_mul_f32 v68, s86, v68
    v_mfma_f32_16x16x32_bf16 v[204:207], v[196:199], a[44:47], v[204:207]
    s_barrier
    v_mfma_f32_16x16x32_bf16 v[204:207], v[192:195], a[36:39], v[204:207]
    s_cmp_lg_u32 s3, 0
    s_cbranch_scc1 KF_nf5
    s_mov_b64 exec, 0x1
    buffer_store_dword v7, v6, s[16:19], s91 offen sc1
    s_mov_b64 exec, -1
KF_nf5:
    v_mfma_f32_16x16x32_bf16 v[208:211], v[192:195], a[160:163], v[208:211]
    ds_read_b64_tr_b16 v[188:189], v253 offset:0
    v_mul_f32 v69, s86, v69
    v_mfma_f32_16x16x32_bf16 v[208:211], v[196:199], a[168:171], v[208:211]
    ds_read_b64_tr_b16 v[190:191], v253 offset:512
    s_waitcnt lgkmcnt(4)
    v_mfma_f32_16x16x32_bf16 v[212:215], v[196:199], a[172:175], v[212:215]
    v_mul_f32 v70, s86, v70
    v_mul_f32 v71, s86, v71
    v_mfma_f32_16x16x32_bf16 v[212:215], v[192:195], a[164:167], v[212:215]
    v_cvt_pk_bf16_f32 v52, v52, v53
    v_cvt_pk_bf16_f32 v53, v54, v55
    v_mfma_f32_16x16x32_bf16 v[212:215], v[176:179], a[180:183], v[212:215]
    ds_read_b64_tr_b16 v[192:193], v253 offset:4096
    v_cvt_pk_bf16_f32 v54, v68, v69
    v_mfma_f32_16x16x32_bf16 v[212:215], v[180:183], a[188:191], v[212:215]
    ds_read_b64_tr_b16 v[194:195], v253 offset:4608
    v_cvt_pk_bf16_f32 v55, v70, v71
    v_mfma_f32_16x16x32_bf16 v[208:211], v[180:183], a[184:187], v[208:211]
    v_mul_f32 v56, s86, v56
    v_mul_f32 v57, s86, v57
    v_mfma_f32_16x16x32_bf16 v[208:211], v[176:179], a[176:179], v[208:211]
    v_mul_f32 v58, s86, v58
    v_mul_f32 v59, s86, v59
    v_mfma_f32_16x16x32_bf16 v[204:207], v[176:179], a[52:55], v[204:207]
    ds_read_b64_tr_b16 v[196:197], v253 offset:8192
    v_mul_f32 v72, s86, v72
    v_mfma_f32_16x16x32_bf16 v[204:207], v[180:183], a[60:63], v[204:207]
    ds_read_b64_tr_b16 v[198:199], v253 offset:8704
    s_waitcnt lgkmcnt(4)
    v_mfma_f32_16x16x32_bf16 v[200:203], v[180:183], a[56:59], v[200:203]
    v_mul_f32 v73, s86, v73
    v_mul_f32 v74, s86, v74
    v_mfma_f32_16x16x32_bf16 v[200:203], v[176:179], a[48:51], v[200:203]
    v_mul_f32 v75, s86, v75
    v_cvt_pk_bf16_f32 v56, v56, v57
    v_mfma_f32_16x16x32_bf16 v[200:203], v[184:187], a[64:67], v[200:203]
    ds_read_b64_tr_b16 v[176:177], v253 offset:12288
    v_add_u32 v251, 36864, v250
    v_mfma_f32_16x16x32_bf16 v[200:203], v[188:191], a[72:75], v[200:203]
    ds_read_b64_tr_b16 v[178:179], v253 offset:12800
    v_cvt_pk_bf16_f32 v57, v58, v59
    v_mfma_f32_16x16x32_bf16 v[204:207], v[188:191], a[76:79], v[204:207]
    s_cmp_lt_u32 s64, 4
    s_cselect_b32 s24, s48, s54
    s_cselect_b32 s25, s49, s55
    v_mfma_f32_16x16x32_bf16 v[204:207], v[184:187], a[68:71], v[204:207]
    v_cvt_pk_bf16_f32 v58, v72, v73
    v_cvt_pk_bf16_f32 v59, v74, v75
    v_mfma_f32_16x16x32_bf16 v[208:211], v[184:187], a[192:195], v[208:211]
    ds_read_b64_tr_b16 v[180:181], v253 offset:16384
    v_mul_f32 v60, s86, v60
    v_mfma_f32_16x16x32_bf16 v[208:211], v[188:191], a[200:203], v[208:211]
    ds_read_b64_tr_b16 v[182:183], v253 offset:16896
    s_waitcnt lgkmcnt(4)
    v_mfma_f32_16x16x32_bf16 v[212:215], v[188:191], a[204:207], v[212:215]
    v_mul_f32 v61, s86, v61
    v_mul_f32 v62, s86, v62
    v_mfma_f32_16x16x32_bf16 v[212:215], v[184:187], a[196:199], v[212:215]
    v_mul_f32 v63, s86, v63
    v_mul_f32 v76, s86, v76
    v_mfma_f32_16x16x32_bf16 v[212:215], v[192:195], a[212:215], v[212:215]
    ds_read_b64_tr_b16 v[184:185], v253 offset:20480
    v_mul_f32 v77, s86, v77
    v_mfma_f32_16x16x32_bf16 v[212:215], v[196:199], a[220:223], v[212:215]
    ds_read_b64_tr_b16 v[186:187], v253 offset:20992
    v_mul_f32 v78, s86, v78
    v_mfma_f32_16x16x32_bf16 v[208:211], v[196:199], a[216:219], v[208:211]
    s_add_u32 m0, s67, 73728
    s_add_u32 s68, s79, 128
    v_mul_f32 v79, s86, v79
    v_mfma_f32_16x16x32_bf16 v[208:211], v[192:195], a[208:211], v[208:211]
    buffer_load_dwordx4 v2, s[12:15], s68 offen lds
    v_mfma_f32_16x16x32_bf16 v[204:207], v[192:195], a[84:87], v[204:207]
    ds_read_b64_tr_b16 v[188:189], v253 offset:24576
    v_cvt_pk_bf16_f32 v60, v60, v61
    v_mfma_f32_16x16x32_bf16 v[204:207], v[196:199], a[92:95], v[204:207]
    ds_read_b64_tr_b16 v[190:191], v253 offset:25088
    s_waitcnt lgkmcnt(4)
    v_mfma_f32_16x16x32_bf16 v[200:203], v[196:199], a[88:91], v[200:203]
    s_add_u32 m0, s67, 77824
    s_add_u32 s68, s79, 295040
    v_cvt_pk_bf16_f32 v61, v62, v63
    v_mfma_f32_16x16x32_bf16 v[200:203], v[192:195], a[80:83], v[200:203]
    s_cmp_lt_u32 s64, 4
    s_cselect_b32 s72, 32, 36
    s_cselect_b32 s5, 0, 1
    v_mfma_f32_16x16x32_bf16 v[200:203], v[176:179], a[96:99], v[200:203]
    ds_read_b64_tr_b16 v[192:193], v253 offset:28672
    v_cvt_pk_bf16_f32 v62, v76, v77
    v_mfma_f32_16x16x32_bf16 v[200:203], v[180:183], a[104:107], v[200:203]
    ds_read_b64_tr_b16 v[194:195], v253 offset:29184
    v_cvt_pk_bf16_f32 v63, v78, v79
    v_mfma_f32_16x16x32_bf16 v[204:207], v[180:183], a[108:111], v[204:207]
    buffer_load_dwordx4 v2, s[12:15], s68 offen lds
    v_mfma_f32_16x16x32_bf16 v[204:207], v[176:179], a[100:103], v[204:207]
    s_and_b32 s73, s64, 3
    s_mul_i32 s7, s73, s72
    v_mul_f32 v80, s86, v80
    v_mfma_f32_16x16x32_bf16 v[208:211], v[176:179], a[224:227], v[208:211]
    ds_read_b64_tr_b16 v[196:197], v253 offset:32768
    v_mul_f32 v81, s86, v81
    v_mfma_f32_16x16x32_bf16 v[208:211], v[180:183], a[232:235], v[208:211]
    ds_read_b64_tr_b16 v[198:199], v253 offset:33280
    s_waitcnt lgkmcnt(4)
    v_mfma_f32_16x16x32_bf16 v[212:215], v[180:183], a[236:239], v[212:215]
    s_add_u32 m0, s67, 81920
    s_add_u32 s68, s79, 589952
    v_mul_f32 v82, s86, v82
    v_mfma_f32_16x16x32_bf16 v[212:215], v[176:179], a[228:231], v[212:215]
    buffer_load_dwordx4 v2, s[12:15], s68 offen lds
    v_mfma_f32_16x16x32_bf16 v[212:215], v[184:187], a[244:247], v[212:215]
    ds_read_b64_tr_b16 v[176:177], v250 offset:0
    v_mul_f32 v83, s86, v83
    v_mfma_f32_16x16x32_bf16 v[212:215], v[188:191], a[252:255], v[212:215]
    ds_read_b64_tr_b16 v[178:179], v250 offset:512
    v_mul_f32 v96, s86, v96
    v_mfma_f32_16x16x32_bf16 v[208:211], v[188:191], a[248:251], v[208:211]
    s_add_u32 m0, s67, 86016
    s_add_u32 s68, s79, 884864
    v_mul_f32 v97, s86, v97
    v_mfma_f32_16x16x32_bf16 v[208:211], v[184:187], a[240:243], v[208:211]
    v_mul_f32 v98, s86, v98
    v_mul_f32 v99, s86, v99
    v_mfma_f32_16x16x32_bf16 v[204:207], v[184:187], a[116:119], v[204:207]
    ds_read_b64_tr_b16 v[180:181], v250 offset:4096
    v_cvt_pk_bf16_f32 v80, v80, v81
    v_mfma_f32_16x16x32_bf16 v[204:207], v[188:191], a[124:127], v[204:207]
    ds_read_b64_tr_b16 v[182:183], v250 offset:4608
    s_waitcnt lgkmcnt(4)
    v_mfma_f32_16x16x32_bf16 v[200:203], v[188:191], a[120:123], v[200:203]
    buffer_load_dwordx4 v2, s[12:15], s68 offen lds
    v_mfma_f32_16x16x32_bf16 v[200:203], v[184:187], a[112:115], v[200:203]
    s_lshl_b32 s6, s5, 7
    s_add_u32 s6, s6, s7
    v_cvt_pk_bf16_f32 v81, v82, v83
    v_mfma_f32_16x16x32_bf16 v[200:203], v[192:195], v[16:19], v[200:203]
    ds_read_b64_tr_b16 v[184:185], v250 offset:8192
    v_xor_b32 v252, 64, v5
    v_mfma_f32_16x16x32_bf16 v[200:203], v[196:199], v[24:27], v[200:203]
    ds_read_b64_tr_b16 v[186:187], v250 offset:8704
    v_cvt_pk_bf16_f32 v82, v96, v97
    v_mfma_f32_16x16x32_bf16 v[204:207], v[196:199], v[28:31], v[204:207]
    s_add_u32 m0, s67, 90112
    s_add_u32 s68, s79, 1179776
    v_cvt_pk_bf16_f32 v83, v98, v99
    v_mfma_f32_16x16x32_bf16 v[204:207], v[192:195], v[20:23], v[204:207]
    v_mul_f32 v84, s86, v84
    v_mul_f32 v85, s86, v85
    v_mfma_f32_16x16x32_bf16 v[208:211], v[192:195], v[32:35], v[208:211]
    ds_read_b64_tr_b16 v[188:189], v250 offset:12288
    v_mul_f32 v86, s86, v86
    v_mfma_f32_16x16x32_bf16 v[208:211], v[196:199], v[40:43], v[208:211]
    ds_read_b64_tr_b16 v[190:191], v250 offset:12800
    s_waitcnt lgkmcnt(4)
    v_mfma_f32_16x16x32_bf16 v[212:215], v[196:199], v[44:47], v[212:215]
    buffer_load_dwordx4 v2, s[12:15], s68 offen lds
    v_mfma_f32_16x16x32_bf16 v[212:215], v[192:195], v[36:39], v[212:215]
    s_add_u32 m0, s67, 94208
    s_add_u32 s68, s79, 1474688
    v_mul_f32 v87, s86, v87
    v_mfma_f32_16x16x32_bf16 v[216:219], v[176:179], a[0:3], 0
    ds_read_b64_tr_b16 v[192:193], v250 offset:16384
    v_mul_f32 v100, s86, v100
    v_mfma_f32_16x16x32_bf16 v[216:219], v[180:183], a[8:11], v[216:219]
    ds_read_b64_tr_b16 v[194:195], v250 offset:16896
    v_mul_f32 v101, s86, v101
    v_mfma_f32_16x16x32_bf16 v[220:223], v[176:179], a[4:7], 0
    buffer_load_dwordx4 v2, s[12:15], s68 offen lds
    v_mfma_f32_16x16x32_bf16 v[220:223], v[180:183], a[12:15], v[220:223]
    s_add_u32 s26, s7, s72
    s_mul_i32 s26, s26, 36864
    v_mul_f32 v102, s86, v102
    v_mfma_f32_16x16x32_bf16 v[224:227], v[176:179], a[128:131], 0
    ds_read_b64_tr_b16 v[196:197], v250 offset:20480
    v_mul_f32 v103, s86, v103
    v_mfma_f32_16x16x32_bf16 v[224:227], v[180:183], a[136:139], v[224:227]
    ds_read_b64_tr_b16 v[198:199], v250 offset:20992
    s_waitcnt lgkmcnt(4)
    v_mfma_f32_16x16x32_bf16 v[228:231], v[176:179], a[132:135], 0
    s_add_u32 m0, s67, 98304
    s_add_u32 s68, s79, 1769600
    v_cvt_pk_bf16_f32 v84, v84, v85
    v_mfma_f32_16x16x32_bf16 v[228:231], v[180:183], a[140:143], v[228:231]
    s_mul_i32 s7, s7, 36864
    v_cvt_pk_bf16_f32 v85, v86, v87
    v_cvt_pk_bf16_f32 v86, v100, v101
    v_mfma_f32_16x16x32_bf16 v[228:231], v[184:187], a[148:151], v[228:231]
    ds_read_b64_tr_b16 v[176:177], v250 offset:24576
    v_cvt_pk_bf16_f32 v232, v200, v201
    v_mfma_f32_16x16x32_bf16 v[228:231], v[188:191], a[156:159], v[228:231]
    ds_read_b64_tr_b16 v[178:179], v250 offset:25088
    v_cvt_pk_bf16_f32 v87, v102, v103
    v_mfma_f32_16x16x32_bf16 v[224:227], v[188:191], a[152:155], v[224:227]
    buffer_load_dwordx4 v2, s[12:15], s68 offen lds
    v_mfma_f32_16x16x32_bf16 v[224:227], v[184:187], a[144:147], v[224:227]
    s_add_u32 m0, s67, 102400
    s_add_u32 s68, s79, 2064512
    v_add_u32 v252, 0, v252
    v_mfma_f32_16x16x32_bf16 v[220:223], v[184:187], a[20:23], v[220:223]
    ds_read_b64_tr_b16 v[180:181], v250 offset:28672
    v_cvt_pk_bf16_f32 v233, v202, v203
    v_mfma_f32_16x16x32_bf16 v[220:223], v[188:191], a[28:31], v[220:223]
    ds_read_b64_tr_b16 v[182:183], v250 offset:29184
    s_waitcnt lgkmcnt(4)
    v_mfma_f32_16x16x32_bf16 v[216:219], v[188:191], a[24:27], v[216:219]
    buffer_load_dwordx4 v2, s[12:15], s68 offen lds
    v_mfma_f32_16x16x32_bf16 v[216:219], v[184:187], a[16:19], v[216:219]
    v_pk_max_i16 v232, v232, 0
    v_mul_f32 v88, s86, v88
    v_mfma_f32_16x16x32_bf16 v[216:219], v[192:195], a[32:35], v[216:219]
    ds_read_b64_tr_b16 v[184:185], v250 offset:32768
    v_mul_f32 v89, s86, v89
    v_mfma_f32_16x16x32_bf16 v[216:219], v[196:199], a[40:43], v[216:219]
    ds_read_b64_tr_b16 v[186:187], v250 offset:33280
    v_mul_f32 v90, s86, v90
    v_mfma_f32_16x16x32_bf16 v[220:223], v[196:199], a[44:47], v[220:223]
    s_add_u32 m0, s67, 106496
    s_add_u32 s68, s79, 2359424
    v_pk_max_i16 v233, v233, 0
    v_mfma_f32_16x16x32_bf16 v[220:223], v[192:195], a[36:39], v[220:223]
    s_lshr_b32 s72, s2, 3
    s_lshl_b32 s72, s72, 2
    v_mul_f32 v91, s86, v91
    v_mfma_f32_16x16x32_bf16 v[224:227], v[192:195], a[160:163], v[224:227]
    ds_read_b64_tr_b16 v[188:189], v251 offset:0
    v_mul_f32 v104, s86, v104
    v_mfma_f32_16x16x32_bf16 v[224:227], v[196:199], a[168:171], v[224:227]
    ds_read_b64_tr_b16 v[190:191], v251 offset:512
    s_waitcnt lgkmcnt(4)
    v_mfma_f32_16x16x32_bf16 v[228:231], v[196:199], a[172:175], v[228:231]
    buffer_load_dwordx4 v2, s[12:15], s68 offen lds
    v_mfma_f32_16x16x32_bf16 v[228:231], v[192:195], a[164:167], v[228:231]
    v_cvt_pk_bf16_f32 v236, v204, v205
    v_mul_f32 v105, s86, v105
    v_mfma_f32_16x16x32_bf16 v[228:231], v[176:179], a[180:183], v[228:231]
    ds_read_b64_tr_b16 v[192:193], v251 offset:4096
    v_mul_f32 v106, s86, v106
    v_mfma_f32_16x16x32_bf16 v[228:231], v[180:183], a[188:191], v[228:231]
    ds_read_b64_tr_b16 v[194:195], v251 offset:4608
    v_cvt_pk_bf16_f32 v237, v206, v207
    v_mfma_f32_16x16x32_bf16 v[224:227], v[180:183], a[184:187], v[224:227]
    s_add_u32 m0, s67, 110592
    s_add_u32 s68, s79, 2654336
    v_mul_f32 v107, s86, v107
    v_mfma_f32_16x16x32_bf16 v[224:227], v[176:179], a[176:179], v[224:227]
    buffer_load_dwordx4 v2, s[12:15], s68 offen lds
    v_mfma_f32_16x16x32_bf16 v[220:223], v[176:179], a[52:55], v[220:223]
    ds_read_b64_tr_b16 v[196:197], v251 offset:8192
    v_cvt_pk_bf16_f32 v88, v88, v89
    v_mfma_f32_16x16x32_bf16 v[220:223], v[180:183], a[60:63], v[220:223]
    ds_read_b64_tr_b16 v[198:199], v251 offset:8704
    s_waitcnt lgkmcnt(4)
    v_mfma_f32_16x16x32_bf16 v[216:219], v[180:183], a[56:59], v[216:219]
    s_add_u32 m0, s67, 114688
    s_add_u32 s68, s79, 2949248
    v_add_u32 v253, 36864, v252
    v_mfma_f32_16x16x32_bf16 v[216:219], v[176:179], a[48:51], v[216:219]
    s_add_u32 s72, s72, s3
    s_mul_i32 s72, s72, 2688
    v_pk_max_i16 v236, v236, 0
    v_mfma_f32_16x16x32_bf16 v[216:219], v[184:187], a[64:67], v[216:219]
    ds_read_b64_tr_b16 v[176:177], v251 offset:12288
    v_pk_max_i16 v237, v237, 0
    v_mfma_f32_16x16x32_bf16 v[216:219], v[188:191], a[72:75], v[216:219]
    ds_read_b64_tr_b16 v[178:179], v251 offset:12800
    v_cvt_pk_bf16_f32 v89, v90, v91
    v_mfma_f32_16x16x32_bf16 v[220:223], v[188:191], a[76:79], v[220:223]
    buffer_load_dwordx4 v2, s[12:15], s68 offen lds
    v_mfma_f32_16x16x32_bf16 v[220:223], v[184:187], a[68:71], v[220:223]
    s_add_u32 s89, s7, s72
    s_mov_b32 s39, s89
    v_cvt_pk_bf16_f32 v90, v104, v105
    v_mfma_f32_16x16x32_bf16 v[224:227], v[184:187], a[192:195], v[224:227]
    ds_read_b64_tr_b16 v[180:181], v251 offset:16384
    v_cvt_pk_bf16_f32 v240, v208, v209
    v_mfma_f32_16x16x32_bf16 v[224:227], v[188:191], a[200:203], v[224:227]
    ds_read_b64_tr_b16 v[182:183], v251 offset:16896
    s_waitcnt lgkmcnt(4)
    v_mfma_f32_16x16x32_bf16 v[228:231], v[188:191], a[204:207], v[228:231]
    s_add_u32 m0, s67, 118784
    s_add_u32 s68, s79, 3244160
    v_cvt_pk_bf16_f32 v91, v106, v107
    v_mfma_f32_16x16x32_bf16 v[228:231], v[184:187], a[196:199], v[228:231]
    buffer_load_dwordx4 v2, s[12:15], s68 offen lds
    v_mfma_f32_16x16x32_bf16 v[228:231], v[192:195], a[212:215], v[228:231]
    ds_read_b64_tr_b16 v[184:185], v251 offset:20480
    v_cvt_pk_bf16_f32 v241, v210, v211
    v_mfma_f32_16x16x32_bf16 v[228:231], v[196:199], a[220:223], v[228:231]
    ds_read_b64_tr_b16 v[186:187], v251 offset:20992
    v_mul_f32 v92, s86, v92
    v_mfma_f32_16x16x32_bf16 v[224:227], v[196:199], a[216:219], v[224:227]
    s_add_u32 m0, s67, 122880
    s_add_u32 s68, s79, 3539072
    v_mul_f32 v93, s86, v93
    v_mfma_f32_16x16x32_bf16 v[224:227], v[192:195], a[208:211], v[224:227]
    v_pk_max_i16 v240, v240, 0
    v_mul_f32 v94, s86, v94
    v_mfma_f32_16x16x32_bf16 v[220:223], v[192:195], a[84:87], v[220:223]
    ds_read_b64_tr_b16 v[188:189], v251 offset:24576
    v_mul_f32 v95, s86, v95
    v_mfma_f32_16x16x32_bf16 v[220:223], v[196:199], a[92:95], v[220:223]
    ds_read_b64_tr_b16 v[190:191], v251 offset:25088
    s_waitcnt lgkmcnt(4)
    v_mfma_f32_16x16x32_bf16 v[216:219], v[196:199], a[88:91], v[216:219]
    buffer_load_dwordx4 v2, s[12:15], s68 offen lds
    v_mfma_f32_16x16x32_bf16 v[216:219], v[192:195], a[80:83], v[216:219]
    s_add_u32 s88, s89, 671744
    v_pk_max_i16 v241, v241, 0
    v_mul_f32 v108, s86, v108
    v_mfma_f32_16x16x32_bf16 v[216:219], v[176:179], a[96:99], v[216:219]
    ds_read_b64_tr_b16 v[192:193], v251 offset:28672
    v_mul_f32 v109, s86, v109
    v_mfma_f32_16x16x32_bf16 v[216:219], v[180:183], a[104:107], v[216:219]
    ds_read_b64_tr_b16 v[194:195], v251 offset:29184
    v_mul_f32 v110, s86, v110
    v_mfma_f32_16x16x32_bf16 v[220:223], v[180:183], a[108:111], v[220:223]
    s_add_u32 m0, s67, 126976
    s_add_u32 s68, s79, 3833984
    v_cvt_pk_bf16_f32 v244, v212, v213
    v_mfma_f32_16x16x32_bf16 v[220:223], v[176:179], a[100:103], v[220:223]
    v_mul_f32 v111, s86, v111
    v_cvt_pk_bf16_f32 v92, v92, v93
    v_mfma_f32_16x16x32_bf16 v[224:227], v[176:179], a[224:227], v[224:227]
    ds_read_b64_tr_b16 v[196:197], v251 offset:32768
    v_cvt_pk_bf16_f32 v93, v94, v95
    v_mfma_f32_16x16x32_bf16 v[224:227], v[180:183], a[232:235], v[224:227]
    ds_read_b64_tr_b16 v[198:199], v251 offset:33280
    s_waitcnt lgkmcnt(4)
    v_mfma_f32_16x16x32_bf16 v[228:231], v[180:183], a[236:239], v[228:231]
    buffer_load_dwordx4 v2, s[12:15], s68 offen lds
    v_mfma_f32_16x16x32_bf16 v[228:231], v[176:179], a[228:231], v[228:231]
    s_add_u32 m0, s67, 131072
    s_add_u32 s68, s79, 4128896
    v_lshlrev_b32 v254, 3, v1
    v_mfma_f32_16x16x32_bf16 v[228:231], v[184:187], a[244:247], v[228:231]
    ds_read_b64_tr_b16 v[176:177], v252 offset:0
    v_cvt_pk_bf16_f32 v245, v214, v215
    v_mfma_f32_16x16x32_bf16 v[228:231], v[188:191], a[252:255], v[228:231]
    ds_read_b64_tr_b16 v[178:179], v252 offset:512
    v_pk_max_i16 v244, v244, 0
    v_mfma_f32_16x16x32_bf16 v[224:227], v[188:191], a[248:251], v[224:227]
    buffer_load_dwordx4 v2, s[12:15], s68 offen lds
    v_mfma_f32_16x16x32_bf16 v[224:227], v[184:187], a[240:243], v[224:227]
    v_cvt_pk_bf16_f32 v94, v108, v109
    v_cvt_pk_bf16_f32 v95, v110, v111
    v_mfma_f32_16x16x32_bf16 v[220:223], v[184:187], a[116:119], v[220:223]
    ds_read_b64_tr_b16 v[180:181], v252 offset:4096
    v_pk_max_i16 v245, v245, 0
    v_mfma_f32_16x16x32_bf16 v[220:223], v[188:191], a[124:127], v[220:223]
    ds_read_b64_tr_b16 v[182:183], v252 offset:4608
    s_waitcnt lgkmcnt(4)
    v_mfma_f32_16x16x32_bf16 v[216:219], v[188:191], a[120:123], v[216:219]
    s_add_u32 m0, s67, 135168
    s_add_u32 s68, s79, 4423808
    v_mul_f32 v112, s86, v112
    v_mfma_f32_16x16x32_bf16 v[216:219], v[184:187], a[112:115], v[216:219]
    v_mul_f32 v113, s86, v113
    v_mul_f32 v114, s86, v114
    v_mfma_f32_16x16x32_bf16 v[216:219], v[192:195], v[16:19], v[216:219]
    ds_read_b64_tr_b16 v[184:185], v252 offset:8192
    v_mul_f32 v115, s86, v115
    v_mfma_f32_16x16x32_bf16 v[216:219], v[196:199], v[24:27], v[216:219]
    ds_read_b64_tr_b16 v[186:187], v252 offset:8704
    v_mul_f32 v128, s86, v128
    v_mfma_f32_16x16x32_bf16 v[220:223], v[196:199], v[28:31], v[220:223]
    buffer_load_dwordx4 v2, s[12:15], s68 offen lds
    v_mfma_f32_16x16x32_bf16 v[220:223], v[192:195], v[20:23], v[220:223]
    s_add_u32 m0, s67, 139264
    s_add_u32 s68, s79, 4718720
    v_mul_f32 v129, s86, v129
    v_mfma_f32_16x16x32_bf16 v[224:227], v[192:195], v[32:35], v[224:227]
    ds_read_b64_tr_b16 v[188:189], v252 offset:12288
    v_mul_f32 v130, s86, v130
    v_mfma_f32_16x16x32_bf16 v[224:227], v[196:199], v[40:43], v[224:227]
    ds_read_b64_tr_b16 v[190:191], v252 offset:12800
    s_waitcnt lgkmcnt(4)
    v_mfma_f32_16x16x32_bf16 v[228:231], v[196:199], v[44:47], v[228:231]
    buffer_load_dwordx4 v2, s[12:15], s68 offen lds
    v_mfma_f32_16x16x32_bf16 v[228:231], v[192:195], v[36:39], v[228:231]
    v_mul_f32 v131, s86, v131
    v_cvt_pk_bf16_f32 v112, v112, v113
    v_mfma_f32_16x16x32_bf16 v[200:203], v[176:179], a[0:3], 0
    ds_read_b64_tr_b16 v[192:193], v252 offset:16384
    v_bfe_u32 v9, v1, 4, 4
    v_mfma_f32_16x16x32_bf16 v[200:203], v[180:183], a[8:11], v[200:203]
    ds_read_b64_tr_b16 v[194:195], v252 offset:16896
    v_xor_b32 v250, 96, v5
    v_mfma_f32_16x16x32_bf16 v[204:207], v[176:179], a[4:7], 0
    s_add_u32 m0, s67, 143360
    s_add_u32 s68, s79, 5013632
    v_cvt_pk_bf16_f32 v113, v114, v115
    v_mfma_f32_16x16x32_bf16 v[204:207], v[180:183], a[12:15], v[204:207]
    v_cvt_pk_bf16_f32 v114, v128, v129
    v_cvt_pk_bf16_f32 v115, v130, v131
    v_mfma_f32_16x16x32_bf16 v[208:211], v[176:179], a[128:131], 0
    ds_read_b64_tr_b16 v[196:197], v252 offset:20480
    v_lshlrev_b32 v9, 2, v9
    v_mfma_f32_16x16x32_bf16 v[208:211], v[180:183], a[136:139], v[208:211]
    ds_read_b64_tr_b16 v[198:199], v252 offset:20992
    s_waitcnt lgkmcnt(4)
    v_mfma_f32_16x16x32_bf16 v[212:215], v[176:179], a[132:135], 0
    buffer_load_dwordx4 v2, s[12:15], s68 offen lds
    v_mfma_f32_16x16x32_bf16 v[212:215], v[180:183], a[140:143], v[212:215]
    v_mul_f32 v116, s86, v116
    v_mul_f32 v117, s86, v117
    v_mfma_f32_16x16x32_bf16 v[212:215], v[184:187], a[148:151], v[212:215]
    ds_read_b64_tr_b16 v[176:177], v252 offset:24576
    v_cvt_pk_bf16_f32 v234, v216, v217
    v_mfma_f32_16x16x32_bf16 v[212:215], v[188:191], a[156:159], v[212:215]
    ds_read_b64_tr_b16 v[178:179], v252 offset:25088
    v_mul_f32 v118, s86, v118
    v_mfma_f32_16x16x32_bf16 v[208:211], v[188:191], a[152:155], v[208:211]
    buffer_load_dword v14, v9, s[16:19], s90 offen sc1
    v_mfma_f32_16x16x32_bf16 v[208:211], v[184:187], a[144:147], v[208:211]
    v_cvt_pk_bf16_f32 v235, v218, v219
    v_mul_f32 v119, s86, v119
    v_mfma_f32_16x16x32_bf16 v[204:207], v[184:187], a[20:23], v[204:207]
    ds_read_b64_tr_b16 v[180:181], v252 offset:28672
    v_mul_f32 v132, s86, v132
    v_mfma_f32_16x16x32_bf16 v[204:207], v[188:191], a[28:31], v[204:207]
    ds_read_b64_tr_b16 v[182:183], v252 offset:29184
    s_waitcnt lgkmcnt(4)
    v_mfma_f32_16x16x32_bf16 v[200:203], v[188:191], a[24:27], v[200:203]
    v_pk_max_i16 v234, v234, 0
    v_mul_f32 v133, s86, v133
    v_mfma_f32_16x16x32_bf16 v[200:203], v[184:187], a[16:19], v[200:203]
    v_mul_f32 v134, s86, v134
    v_mul_f32 v135, s86, v135
    v_mfma_f32_16x16x32_bf16 v[200:203], v[192:195], a[32:35], v[200:203]
    ds_read_b64_tr_b16 v[184:185], v252 offset:32768
    v_add_u32 v250, 0, v250
    v_mfma_f32_16x16x32_bf16 v[200:203], v[196:199], a[40:43], v[200:203]
    ds_read_b64_tr_b16 v[186:187], v252 offset:33280
    v_pk_max_i16 v235, v235, 0
    v_mfma_f32_16x16x32_bf16 v[204:207], v[196:199], a[44:47], v[204:207]
    v_cvt_pk_bf16_f32 v116, v116, v117
    v_cvt_pk_bf16_f32 v117, v118, v119
    v_mfma_f32_16x16x32_bf16 v[204:207], v[192:195], a[36:39], v[204:207]
    buffer_store_dwordx4 v[232:235], v10, s[16:19], s84 offen offset:0 sc1
    v_mfma_f32_16x16x32_bf16 v[208:211], v[192:195], a[160:163], v[208:211]
    ds_read_b64_tr_b16 v[188:189], v253 offset:0
    v_cvt_pk_bf16_f32 v118, v132, v133
    v_mfma_f32_16x16x32_bf16 v[208:211], v[196:199], a[168:171], v[208:211]
    ds_read_b64_tr_b16 v[190:191], v253 offset:512
    s_waitcnt lgkmcnt(4)
    v_mfma_f32_16x16x32_bf16 v[212:215], v[196:199], a[172:175], v[212:215]
    v_cvt_pk_bf16_f32 v238, v220, v221
    v_cvt_pk_bf16_f32 v119, v134, v135
    v_mfma_f32_16x16x32_bf16 v[212:215], v[192:195], a[164:167], v[212:215]
    v_mul_f32 v120, s86, v120
    v_mul_f32 v121, s86, v121
    v_mfma_f32_16x16x32_bf16 v[212:215], v[176:179], a[180:183], v[212:215]
    ds_read_b64_tr_b16 v[192:193], v253 offset:4096
    v_cvt_pk_bf16_f32 v239, v222, v223
    v_mfma_f32_16x16x32_bf16 v[212:215], v[180:183], a[188:191], v[212:215]
    ds_read_b64_tr_b16 v[194:195], v253 offset:4608
    v_mul_f32 v122, s86, v122
    v_mfma_f32_16x16x32_bf16 v[208:211], v[180:183], a[184:187], v[208:211]
    v_mul_f32 v123, s86, v123
    v_mul_f32 v136, s86, v136
    v_mfma_f32_16x16x32_bf16 v[208:211], v[176:179], a[176:179], v[208:211]
    v_pk_max_i16 v238, v238, 0
    v_mul_f32 v137, s86, v137
    v_mfma_f32_16x16x32_bf16 v[204:207], v[176:179], a[52:55], v[204:207]
    ds_read_b64_tr_b16 v[196:197], v253 offset:8192
    v_mul_f32 v138, s86, v138
    v_mfma_f32_16x16x32_bf16 v[204:207], v[180:183], a[60:63], v[204:207]
    ds_read_b64_tr_b16 v[198:199], v253 offset:8704
    s_waitcnt lgkmcnt(4)
    v_mfma_f32_16x16x32_bf16 v[200:203], v[180:183], a[56:59], v[200:203]
    v_pk_max_i16 v239, v239, 0
    v_mul_f32 v139, s86, v139
    v_mfma_f32_16x16x32_bf16 v[200:203], v[176:179], a[48:51], v[200:203]
    v_cvt_pk_bf16_f32 v120, v120, v121
    v_cvt_pk_bf16_f32 v121, v122, v123
    v_mfma_f32_16x16x32_bf16 v[200:203], v[184:187], a[64:67], v[200:203]
    ds_read_b64_tr_b16 v[176:177], v253 offset:12288
    v_add_u32 v251, 36864, v250
    v_mfma_f32_16x16x32_bf16 v[200:203], v[188:191], a[72:75], v[200:203]
    ds_read_b64_tr_b16 v[178:179], v253 offset:12800
    v_cvt_pk_bf16_f32 v122, v136, v137
    v_mfma_f32_16x16x32_bf16 v[204:207], v[188:191], a[76:79], v[204:207]
    buffer_store_dwordx4 v[236:239], v11, s[16:19], s84 offen offset:0 sc1
    v_mfma_f32_16x16x32_bf16 v[204:207], v[184:187], a[68:71], v[204:207]
    v_cvt_pk_bf16_f32 v123, v138, v139
    v_mul_f32 v124, s86, v124
    v_mfma_f32_16x16x32_bf16 v[208:211], v[184:187], a[192:195], v[208:211]
    ds_read_b64_tr_b16 v[180:181], v253 offset:16384
    v_cvt_pk_bf16_f32 v242, v224, v225
    v_mfma_f32_16x16x32_bf16 v[208:211], v[188:191], a[200:203], v[208:211]
    ds_read_b64_tr_b16 v[182:183], v253 offset:16896
    s_waitcnt lgkmcnt(4)
    v_mfma_f32_16x16x32_bf16 v[212:215], v[188:191], a[204:207], v[212:215]
    v_cvt_pk_bf16_f32 v243, v226, v227
    v_mul_f32 v125, s86, v125
    v_mfma_f32_16x16x32_bf16 v[212:215], v[184:187], a[196:199], v[212:215]
    v_mul_f32 v126, s86, v126
    v_mul_f32 v127, s86, v127
    v_mfma_f32_16x16x32_bf16 v[212:215], v[192:195], a[212:215], v[212:215]
    ds_read_b64_tr_b16 v[184:185], v253 offset:20480
    v_mul_f32 v140, s86, v140
    v_mfma_f32_16x16x32_bf16 v[212:215], v[196:199], a[220:223], v[212:215]
    ds_read_b64_tr_b16 v[186:187], v253 offset:20992
    v_pk_max_i16 v242, v242, 0
    v_mfma_f32_16x16x32_bf16 v[208:211], v[196:199], a[216:219], v[208:211]
    v_mul_f32 v141, s86, v141
    v_mul_f32 v142, s86, v142
    v_mfma_f32_16x16x32_bf16 v[208:211], v[192:195], a[208:211], v[208:211]
    v_mul_f32 v143, s86, v143
    v_cvt_pk_bf16_f32 v124, v124, v125
    v_mfma_f32_16x16x32_bf16 v[204:207], v[192:195], a[84:87], v[204:207]
    ds_read_b64_tr_b16 v[188:189], v253 offset:24576
    v_pk_max_i16 v243, v243, 0
    v_mfma_f32_16x16x32_bf16 v[204:207], v[196:199], a[92:95], v[204:207]
    ds_read_b64_tr_b16 v[190:191], v253 offset:25088
    s_waitcnt lgkmcnt(4)
    v_mfma_f32_16x16x32_bf16 v[200:203], v[196:199], a[88:91], v[200:203]
    v_cvt_pk_bf16_f32 v125, v126, v127
    v_cvt_pk_bf16_f32 v126, v140, v141
    v_mfma_f32_16x16x32_bf16 v[200:203], v[192:195], a[80:83], v[200:203]
    buffer_store_dwordx4 v[240:243], v12, s[16:19], s84 offen offset:0 sc1
    v_mfma_f32_16x16x32_bf16 v[200:203], v[176:179], a[96:99], v[200:203]
    ds_read_b64_tr_b16 v[192:193], v253 offset:28672
    v_cvt_pk_bf16_f32 v127, v142, v143
    v_mfma_f32_16x16x32_bf16 v[200:203], v[180:183], a[104:107], v[200:203]
    ds_read_b64_tr_b16 v[194:195], v253 offset:29184
    v_mul_f32 v144, s86, v144
    v_mfma_f32_16x16x32_bf16 v[204:207], v[180:183], a[108:111], v[204:207]
    v_cvt_pk_bf16_f32 v246, v228, v229
    v_mul_f32 v145, s86, v145
    v_mfma_f32_16x16x32_bf16 v[204:207], v[176:179], a[100:103], v[204:207]
    v_mul_f32 v146, s86, v146
    v_mul_f32 v147, s86, v147
    v_mfma_f32_16x16x32_bf16 v[208:211], v[176:179], a[224:227], v[208:211]
    ds_read_b64_tr_b16 v[196:197], v253 offset:32768
    v_cvt_pk_bf16_f32 v247, v230, v231
    v_mfma_f32_16x16x32_bf16 v[208:211], v[180:183], a[232:235], v[208:211]
    ds_read_b64_tr_b16 v[198:199], v253 offset:33280
    s_waitcnt lgkmcnt(4)
    v_mfma_f32_16x16x32_bf16 v[212:215], v[180:183], a[236:239], v[212:215]
    v_mul_f32 v160, s86, v160
    v_mul_f32 v161, s86, v161
    v_mfma_f32_16x16x32_bf16 v[212:215], v[176:179], a[228:231], v[212:215]
    v_pk_max_i16 v246, v246, 0
    v_mul_f32 v162, s86, v162
    v_mfma_f32_16x16x32_bf16 v[212:215], v[184:187], a[244:247], v[212:215]
    ds_read_b64_tr_b16 v[176:177], v250 offset:0
    v_mul_f32 v163, s86, v163
    v_mfma_f32_16x16x32_bf16 v[212:215], v[188:191], a[252:255], v[212:215]
    ds_read_b64_tr_b16 v[178:179], v250 offset:512
    v_cvt_pk_bf16_f32 v144, v144, v145
    v_mfma_f32_16x16x32_bf16 v[208:211], v[188:191], a[248:251], v[208:211]
    v_pk_max_i16 v247, v247, 0
    v_cvt_pk_bf16_f32 v145, v146, v147
    v_mfma_f32_16x16x32_bf16 v[208:211], v[184:187], a[240:243], v[208:211]
    v_cvt_pk_bf16_f32 v146, v160, v161
    v_cvt_pk_bf16_f32 v147, v162, v163
    v_mfma_f32_16x16x32_bf16 v[204:207], v[184:187], a[116:119], v[204:207]
    ds_read_b64_tr_b16 v[180:181], v250 offset:4096
    v_mul_f32 v148, s86, v148
    v_mfma_f32_16x16x32_bf16 v[204:207], v[188:191], a[124:127], v[204:207]
    ds_read_b64_tr_b16 v[182:183], v250 offset:4608
    s_waitcnt lgkmcnt(4)
    v_mfma_f32_16x16x32_bf16 v[200:203], v[188:191], a[120:123], v[200:203]
    buffer_store_dwordx4 v[244:247], v13, s[16:19], s84 offen offset:0 sc1
    v_mfma_f32_16x16x32_bf16 v[200:203], v[184:187], a[112:115], v[200:203]
    v_mul_f32 v149, s86, v149
    v_mul_f32 v150, s86, v150
    v_mfma_f32_16x16x32_bf16 v[200:203], v[192:195], v[16:19], v[200:203]
    ds_read_b64_tr_b16 v[184:185], v250 offset:8192
    v_xor_b32 v252, 0, v5
    v_mfma_f32_16x16x32_bf16 v[200:203], v[196:199], v[24:27], v[200:203]
    ds_read_b64_tr_b16 v[186:187], v250 offset:8704
    v_mul_f32 v151, s86, v151
    v_mfma_f32_16x16x32_bf16 v[204:207], v[196:199], v[28:31], v[204:207]
    v_mul_f32 v164, s86, v164
    v_mul_f32 v165, s86, v165
    v_mfma_f32_16x16x32_bf16 v[204:207], v[192:195], v[20:23], v[204:207]
    v_mul_f32 v166, s86, v166
    v_mul_f32 v167, s86, v167
    v_mfma_f32_16x16x32_bf16 v[208:211], v[192:195], v[32:35], v[208:211]
    ds_read_b64_tr_b16 v[188:189], v250 offset:12288
    v_cvt_pk_bf16_f32 v148, v148, v149
    v_mfma_f32_16x16x32_bf16 v[208:211], v[196:199], v[40:43], v[208:211]
    ds_read_b64_tr_b16 v[190:191], v250 offset:12800
    s_waitcnt lgkmcnt(4)
    v_mfma_f32_16x16x32_bf16 v[212:215], v[196:199], v[44:47], v[212:215]
    v_cvt_pk_bf16_f32 v149, v150, v151
    v_cvt_pk_bf16_f32 v150, v164, v165
    v_mfma_f32_16x16x32_bf16 v[212:215], v[192:195], v[36:39], v[212:215]
    v_cvt_pk_bf16_f32 v151, v166, v167
    v_mul_f32 v152, s86, v152
    v_mfma_f32_16x16x32_bf16 v[216:219], v[176:179], a[0:3], 0
    ds_read_b64_tr_b16 v[192:193], v250 offset:16384
    v_mul_f32 v153, s86, v153
    v_mfma_f32_16x16x32_bf16 v[216:219], v[180:183], a[8:11], v[216:219]
    ds_read_b64_tr_b16 v[194:195], v250 offset:16896
    v_mul_f32 v154, s86, v154
    v_mfma_f32_16x16x32_bf16 v[220:223], v[176:179], a[4:7], 0
    v_mul_f32 v155, s86, v155
    v_mul_f32 v168, s86, v168
    v_mfma_f32_16x16x32_bf16 v[220:223], v[180:183], a[12:15], v[220:223]
    v_mul_f32 v169, s86, v169
    v_mul_f32 v170, s86, v170
    v_mfma_f32_16x16x32_bf16 v[224:227], v[176:179], a[128:131], 0
    ds_read_b64_tr_b16 v[196:197], v250 offset:20480
    v_mul_f32 v171, s86, v171
    v_mfma_f32_16x16x32_bf16 v[224:227], v[180:183], a[136:139], v[224:227]
    ds_read_b64_tr_b16 v[198:199], v250 offset:20992
    s_waitcnt lgkmcnt(4)
    v_mfma_f32_16x16x32_bf16 v[228:231], v[176:179], a[132:135], 0
    v_cvt_pk_bf16_f32 v152, v152, v153
    v_cvt_pk_bf16_f32 v153, v154, v155
    v_mfma_f32_16x16x32_bf16 v[228:231], v[180:183], a[140:143], v[228:231]
    v_cvt_pk_bf16_f32 v154, v168, v169
    v_cvt_pk_bf16_f32 v155, v170, v171
    v_mfma_f32_16x16x32_bf16 v[228:231], v[184:187], a[148:151], v[228:231]
    ds_read_b64_tr_b16 v[176:177], v250 offset:24576
    v_cvt_pk_bf16_f32 v232, v200, v201
    v_mfma_f32_16x16x32_bf16 v[228:231], v[188:191], a[156:159], v[228:231]
    ds_read_b64_tr_b16 v[178:179], v250 offset:25088
    v_mul_f32 v156, s86, v156
    v_mfma_f32_16x16x32_bf16 v[224:227], v[188:191], a[152:155], v[224:227]
    s_waitcnt vmcnt(4)
    v_cmp_ne_u32 vcc, v14, v7
    s_nop 0
    s_cbranch_vccnz KF_ck6
KF_cr7:
    v_mfma_f32_16x16x32_bf16 v[224:227], v[184:187], a[144:147], v[224:227]
    v_add_u32 v252, 73728, v252
    v_cvt_pk_bf16_f32 v233, v202, v203
    v_mfma_f32_16x16x32_bf16 v[220:223], v[184:187], a[20:23], v[220:223]
    ds_read_b64_tr_b16 v[180:181], v250 offset:28672
    v_mul_f32 v157, s86, v157
    v_mfma_f32_16x16x32_bf16 v[220:223], v[188:191], a[28:31], v[220:223]
    ds_read_b64_tr_b16 v[182:183], v250 offset:29184
    s_waitcnt lgkmcnt(4)
    v_mfma_f32_16x16x32_bf16 v[216:219], v[188:191], a[24:27], v[216:219]
    s_lshl_b32 s72, s3, 12
    s_add_u32 s70, s82, s72
    v_mul_f32 v158, s86, v158
    v_mfma_f32_16x16x32_bf16 v[216:219], v[184:187], a[16:19], v[216:219]
    v_pk_max_i16 v232, v232, 0
    v_mul_f32 v159, s86, v159
    v_mfma_f32_16x16x32_bf16 v[216:219], v[192:195], a[32:35], v[216:219]
    ds_read_b64_tr_b16 v[184:185], v250 offset:32768
    v_mul_f32 v172, s86, v172
    v_mfma_f32_16x16x32_bf16 v[216:219], v[196:199], a[40:43], v[216:219]
    ds_read_b64_tr_b16 v[186:187], v250 offset:33280
    v_mul_f32 v173, s86, v173
    v_mfma_f32_16x16x32_bf16 v[220:223], v[196:199], a[44:47], v[220:223]
    v_pk_max_i16 v233, v233, 0
    v_mul_f32 v174, s86, v174
    v_mfma_f32_16x16x32_bf16 v[220:223], v[192:195], a[36:39], v[220:223]
    s_add_u32 m0, s72, 147456
    s_add_u32 s68, s70, 0
    v_mul_f32 v175, s86, v175
    v_mfma_f32_16x16x32_bf16 v[224:227], v[192:195], a[160:163], v[224:227]
    ds_read_b64_tr_b16 v[188:189], v251 offset:0
    v_cvt_pk_bf16_f32 v156, v156, v157
    v_mfma_f32_16x16x32_bf16 v[224:227], v[196:199], a[168:171], v[224:227]
    ds_read_b64_tr_b16 v[190:191], v251 offset:512
    s_waitcnt lgkmcnt(4)
    v_mfma_f32_16x16x32_bf16 v[228:231], v[196:199], a[172:175], v[228:231]
    v_cvt_pk_bf16_f32 v236, v204, v205
    v_cvt_pk_bf16_f32 v157, v158, v159
    v_mfma_f32_16x16x32_bf16 v[228:231], v[192:195], a[164:167], v[228:231]
    v_cvt_pk_bf16_f32 v158, v172, v173
    v_cvt_pk_bf16_f32 v159, v174, v175
    v_mfma_f32_16x16x32_bf16 v[228:231], v[176:179], a[180:183], v[228:231]
    ds_read_b64_tr_b16 v[192:193], v251 offset:4096
    v_mfma_f32_16x16x32_bf16 v[228:231], v[180:183], a[188:191], v[228:231]
    ds_read_b64_tr_b16 v[194:195], v251 offset:4608
    v_cvt_pk_bf16_f32 v237, v206, v207
    v_mfma_f32_16x16x32_bf16 v[224:227], v[180:183], a[184:187], v[224:227]
    buffer_load_dwordx4 v1, s[20:23], s68 offen offset:0 sc1 lds
    v_mfma_f32_16x16x32_bf16 v[224:227], v[176:179], a[176:179], v[224:227]
    v_mfma_f32_16x16x32_bf16 v[220:223], v[176:179], a[52:55], v[220:223]
    ds_read_b64_tr_b16 v[196:197], v251 offset:8192
    v_mfma_f32_16x16x32_bf16 v[220:223], v[180:183], a[60:63], v[220:223]
    ds_read_b64_tr_b16 v[198:199], v251 offset:8704
    s_waitcnt lgkmcnt(4)
    v_mfma_f32_16x16x32_bf16 v[216:219], v[180:183], a[56:59], v[216:219]
    v_add_u32 v253, 36864, v252
    v_pk_max_i16 v236, v236, 0
    v_mfma_f32_16x16x32_bf16 v[216:219], v[176:179], a[48:51], v[216:219]
    v_mfma_f32_16x16x32_bf16 v[216:219], v[184:187], a[64:67], v[216:219]
    ds_read_b64_tr_b16 v[176:177], v251 offset:12288
    v_pk_max_i16 v237, v237, 0
    v_mfma_f32_16x16x32_bf16 v[216:219], v[188:191], a[72:75], v[216:219]
    ds_read_b64_tr_b16 v[178:179], v251 offset:12800
    v_mfma_f32_16x16x32_bf16 v[220:223], v[188:191], a[76:79], v[220:223]
    buffer_load_dwordx4 v1, s[20:23], s68 offen offset:1024 sc1 lds
    v_mfma_f32_16x16x32_bf16 v[220:223], v[184:187], a[68:71], v[220:223]
    v_mfma_f32_16x16x32_bf16 v[224:227], v[184:187], a[192:195], v[224:227]
    ds_read_b64_tr_b16 v[180:181], v251 offset:16384
    v_cvt_pk_bf16_f32 v240, v208, v209
    v_mfma_f32_16x16x32_bf16 v[224:227], v[188:191], a[200:203], v[224:227]
    ds_read_b64_tr_b16 v[182:183], v251 offset:16896
    s_waitcnt lgkmcnt(4)
    v_mfma_f32_16x16x32_bf16 v[228:231], v[188:191], a[204:207], v[228:231]
    v_mfma_f32_16x16x32_bf16 v[228:231], v[184:187], a[196:199], v[228:231]
    v_cvt_pk_bf16_f32 v241, v210, v211
    v_mfma_f32_16x16x32_bf16 v[228:231], v[192:195], a[212:215], v[228:231]
    ds_read_b64_tr_b16 v[184:185], v251 offset:20480
    v_mfma_f32_16x16x32_bf16 v[228:231], v[196:199], a[220:223], v[228:231]
    ds_read_b64_tr_b16 v[186:187], v251 offset:20992
    v_mfma_f32_16x16x32_bf16 v[224:227], v[196:199], a[216:219], v[224:227]
    s_barrier
    v_mfma_f32_16x16x32_bf16 v[224:227], v[192:195], a[208:211], v[224:227]
    buffer_load_dwordx4 v1, s[20:23], s68 offen offset:2048 sc1 lds
    v_mfma_f32_16x16x32_bf16 v[220:223], v[192:195], a[84:87], v[220:223]
    ds_read_b64_tr_b16 v[188:189], v251 offset:24576
    v_pk_max_i16 v240, v240, 0
    v_mfma_f32_16x16x32_bf16 v[220:223], v[196:199], a[92:95], v[220:223]
    ds_read_b64_tr_b16 v[190:191], v251 offset:25088
    s_waitcnt lgkmcnt(4)
    v_mfma_f32_16x16x32_bf16 v[216:219], v[196:199], a[88:91], v[216:219]
    v_pk_max_i16 v241, v241, 0
    v_mfma_f32_16x16x32_bf16 v[216:219], v[192:195], a[80:83], v[216:219]
    v_mfma_f32_16x16x32_bf16 v[216:219], v[176:179], a[96:99], v[216:219]
    ds_read_b64_tr_b16 v[192:193], v251 offset:28672
    v_mfma_f32_16x16x32_bf16 v[216:219], v[180:183], a[104:107], v[216:219]
    ds_read_b64_tr_b16 v[194:195], v251 offset:29184
    v_mfma_f32_16x16x32_bf16 v[220:223], v[180:183], a[108:111], v[220:223]
    buffer_load_dwordx4 v1, s[20:23], s68 offen offset:3072 sc1 lds
    v_mfma_f32_16x16x32_bf16 v[220:223], v[176:179], a[100:103], v[220:223]
    v_cvt_pk_bf16_f32 v244, v212, v213
    v_mfma_f32_16x16x32_bf16 v[224:227], v[176:179], a[224:227], v[224:227]
    ds_read_b64_tr_b16 v[196:197], v251 offset:32768
    v_mfma_f32_16x16x32_bf16 v[224:227], v[180:183], a[232:235], v[224:227]
    ds_read_b64_tr_b16 v[198:199], v251 offset:33280
    s_waitcnt lgkmcnt(4)
    v_mfma_f32_16x16x32_bf16 v[228:231], v[180:183], a[236:239], v[228:231]
    v_cvt_pk_bf16_f32 v245, v214, v215
    v_mfma_f32_16x16x32_bf16 v[228:231], v[176:179], a[228:231], v[228:231]
    v_mfma_f32_16x16x32_bf16 v[228:231], v[184:187], a[244:247], v[228:231]
    ds_read_b64_tr_b16 v[176:177], v252 offset:0
    s_add_u32 s92, s82, s81
    v_mfma_f32_16x16x32_bf16 v[228:231], v[188:191], a[252:255], v[228:231]
    ds_read_b64_tr_b16 v[178:179], v252 offset:512
    v_pk_max_i16 v244, v244, 0
    v_mfma_f32_16x16x32_bf16 v[224:227], v[188:191], a[248:251], v[224:227]
    v_mfma_f32_16x16x32_bf16 v[224:227], v[184:187], a[240:243], v[224:227]
    v_mfma_f32_16x16x32_bf16 v[220:223], v[184:187], a[116:119], v[220:223]
    ds_read_b64_tr_b16 v[180:181], v252 offset:4096
    v_pk_max_i16 v245, v245, 0
    v_mfma_f32_16x16x32_bf16 v[220:223], v[188:191], a[124:127], v[220:223]
    ds_read_b64_tr_b16 v[182:183], v252 offset:4608
    s_waitcnt lgkmcnt(4)
    v_mfma_f32_16x16x32_bf16 v[216:219], v[188:191], a[120:123], v[216:219]
    v_mfma_f32_16x16x32_bf16 v[216:219], v[184:187], a[112:115], v[216:219]
    v_mfma_f32_16x16x32_bf16 v[216:219], v[192:195], v[16:19], v[216:219]
    ds_read_b64_tr_b16 v[184:185], v252 offset:8192
    v_mfma_f32_16x16x32_bf16 v[216:219], v[196:199], v[24:27], v[216:219]
    ds_read_b64_tr_b16 v[186:187], v252 offset:8704
    v_mfma_f32_16x16x32_bf16 v[220:223], v[196:199], v[28:31], v[220:223]
    s_lshl_b32 s72, s63, 2
    s_add_u32 s72, s72, s65
    v_mfma_f32_16x16x32_bf16 v[220:223], v[192:195], v[20:23], v[220:223]
    v_mfma_f32_16x16x32_bf16 v[224:227], v[192:195], v[32:35], v[224:227]
    ds_read_b64_tr_b16 v[188:189], v252 offset:12288
    v_mfma_f32_16x16x32_bf16 v[224:227], v[196:199], v[40:43], v[224:227]
    ds_read_b64_tr_b16 v[190:191], v252 offset:12800
    s_waitcnt lgkmcnt(4)
    v_mfma_f32_16x16x32_bf16 v[228:231], v[196:199], v[44:47], v[228:231]
    s_lshl_b32 s72, s72, 2
    s_add_u32 s72, s72, s3
    v_mfma_f32_16x16x32_bf16 v[228:231], v[192:195], v[36:39], v[228:231]
    v_mfma_f32_16x16x32_bf16 v[200:203], v[176:179], a[0:3], 0
    ds_read_b64_tr_b16 v[192:193], v252 offset:16384
    v_xor_b32 v250, 32, v5
    v_mfma_f32_16x16x32_bf16 v[200:203], v[180:183], a[8:11], v[200:203]
    ds_read_b64_tr_b16 v[194:195], v252 offset:16896
    v_mfma_f32_16x16x32_bf16 v[204:207], v[176:179], a[4:7], 0
    s_mul_i32 s78, s72, 172032
    s_add_u32 s78, s78, 67108864
    v_mfma_f32_16x16x32_bf16 v[204:207], v[180:183], a[12:15], v[204:207]
    v_mfma_f32_16x16x32_bf16 v[208:211], v[176:179], a[128:131], 0
    ds_read_b64_tr_b16 v[196:197], v252 offset:20480
    v_mfma_f32_16x16x32_bf16 v[208:211], v[180:183], a[136:139], v[208:211]
    ds_read_b64_tr_b16 v[198:199], v252 offset:20992
    s_waitcnt lgkmcnt(4)
    v_mfma_f32_16x16x32_bf16 v[212:215], v[176:179], a[132:135], 0
    s_barrier
    v_mfma_f32_16x16x32_bf16 v[212:215], v[180:183], a[140:143], v[212:215]
    s_mul_i32 s73, s64, 21504
    s_add_u32 s74, s78, s73
    v_mfma_f32_16x16x32_bf16 v[212:215], v[184:187], a[148:151], v[212:215]
    ds_read_b64_tr_b16 v[176:177], v252 offset:24576
    v_cvt_pk_bf16_f32 v234, v216, v217
    v_mfma_f32_16x16x32_bf16 v[212:215], v[188:191], a[156:159], v[212:215]
    ds_read_b64_tr_b16 v[178:179], v252 offset:25088
    v_mfma_f32_16x16x32_bf16 v[208:211], v[188:191], a[152:155], v[208:211]
    s_add_u32 m0, s81, 0
    s_add_u32 s68, s80, 0
    v_cvt_pk_bf16_f32 v235, v218, v219
    v_mfma_f32_16x16x32_bf16 v[208:211], v[184:187], a[144:147], v[208:211]
    s_add_u32 s75, s74, 5120
    s_add_u32 s76, s74, 10240
    v_mfma_f32_16x16x32_bf16 v[204:207], v[184:187], a[20:23], v[204:207]
    ds_read_b64_tr_b16 v[180:181], v252 offset:28672
    v_mfma_f32_16x16x32_bf16 v[204:207], v[188:191], a[28:31], v[204:207]
    ds_read_b64_tr_b16 v[182:183], v252 offset:29184
    s_waitcnt lgkmcnt(4)
    v_mfma_f32_16x16x32_bf16 v[200:203], v[188:191], a[24:27], v[200:203]
    buffer_load_dwordx4 v3, s[12:15], s68 offen lds
    v_mfma_f32_16x16x32_bf16 v[200:203], v[184:187], a[16:19], v[200:203]
    s_add_u32 s77, s74, 15360
    s_mov_b32 s95, s74
    v_pk_max_i16 v234, v234, 0
    v_mfma_f32_16x16x32_bf16 v[200:203], v[192:195], a[32:35], v[200:203]
    ds_read_b64_tr_b16 v[184:185], v252 offset:32768
    v_add_u32 v250, 73728, v250
    v_mfma_f32_16x16x32_bf16 v[200:203], v[196:199], a[40:43], v[200:203]
    ds_read_b64_tr_b16 v[186:187], v252 offset:33280
    v_mov_b32 v248, v4
    v_mfma_f32_16x16x32_bf16 v[204:207], v[196:199], a[44:47], v[204:207]
    s_add_u32 m0, s81, 1024
    s_add_u32 s68, s80, 147456
    v_pk_max_i16 v235, v235, 0
    v_mfma_f32_16x16x32_bf16 v[204:207], v[192:195], a[36:39], v[204:207]
    buffer_store_dwordx4 v[232:235], v10, s[16:19], s84 offen offset:1024 sc1
    v_mfma_f32_16x16x32_bf16 v[208:211], v[192:195], a[160:163], v[208:211]
    ds_read_b64_tr_b16 v[188:189], v253 offset:0
    v_mfma_f32_16x16x32_bf16 v[208:211], v[196:199], a[168:171], v[208:211]
    ds_read_b64_tr_b16 v[190:191], v253 offset:512
    s_waitcnt lgkmcnt(4)
    v_mfma_f32_16x16x32_bf16 v[212:215], v[196:199], a[172:175], v[212:215]
    v_cvt_pk_bf16_f32 v238, v220, v221
    v_mfma_f32_16x16x32_bf16 v[212:215], v[192:195], a[164:167], v[212:215]
    v_mfma_f32_16x16x32_bf16 v[212:215], v[176:179], a[180:183], v[212:215]
    ds_read_b64_tr_b16 v[192:193], v253 offset:4096
    v_cvt_pk_bf16_f32 v239, v222, v223
    v_mfma_f32_16x16x32_bf16 v[212:215], v[180:183], a[188:191], v[212:215]
    ds_read_b64_tr_b16 v[194:195], v253 offset:4608
    v_mfma_f32_16x16x32_bf16 v[208:211], v[180:183], a[184:187], v[208:211]
    buffer_load_dwordx4 v3, s[12:15], s68 offen lds
    v_mfma_f32_16x16x32_bf16 v[208:211], v[176:179], a[176:179], v[208:211]
    v_pk_max_i16 v238, v238, 0
    v_mfma_f32_16x16x32_bf16 v[204:207], v[176:179], a[52:55], v[204:207]
    ds_read_b64_tr_b16 v[196:197], v253 offset:8192
    v_mfma_f32_16x16x32_bf16 v[204:207], v[180:183], a[60:63], v[204:207]
    ds_read_b64_tr_b16 v[198:199], v253 offset:8704
    s_waitcnt lgkmcnt(4)
    v_mfma_f32_16x16x32_bf16 v[200:203], v[180:183], a[56:59], v[200:203]
    s_add_u32 m0, s81, 2048
    s_add_u32 s68, s80, 294912
    v_pk_max_i16 v239, v239, 0
    v_mfma_f32_16x16x32_bf16 v[200:203], v[176:179], a[48:51], v[200:203]
    v_mfma_f32_16x16x32_bf16 v[200:203], v[184:187], a[64:67], v[200:203]
    ds_read_b64_tr_b16 v[176:177], v253 offset:12288
    v_add_u32 v251, 36864, v250
    v_mfma_f32_16x16x32_bf16 v[200:203], v[188:191], a[72:75], v[200:203]
    ds_read_b64_tr_b16 v[178:179], v253 offset:12800
    v_mfma_f32_16x16x32_bf16 v[204:207], v[188:191], a[76:79], v[204:207]
    buffer_load_dwordx4 v3, s[12:15], s68 offen lds
    v_mfma_f32_16x16x32_bf16 v[204:207], v[184:187], a[68:71], v[204:207]
    buffer_store_dwordx4 v[236:239], v11, s[16:19], s84 offen offset:1024 sc1
    v_mfma_f32_16x16x32_bf16 v[208:211], v[184:187], a[192:195], v[208:211]
    ds_read_b64_tr_b16 v[180:181], v253 offset:16384
    v_cvt_pk_bf16_f32 v242, v224, v225
    v_mfma_f32_16x16x32_bf16 v[208:211], v[188:191], a[200:203], v[208:211]
    ds_read_b64_tr_b16 v[182:183], v253 offset:16896
    s_waitcnt lgkmcnt(4)
    v_mfma_f32_16x16x32_bf16 v[212:215], v[188:191], a[204:207], v[212:215]
    v_cvt_pk_bf16_f32 v243, v226, v227
    v_mfma_f32_16x16x32_bf16 v[212:215], v[184:187], a[196:199], v[212:215]
    v_mfma_f32_16x16x32_bf16 v[212:215], v[192:195], a[212:215], v[212:215]
    ds_read_b64_tr_b16 v[184:185], v253 offset:20480
    v_mfma_f32_16x16x32_bf16 v[212:215], v[196:199], a[220:223], v[212:215]
    ds_read_b64_tr_b16 v[186:187], v253 offset:20992
    v_pk_max_i16 v242, v242, 0
    v_mfma_f32_16x16x32_bf16 v[208:211], v[196:199], a[216:219], v[208:211]
    s_add_u32 m0, s81, 3072
    s_add_u32 s68, s80, 442368
    v_mfma_f32_16x16x32_bf16 v[208:211], v[192:195], a[208:211], v[208:211]
    v_mfma_f32_16x16x32_bf16 v[204:207], v[192:195], a[84:87], v[204:207]
    ds_read_b64_tr_b16 v[188:189], v253 offset:24576
    v_pk_max_i16 v243, v243, 0
    v_mfma_f32_16x16x32_bf16 v[204:207], v[196:199], a[92:95], v[204:207]
    ds_read_b64_tr_b16 v[190:191], v253 offset:25088
    s_waitcnt lgkmcnt(4)
    v_mfma_f32_16x16x32_bf16 v[200:203], v[196:199], a[88:91], v[200:203]
    buffer_load_dwordx4 v3, s[12:15], s68 offen lds
    v_mfma_f32_16x16x32_bf16 v[200:203], v[192:195], a[80:83], v[200:203]
    buffer_store_dwordx4 v[240:243], v12, s[16:19], s84 offen offset:1024 sc1
    v_mfma_f32_16x16x32_bf16 v[200:203], v[176:179], a[96:99], v[200:203]
    ds_read_b64_tr_b16 v[192:193], v253 offset:28672
    v_xor_b32 v249, 32, v4
    v_mfma_f32_16x16x32_bf16 v[200:203], v[180:183], a[104:107], v[200:203]
    ds_read_b64_tr_b16 v[194:195], v253 offset:29184
    v_mfma_f32_16x16x32_bf16 v[204:207], v[180:183], a[108:111], v[204:207]
    s_add_u32 m0, s81, 4096
    s_add_u32 s68, s80, 589824
    v_cvt_pk_bf16_f32 v246, v228, v229
    v_mfma_f32_16x16x32_bf16 v[204:207], v[176:179], a[100:103], v[204:207]
    v_mfma_f32_16x16x32_bf16 v[208:211], v[176:179], a[224:227], v[208:211]
    ds_read_b64_tr_b16 v[196:197], v253 offset:32768
    v_cvt_pk_bf16_f32 v247, v230, v231
    v_mfma_f32_16x16x32_bf16 v[208:211], v[180:183], a[232:235], v[208:211]
    ds_read_b64_tr_b16 v[198:199], v253 offset:33280
    s_waitcnt lgkmcnt(4)
    v_mfma_f32_16x16x32_bf16 v[212:215], v[180:183], a[236:239], v[212:215]
    v_mfma_f32_16x16x32_bf16 v[212:215], v[176:179], a[228:231], v[212:215]
    v_pk_max_i16 v246, v246, 0
    v_mfma_f32_16x16x32_bf16 v[212:215], v[184:187], a[244:247], v[212:215]
    ds_read_b64_tr_b16 v[176:177], v250 offset:0
    v_mfma_f32_16x16x32_bf16 v[212:215], v[188:191], a[252:255], v[212:215]
    ds_read_b64_tr_b16 v[178:179], v250 offset:512
    v_mfma_f32_16x16x32_bf16 v[208:211], v[188:191], a[248:251], v[208:211]
    buffer_load_dwordx4 v3, s[12:15], s68 offen lds
    v_mfma_f32_16x16x32_bf16 v[208:211], v[184:187], a[240:243], v[208:211]
    v_pk_max_i16 v247, v247, 0
    v_mfma_f32_16x16x32_bf16 v[204:207], v[184:187], a[116:119], v[204:207]
    ds_read_b64_tr_b16 v[180:181], v250 offset:4096
    v_mfma_f32_16x16x32_bf16 v[204:207], v[188:191], a[124:127], v[204:207]
    ds_read_b64_tr_b16 v[182:183], v250 offset:4608
    s_waitcnt lgkmcnt(4)
    v_mfma_f32_16x16x32_bf16 v[200:203], v[188:191], a[120:123], v[200:203]
    s_add_u32 m0, s81, 5120
    s_add_u32 s68, s80, 737280
    v_mfma_f32_16x16x32_bf16 v[200:203], v[184:187], a[112:115], v[200:203]
    buffer_store_dwordx4 v[244:247], v13, s[16:19], s84 offen offset:1024 sc1
    v_mfma_f32_16x16x32_bf16 v[200:203], v[192:195], v[16:19], v[200:203]
    ds_read_b64_tr_b16 v[184:185], v250 offset:8192
    v_xor_b32 v252, 64, v5
    v_mfma_f32_16x16x32_bf16 v[200:203], v[196:199], v[24:27], v[200:203]
    ds_read_b64_tr_b16 v[186:187], v250 offset:8704
    v_mfma_f32_16x16x32_bf16 v[204:207], v[196:199], v[28:31], v[204:207]
    buffer_load_dwordx4 v3, s[12:15], s68 offen lds
    v_mfma_f32_16x16x32_bf16 v[204:207], v[192:195], v[20:23], v[204:207]
    v_mfma_f32_16x16x32_bf16 v[208:211], v[192:195], v[32:35], v[208:211]
    ds_read_b64_tr_b16 v[188:189], v250 offset:12288
    v_mfma_f32_16x16x32_bf16 v[208:211], v[196:199], v[40:43], v[208:211]
    ds_read_b64_tr_b16 v[190:191], v250 offset:12800
    s_waitcnt lgkmcnt(4)
    v_mfma_f32_16x16x32_bf16 v[212:215], v[196:199], v[44:47], v[212:215]
    v_mfma_f32_16x16x32_bf16 v[212:215], v[192:195], v[36:39], v[212:215]
    v_mfma_f32_16x16x32_bf16 v[216:219], v[176:179], a[0:3], 0
    ds_read_b64_tr_b16 v[192:193], v250 offset:16384
    v_mfma_f32_16x16x32_bf16 v[216:219], v[180:183], a[8:11], v[216:219]
    ds_read_b64_tr_b16 v[194:195], v250 offset:16896
    v_mfma_f32_16x16x32_bf16 v[220:223], v[176:179], a[4:7], 0
    s_add_u32 m0, s81, 6144
    s_add_u32 s68, s80, 884736
    v_mfma_f32_16x16x32_bf16 v[220:223], v[180:183], a[12:15], v[220:223]
    v_mfma_f32_16x16x32_bf16 v[224:227], v[176:179], a[128:131], 0
    ds_read_b64_tr_b16 v[196:197], v250 offset:20480
    v_mfma_f32_16x16x32_bf16 v[224:227], v[180:183], a[136:139], v[224:227]
    ds_read_b64_tr_b16 v[198:199], v250 offset:20992
    s_waitcnt lgkmcnt(4)
    v_mfma_f32_16x16x32_bf16 v[228:231], v[176:179], a[132:135], 0
    buffer_load_dwordx4 v3, s[12:15], s68 offen lds
    v_mfma_f32_16x16x32_bf16 v[228:231], v[180:183], a[140:143], v[228:231]
    v_mfma_f32_16x16x32_bf16 v[228:231], v[184:187], a[148:151], v[228:231]
    ds_read_b64_tr_b16 v[176:177], v250 offset:24576
    v_cvt_pk_bf16_f32 v232, v200, v201
    v_mfma_f32_16x16x32_bf16 v[228:231], v[188:191], a[156:159], v[228:231]
    ds_read_b64_tr_b16 v[178:179], v250 offset:25088
    v_mfma_f32_16x16x32_bf16 v[224:227], v[188:191], a[152:155], v[224:227]
    s_add_u32 m0, s81, 7168
    s_add_u32 s68, s80, 1032192
    v_add_u32 v252, 73728, v252
    v_mfma_f32_16x16x32_bf16 v[224:227], v[184:187], a[144:147], v[224:227]
    v_cvt_pk_bf16_f32 v233, v202, v203
    v_mfma_f32_16x16x32_bf16 v[220:223], v[184:187], a[20:23], v[220:223]
    ds_read_b64_tr_b16 v[180:181], v250 offset:28672
    v_mfma_f32_16x16x32_bf16 v[220:223], v[188:191], a[28:31], v[220:223]
    ds_read_b64_tr_b16 v[182:183], v250 offset:29184
    s_waitcnt lgkmcnt(4)
    v_mfma_f32_16x16x32_bf16 v[216:219], v[188:191], a[24:27], v[216:219]
    v_mfma_f32_16x16x32_bf16 v[216:219], v[184:187], a[16:19], v[216:219]
    v_pk_max_i16 v232, v232, 0
    v_mfma_f32_16x16x32_bf16 v[216:219], v[192:195], a[32:35], v[216:219]
    ds_read_b64_tr_b16 v[184:185], v250 offset:32768
    v_mfma_f32_16x16x32_bf16 v[216:219], v[196:199], a[40:43], v[216:219]
    ds_read_b64_tr_b16 v[186:187], v250 offset:33280
    v_mfma_f32_16x16x32_bf16 v[220:223], v[196:199], a[44:47], v[220:223]
    buffer_load_dwordx4 v3, s[12:15], s68 offen lds
    v_mfma_f32_16x16x32_bf16 v[220:223], v[192:195], a[36:39], v[220:223]
    v_pk_max_i16 v233, v233, 0
    v_mfma_f32_16x16x32_bf16 v[224:227], v[192:195], a[160:163], v[224:227]
    ds_read_b64_tr_b16 v[188:189], v251 offset:0
    v_mfma_f32_16x16x32_bf16 v[224:227], v[196:199], a[168:171], v[224:227]
    ds_read_b64_tr_b16 v[190:191], v251 offset:512
    s_waitcnt lgkmcnt(4)
    v_mfma_f32_16x16x32_bf16 v[228:231], v[196:199], a[172:175], v[228:231]
    s_add_u32 m0, s81, 8192
    s_add_u32 s68, s80, 1179648
    v_cvt_pk_bf16_f32 v236, v204, v205
    v_mfma_f32_16x16x32_bf16 v[228:231], v[192:195], a[164:167], v[228:231]
    v_mfma_f32_16x16x32_bf16 v[228:231], v[176:179], a[180:183], v[228:231]
    ds_read_b64_tr_b16 v[192:193], v251 offset:4096
    v_mfma_f32_16x16x32_bf16 v[228:231], v[180:183], a[188:191], v[228:231]
    ds_read_b64_tr_b16 v[194:195], v251 offset:4608
    v_cvt_pk_bf16_f32 v237, v206, v207
    v_mfma_f32_16x16x32_bf16 v[224:227], v[180:183], a[184:187], v[224:227]
    buffer_load_dwordx4 v3, s[12:15], s68 offen lds
    v_mfma_f32_16x16x32_bf16 v[224:227], v[176:179], a[176:179], v[224:227]
    v_mfma_f32_16x16x32_bf16 v[220:223], v[176:179], a[52:55], v[220:223]
    ds_read_b64_tr_b16 v[196:197], v251 offset:8192
    v_mfma_f32_16x16x32_bf16 v[220:223], v[180:183], a[60:63], v[220:223]
    ds_read_b64_tr_b16 v[198:199], v251 offset:8704
    s_waitcnt lgkmcnt(4)
    v_mfma_f32_16x16x32_bf16 v[216:219], v[180:183], a[56:59], v[216:219]
    v_add_u32 v253, 36864, v252
    v_pk_max_i16 v236, v236, 0
    v_mfma_f32_16x16x32_bf16 v[216:219], v[176:179], a[48:51], v[216:219]
    v_mfma_f32_16x16x32_bf16 v[216:219], v[184:187], a[64:67], v[216:219]
    ds_read_b64_tr_b16 v[176:177], v251 offset:12288
    v_pk_max_i16 v237, v237, 0
    v_mfma_f32_16x16x32_bf16 v[216:219], v[188:191], a[72:75], v[216:219]
    ds_read_b64_tr_b16 v[178:179], v251 offset:12800
    v_mfma_f32_16x16x32_bf16 v[220:223], v[188:191], a[76:79], v[220:223]
    s_add_u32 m0, s81, 36864
    s_add_u32 s68, s92, 16384
    v_mfma_f32_16x16x32_bf16 v[220:223], v[184:187], a[68:71], v[220:223]
    v_mfma_f32_16x16x32_bf16 v[224:227], v[184:187], a[192:195], v[224:227]
    ds_read_b64_tr_b16 v[180:181], v251 offset:16384
    v_cvt_pk_bf16_f32 v240, v208, v209
    v_mfma_f32_16x16x32_bf16 v[224:227], v[188:191], a[200:203], v[224:227]
    ds_read_b64_tr_b16 v[182:183], v251 offset:16896
    s_waitcnt lgkmcnt(4)
    v_mfma_f32_16x16x32_bf16 v[228:231], v[188:191], a[204:207], v[228:231]
    buffer_load_dwordx4 v1, s[20:23], s68 offen offset:0 sc1 lds
    v_mfma_f32_16x16x32_bf16 v[228:231], v[184:187], a[196:199], v[228:231]
    v_cvt_pk_bf16_f32 v241, v210, v211
    v_mfma_f32_16x16x32_bf16 v[228:231], v[192:195], a[212:215], v[228:231]
    ds_read_b64_tr_b16 v[184:185], v251 offset:20480
    v_mfma_f32_16x16x32_bf16 v[228:231], v[196:199], a[220:223], v[228:231]
    ds_read_b64_tr_b16 v[186:187], v251 offset:20992
    v_mfma_f32_16x16x32_bf16 v[224:227], v[196:199], a[216:219], v[224:227]
    buffer_load_dwordx4 v1, s[20:23], s68 offen offset:1024 sc1 lds
    v_mfma_f32_16x16x32_bf16 v[224:227], v[192:195], a[208:211], v[224:227]
    v_pk_max_i16 v240, v240, 0
    v_mfma_f32_16x16x32_bf16 v[220:223], v[192:195], a[84:87], v[220:223]
    ds_read_b64_tr_b16 v[188:189], v251 offset:24576
    v_mfma_f32_16x16x32_bf16 v[220:223], v[196:199], a[92:95], v[220:223]
    ds_read_b64_tr_b16 v[190:191], v251 offset:25088
    s_waitcnt lgkmcnt(4)
    v_mfma_f32_16x16x32_bf16 v[216:219], v[196:199], a[88:91], v[216:219]
    v_pk_max_i16 v241, v241, 0
    v_mfma_f32_16x16x32_bf16 v[216:219], v[192:195], a[80:83], v[216:219]
    v_mfma_f32_16x16x32_bf16 v[216:219], v[176:179], a[96:99], v[216:219]
    ds_read_b64_tr_b16 v[192:193], v251 offset:28672
    v_add_u32 v8, 147456, v1
    v_mfma_f32_16x16x32_bf16 v[216:219], v[180:183], a[104:107], v[216:219]
    ds_read_b64_tr_b16 v[194:195], v251 offset:29184
    v_mfma_f32_16x16x32_bf16 v[220:223], v[180:183], a[108:111], v[220:223]
    buffer_load_dwordx4 v1, s[20:23], s68 offen offset:2048 sc1 lds
    v_mfma_f32_16x16x32_bf16 v[220:223], v[176:179], a[100:103], v[220:223]
    v_cvt_pk_bf16_f32 v244, v212, v213
    v_mfma_f32_16x16x32_bf16 v[224:227], v[176:179], a[224:227], v[224:227]
    ds_read_b64_tr_b16 v[196:197], v251 offset:32768
    v_mfma_f32_16x16x32_bf16 v[224:227], v[180:183], a[232:235], v[224:227]
    ds_read_b64_tr_b16 v[198:199], v251 offset:33280
    s_waitcnt lgkmcnt(4)
    v_mfma_f32_16x16x32_bf16 v[228:231], v[180:183], a[236:239], v[228:231]
    buffer_load_dwordx4 v1, s[20:23], s68 offen offset:3072 sc1 lds
    v_mfma_f32_16x16x32_bf16 v[228:231], v[176:179], a[228:231], v[228:231]
    v_cvt_pk_bf16_f32 v245, v214, v215
    v_mfma_f32_16x16x32_bf16 v[228:231], v[184:187], a[244:247], v[228:231]
    ds_read_b64_tr_b16 v[176:177], v252 offset:0
    v_mfma_f32_16x16x32_bf16 v[228:231], v[188:191], a[252:255], v[228:231]
    ds_read_b64_tr_b16 v[178:179], v252 offset:512
    v_pk_max_i16 v244, v244, 0
    v_mfma_f32_16x16x32_bf16 v[224:227], v[188:191], a[248:251], v[224:227]
    s_add_u32 m0, s81, 40960
    s_add_u32 s68, s92, 20480
    v_mfma_f32_16x16x32_bf16 v[224:227], v[184:187], a[240:243], v[224:227]
    v_mfma_f32_16x16x32_bf16 v[220:223], v[184:187], a[116:119], v[220:223]
    ds_read_b64_tr_b16 v[180:181], v252 offset:4096
    v_pk_max_i16 v245, v245, 0
    v_mfma_f32_16x16x32_bf16 v[220:223], v[188:191], a[124:127], v[220:223]
    ds_read_b64_tr_b16 v[182:183], v252 offset:4608
    s_waitcnt lgkmcnt(4)
    v_mfma_f32_16x16x32_bf16 v[216:219], v[188:191], a[120:123], v[216:219]
    v_mfma_f32_16x16x32_bf16 v[216:219], v[184:187], a[112:115], v[216:219]
    v_mfma_f32_16x16x32_bf16 v[216:219], v[192:195], v[16:19], v[216:219]
    ds_read_b64_tr_b16 v[184:185], v252 offset:8192
    v_mfma_f32_16x16x32_bf16 v[216:219], v[196:199], v[24:27], v[216:219]
    ds_read_b64_tr_b16 v[186:187], v252 offset:8704
    v_mfma_f32_16x16x32_bf16 v[220:223], v[196:199], v[28:31], v[220:223]
    buffer_load_dwordx4 v1, s[20:23], s68 offen offset:0 sc1 lds
    v_mfma_f32_16x16x32_bf16 v[220:223], v[192:195], v[20:23], v[220:223]
    v_mfma_f32_16x16x32_bf16 v[224:227], v[192:195], v[32:35], v[224:227]
    ds_read_b64_tr_b16 v[188:189], v252 offset:12288
    v_mfma_f32_16x16x32_bf16 v[224:227], v[196:199], v[40:43], v[224:227]
    ds_read_b64_tr_b16 v[190:191], v252 offset:12800
    s_waitcnt lgkmcnt(4)
    v_mfma_f32_16x16x32_bf16 v[228:231], v[196:199], v[44:47], v[228:231]
    buffer_load_dwordx4 v1, s[20:23], s68 offen offset:1024 sc1 lds
    v_mfma_f32_16x16x32_bf16 v[228:231], v[192:195], v[36:39], v[228:231]
    v_mfma_f32_16x16x32_bf16 v[200:203], v[176:179], a[0:3], 0
    ds_read_b64_tr_b16 v[192:193], v252 offset:16384
    v_xor_b32 v250, 96, v5
    v_mfma_f32_16x16x32_bf16 v[200:203], v[180:183], a[8:11], v[200:203]
    ds_read_b64_tr_b16 v[194:195], v252 offset:16896
    v_mfma_f32_16x16x32_bf16 v[204:207], v[176:179], a[4:7], 0
    buffer_load_dwordx4 v1, s[20:23], s68 offen offset:2048 sc1 lds
    v_mfma_f32_16x16x32_bf16 v[204:207], v[180:183], a[12:15], v[204:207]
    v_mfma_f32_16x16x32_bf16 v[208:211], v[176:179], a[128:131], 0
    ds_read_b64_tr_b16 v[196:197], v252 offset:20480
    v_mfma_f32_16x16x32_bf16 v[208:211], v[180:183], a[136:139], v[208:211]
    ds_read_b64_tr_b16 v[198:199], v252 offset:20992
    s_waitcnt lgkmcnt(4)
    v_mfma_f32_16x16x32_bf16 v[212:215], v[176:179], a[132:135], 0
    s_waitcnt vmcnt(20)
    s_barrier
    v_mfma_f32_16x16x32_bf16 v[212:215], v[180:183], a[140:143], v[212:215]
    ds_read_b128 v[128:131], v8 offset:0
    v_mfma_f32_16x16x32_bf16 v[212:215], v[184:187], a[148:151], v[212:215]
    ds_read_b64_tr_b16 v[176:177], v252 offset:24576
    v_cvt_pk_bf16_f32 v234, v216, v217
    v_mfma_f32_16x16x32_bf16 v[212:215], v[188:191], a[156:159], v[212:215]
    ds_read_b64_tr_b16 v[178:179], v252 offset:25088
    v_mfma_f32_16x16x32_bf16 v[208:211], v[188:191], a[152:155], v[208:211]
    buffer_load_dwordx4 v1, s[20:23], s68 offen offset:3072 sc1 lds
    v_mfma_f32_16x16x32_bf16 v[208:211], v[184:187], a[144:147], v[208:211]
    ds_read_b128 v[132:135], v8 offset:1024
    v_mfma_f32_16x16x32_bf16 v[204:207], v[184:187], a[20:23], v[204:207]
    ds_read_b64_tr_b16 v[180:181], v252 offset:28672
    v_cvt_pk_bf16_f32 v235, v218, v219
    v_mfma_f32_16x16x32_bf16 v[204:207], v[188:191], a[28:31], v[204:207]
    ds_read_b64_tr_b16 v[182:183], v252 offset:29184
    s_waitcnt lgkmcnt(6)
    v_mfma_f32_16x16x32_bf16 v[200:203], v[188:191], a[24:27], v[200:203]
    s_add_u32 m0, s81, 45056
    s_add_u32 s68, s92, 24576
    ds_read_b128 v[136:139], v8 offset:2048
    v_mfma_f32_16x16x32_bf16 v[200:203], v[184:187], a[16:19], v[200:203]
    ds_read_b128 v[140:143], v8 offset:3072
    v_mfma_f32_16x16x32_bf16 v[200:203], v[192:195], a[32:35], v[200:203]
    ds_read_b64_tr_b16 v[184:185], v252 offset:32768
    v_pk_max_i16 v234, v234, 0
    v_mfma_f32_16x16x32_bf16 v[200:203], v[196:199], a[40:43], v[200:203]
    ds_read_b64_tr_b16 v[186:187], v252 offset:33280
    v_mfma_f32_16x16x32_bf16 v[204:207], v[196:199], a[44:47], v[204:207]
    buffer_load_dwordx4 v1, s[20:23], s68 offen offset:0 sc1 lds
    v_mfma_f32_16x16x32_bf16 v[204:207], v[192:195], a[36:39], v[204:207]
    ds_read_b128 v[160:163], v8 offset:4096
    v_mfma_f32_16x16x32_bf16 v[208:211], v[192:195], a[160:163], v[208:211]
    ds_read_b64_tr_b16 v[188:189], v253 offset:0
    v_mfma_f32_16x16x32_bf16 v[208:211], v[196:199], a[168:171], v[208:211]
    ds_read_b64_tr_b16 v[190:191], v253 offset:512
    s_waitcnt lgkmcnt(7)
    v_mfma_f32_16x16x32_bf16 v[212:215], v[196:199], a[172:175], v[212:215]
    ds_read_b128 v[164:167], v8 offset:5120
    v_pk_max_i16 v235, v235, 0
    v_mfma_f32_16x16x32_bf16 v[212:215], v[192:195], a[164:167], v[212:215]
    ds_read_b128 v[168:171], v8 offset:6144
    v_mfma_f32_16x16x32_bf16 v[212:215], v[176:179], a[180:183], v[212:215]
    ds_read_b64_tr_b16 v[192:193], v253 offset:4096
    v_mfma_f32_16x16x32_bf16 v[212:215], v[180:183], a[188:191], v[212:215]
    ds_read_b64_tr_b16 v[194:195], v253 offset:4608
    v_mfma_f32_16x16x32_bf16 v[208:211], v[180:183], a[184:187], v[208:211]
    ds_read_b128 v[172:175], v8 offset:7168
    v_add_u32 v250, 73728, v250
    v_mfma_f32_16x16x32_bf16 v[208:211], v[176:179], a[176:179], v[208:211]
    buffer_store_dwordx4 v[232:235], v10, s[16:19], s84 offen offset:2048 sc1
    v_mfma_f32_16x16x32_bf16 v[204:207], v[176:179], a[52:55], v[204:207]
    ds_read_b64_tr_b16 v[196:197], v253 offset:8192
    v_mfma_f32_16x16x32_bf16 v[204:207], v[180:183], a[60:63], v[204:207]
    ds_read_b64_tr_b16 v[198:199], v253 offset:8704
    s_waitcnt lgkmcnt(7)
    v_mfma_f32_16x16x32_bf16 v[200:203], v[180:183], a[56:59], v[200:203]
    s_waitcnt lgkmcnt(2)
    v_cvt_pk_bf16_f32 v238, v220, v221
    v_mfma_f32_16x16x32_bf16 v[200:203], v[176:179], a[48:51], v[200:203]
    v_mfma_f32_16x16x32_bf16 v[64:67], v[128:131], v[48:51], 0
    v_mfma_f32_16x16x32_bf16 v[64:67], v[132:135], v[80:83], v[64:67]
    v_mfma_f32_16x16x32_bf16 v[64:67], v[136:139], v[112:115], v[64:67]
    v_cvt_pk_bf16_f32 v239, v222, v223
    v_mfma_f32_16x16x32_bf16 v[64:67], v[140:143], v[144:147], v[64:67]
    v_mfma_f32_16x16x32_bf16 v[68:71], v[160:163], v[48:51], 0
    v_mfma_f32_16x16x32_bf16 v[68:71], v[164:167], v[80:83], v[68:71]
    v_mfma_f32_16x16x32_bf16 v[68:71], v[168:171], v[112:115], v[68:71]
    v_pk_max_i16 v238, v238, 0
    v_mfma_f32_16x16x32_bf16 v[68:71], v[172:175], v[144:147], v[68:71]
    v_mfma_f32_16x16x32_bf16 v[72:75], v[128:131], v[52:55], 0
    v_mfma_f32_16x16x32_bf16 v[72:75], v[132:135], v[84:87], v[72:75]
    v_mfma_f32_16x16x32_bf16 v[72:75], v[136:139], v[116:119], v[72:75]
    v_mfma_f32_16x16x32_bf16 v[72:75], v[140:143], v[148:151], v[72:75]
    v_pk_max_i16 v239, v239, 0
    v_mfma_f32_16x16x32_bf16 v[76:79], v[160:163], v[52:55], 0
    v_mfma_f32_16x16x32_bf16 v[76:79], v[164:167], v[84:87], v[76:79]
    v_mfma_f32_16x16x32_bf16 v[76:79], v[168:171], v[116:119], v[76:79]
    v_mfma_f32_16x16x32_bf16 v[76:79], v[172:175], v[148:151], v[76:79]
    buffer_store_dwordx4 v[236:239], v11, s[16:19], s84 offen offset:2048 sc1
    v_mfma_f32_16x16x32_bf16 v[96:99], v[128:131], v[56:59], 0
    v_mfma_f32_16x16x32_bf16 v[96:99], v[132:135], v[88:91], v[96:99]
    v_mfma_f32_16x16x32_bf16 v[96:99], v[136:139], v[120:123], v[96:99]
    v_mfma_f32_16x16x32_bf16 v[96:99], v[140:143], v[152:155], v[96:99]
    v_mfma_f32_16x16x32_bf16 v[100:103], v[160:163], v[56:59], 0
    v_cvt_pk_bf16_f32 v242, v224, v225
    v_mfma_f32_16x16x32_bf16 v[100:103], v[164:167], v[88:91], v[100:103]
    v_add_u32 v251, 36864, v250
    v_mfma_f32_16x16x32_bf16 v[100:103], v[168:171], v[120:123], v[100:103]
    v_mfma_f32_16x16x32_bf16 v[100:103], v[172:175], v[152:155], v[100:103]
    v_mfma_f32_16x16x32_bf16 v[104:107], v[128:131], v[60:63], 0
    v_cvt_pk_bf16_f32 v243, v226, v227
    v_mfma_f32_16x16x32_bf16 v[104:107], v[132:135], v[92:95], v[104:107]
    v_mfma_f32_16x16x32_bf16 v[104:107], v[136:139], v[124:127], v[104:107]
    v_mfma_f32_16x16x32_bf16 v[104:107], v[140:143], v[156:159], v[104:107]
    v_mfma_f32_16x16x32_bf16 v[108:111], v[160:163], v[60:63], 0
    v_pk_max_i16 v242, v242, 0
    v_mfma_f32_16x16x32_bf16 v[108:111], v[164:167], v[92:95], v[108:111]
    v_mfma_f32_16x16x32_bf16 v[108:111], v[168:171], v[124:127], v[108:111]
    v_mfma_f32_16x16x32_bf16 v[108:111], v[172:175], v[156:159], v[108:111]
    v_mfma_f32_16x16x32_bf16 v[200:203], v[184:187], a[64:67], v[200:203]
    ds_read_b64_tr_b16 v[176:177], v253 offset:12288
    v_mfma_f32_16x16x32_bf16 v[200:203], v[188:191], a[72:75], v[200:203]
    ds_read_b64_tr_b16 v[178:179], v253 offset:12800
    v_pk_max_i16 v243, v243, 0
    v_mfma_f32_16x16x32_bf16 v[204:207], v[188:191], a[76:79], v[204:207]
    v_mfma_f32_16x16x32_bf16 v[204:207], v[184:187], a[68:71], v[204:207]
    v_max3_f32 v128, v64, v65, v66
    v_max3_f32 v128, v128, v67, v68
    v_mfma_f32_16x16x32_bf16 v[208:211], v[184:187], a[192:195], v[208:211]
    ds_read_b64_tr_b16 v[180:181], v253 offset:16384
    v_max3_f32 v128, v128, v69, v70
    v_max_f32 v128, v128, v71
    v_mfma_f32_16x16x32_bf16 v[208:211], v[188:191], a[200:203], v[208:211]
    ds_read_b64_tr_b16 v[182:183], v253 offset:16896
    s_waitcnt lgkmcnt(4)
    v_mfma_f32_16x16x32_bf16 v[212:215], v[188:191], a[204:207], v[212:215]
    buffer_store_dwordx4 v[240:243], v12, s[16:19], s84 offen offset:2048 sc1
    v_mfma_f32_16x16x32_bf16 v[212:215], v[184:187], a[196:199], v[212:215]
    v_max3_f32 v132, v72, v73, v74
    v_max3_f32 v132, v132, v75, v76
    v_mfma_f32_16x16x32_bf16 v[212:215], v[192:195], a[212:215], v[212:215]
    ds_read_b64_tr_b16 v[184:185], v253 offset:20480
    v_max3_f32 v132, v132, v77, v78
    v_mfma_f32_16x16x32_bf16 v[212:215], v[196:199], a[220:223], v[212:215]
    ds_read_b64_tr_b16 v[186:187], v253 offset:20992
    v_max_f32 v132, v132, v79
    v_mfma_f32_16x16x32_bf16 v[208:211], v[196:199], a[216:219], v[208:211]
    v_cvt_pk_bf16_f32 v246, v228, v229
    v_max3_f32 v136, v96, v97, v98
    v_mfma_f32_16x16x32_bf16 v[208:211], v[192:195], a[208:211], v[208:211]
    v_max3_f32 v136, v136, v99, v100
    v_max3_f32 v136, v136, v101, v102
    v_mfma_f32_16x16x32_bf16 v[204:207], v[192:195], a[84:87], v[204:207]
    ds_read_b64_tr_b16 v[188:189], v253 offset:24576
    v_max_f32 v136, v136, v103
    v_mfma_f32_16x16x32_bf16 v[204:207], v[196:199], a[92:95], v[204:207]
    ds_read_b64_tr_b16 v[190:191], v253 offset:25088
    s_waitcnt lgkmcnt(4)
    v_mfma_f32_16x16x32_bf16 v[200:203], v[196:199], a[88:91], v[200:203]
    v_cvt_pk_bf16_f32 v247, v230, v231
    v_max3_f32 v140, v104, v105, v106
    v_mfma_f32_16x16x32_bf16 v[200:203], v[192:195], a[80:83], v[200:203]
    v_max3_f32 v140, v140, v107, v108
    v_max3_f32 v140, v140, v109, v110
    v_mfma_f32_16x16x32_bf16 v[200:203], v[176:179], a[96:99], v[200:203]
    ds_read_b64_tr_b16 v[192:193], v253 offset:28672
    v_max_f32 v140, v140, v111
    v_mfma_f32_16x16x32_bf16 v[200:203], v[180:183], a[104:107], v[200:203]
    ds_read_b64_tr_b16 v[194:195], v253 offset:29184
    v_mov_b32 v129, v128
    v_mfma_f32_16x16x32_bf16 v[204:207], v[180:183], a[108:111], v[204:207]
    v_pk_max_i16 v246, v246, 0
    v_mov_b32 v133, v132
    v_mfma_f32_16x16x32_bf16 v[204:207], v[176:179], a[100:103], v[204:207]
    v_mov_b32 v137, v136
    v_mov_b32 v141, v140
    v_mfma_f32_16x16x32_bf16 v[208:211], v[176:179], a[224:227], v[208:211]
    ds_read_b64_tr_b16 v[196:197], v253 offset:32768
    v_permlane32_swap_b32 v129, v128
    v_mfma_f32_16x16x32_bf16 v[208:211], v[180:183], a[232:235], v[208:211]
    ds_read_b64_tr_b16 v[198:199], v253 offset:33280
    s_waitcnt lgkmcnt(4)
    v_mfma_f32_16x16x32_bf16 v[212:215], v[180:183], a[236:239], v[212:215]
    v_permlane32_swap_b32 v133, v132
    v_permlane32_swap_b32 v137, v136
    v_mfma_f32_16x16x32_bf16 v[212:215], v[176:179], a[228:231], v[212:215]
    v_pk_max_i16 v247, v247, 0
    v_permlane32_swap_b32 v141, v140
    v_mfma_f32_16x16x32_bf16 v[212:215], v[184:187], a[244:247], v[212:215]
    ds_read_b64_tr_b16 v[176:177], v250 offset:0
    v_lshrrev_b32 v5, 6, v1
    v_mfma_f32_16x16x32_bf16 v[212:215], v[188:191], a[252:255], v[212:215]
    ds_read_b64_tr_b16 v[178:179], v250 offset:512
    v_max_f32 v128, v128, v129
    v_mfma_f32_16x16x32_bf16 v[208:211], v[188:191], a[248:251], v[208:211]
    v_max_f32 v132, v132, v133
    v_max_f32 v136, v136, v137
    v_max_f32 v140, v140, v141
    v_mfma_f32_16x16x32_bf16 v[208:211], v[184:187], a[240:243], v[208:211]
    buffer_store_dwordx4 v[244:247], v13, s[16:19], s84 offen offset:2048 sc1
    v_mfma_f32_16x16x32_bf16 v[204:207], v[184:187], a[116:119], v[204:207]
    ds_read_b64_tr_b16 v[180:181], v250 offset:4096
    v_mov_b32 v129, v128
    v_mov_b32 v133, v132
    v_mfma_f32_16x16x32_bf16 v[204:207], v[188:191], a[124:127], v[204:207]
    ds_read_b64_tr_b16 v[182:183], v250 offset:4608
    s_waitcnt lgkmcnt(4)
    v_mfma_f32_16x16x32_bf16 v[200:203], v[188:191], a[120:123], v[200:203]
    v_mov_b32 v137, v136
    v_mov_b32 v141, v140
    v_mfma_f32_16x16x32_bf16 v[200:203], v[184:187], a[112:115], v[200:203]
    v_permlane16_swap_b32 v129, v128
    v_permlane16_swap_b32 v133, v132
    v_mfma_f32_16x16x32_bf16 v[200:203], v[192:195], v[16:19], v[200:203]
    ds_read_b64_tr_b16 v[184:185], v250 offset:8192
    v_permlane16_swap_b32 v137, v136
    v_mfma_f32_16x16x32_bf16 v[200:203], v[196:199], v[24:27], v[200:203]
    ds_read_b64_tr_b16 v[186:187], v250 offset:8704
    v_permlane16_swap_b32 v141, v140
    v_mfma_f32_16x16x32_bf16 v[204:207], v[196:199], v[28:31], v[204:207]
    v_max_f32 v128, v128, v129
    v_max_f32 v132, v132, v133
    v_mfma_f32_16x16x32_bf16 v[204:207], v[192:195], v[20:23], v[204:207]
    v_max_f32 v136, v136, v137
    v_max_f32 v140, v140, v141
    v_mfma_f32_16x16x32_bf16 v[208:211], v[192:195], v[32:35], v[208:211]
    ds_read_b64_tr_b16 v[188:189], v250 offset:12288
    v_sub_f32 v64, v64, v128
    v_mfma_f32_16x16x32_bf16 v[208:211], v[196:199], v[40:43], v[208:211]
    ds_read_b64_tr_b16 v[190:191], v250 offset:12800
    s_waitcnt lgkmcnt(4)
    v_mfma_f32_16x16x32_bf16 v[212:215], v[196:199], v[44:47], v[212:215]
    v_sub_f32 v65, v65, v128
    v_sub_f32 v66, v66, v128
    v_mfma_f32_16x16x32_bf16 v[212:215], v[192:195], v[36:39], v[212:215]
    v_sub_f32 v67, v67, v128
    v_sub_f32 v68, v68, v128
    v_mfma_f32_16x16x32_bf16 v[216:219], v[176:179], a[0:3], 0
    ds_read_b64_tr_b16 v[192:193], v250 offset:16384
    v_mul_u32_u24 v5, 288, v5
    v_mfma_f32_16x16x32_bf16 v[216:219], v[180:183], a[8:11], v[216:219]
    ds_read_b64_tr_b16 v[194:195], v250 offset:16896
    v_sub_f32 v69, v69, v128
    v_mfma_f32_16x16x32_bf16 v[220:223], v[176:179], a[4:7], 0
    v_sub_f32 v70, v70, v128
    v_sub_f32 v71, v71, v128
    v_mfma_f32_16x16x32_bf16 v[220:223], v[180:183], a[12:15], v[220:223]
    v_sub_f32 v131, 0, v128
    v_sub_f32 v130, 0, v128
    v_mfma_f32_16x16x32_bf16 v[224:227], v[176:179], a[128:131], 0
    ds_read_b64_tr_b16 v[196:197], v250 offset:20480
    v_sub_f32 v129, 0, v128
    v_mfma_f32_16x16x32_bf16 v[224:227], v[180:183], a[136:139], v[224:227]
    ds_read_b64_tr_b16 v[198:199], v250 offset:20992
    s_waitcnt lgkmcnt(4)
    v_mfma_f32_16x16x32_bf16 v[228:231], v[176:179], a[132:135], 0
    v_sub_f32 v128, 0, v128
    v_sub_f32 v72, v72, v132
    v_mfma_f32_16x16x32_bf16 v[228:231], v[180:183], a[140:143], v[228:231]
    v_sub_f32 v73, v73, v132
    v_sub_f32 v74, v74, v132
    v_mfma_f32_16x16x32_bf16 v[228:231], v[184:187], a[148:151], v[228:231]
    ds_read_b64_tr_b16 v[176:177], v250 offset:24576
    v_cvt_pk_bf16_f32 v232, v200, v201
    v_mfma_f32_16x16x32_bf16 v[228:231], v[188:191], a[156:159], v[228:231]
    ds_read_b64_tr_b16 v[178:179], v250 offset:25088
    v_sub_f32 v75, v75, v132
    v_mfma_f32_16x16x32_bf16 v[224:227], v[188:191], a[152:155], v[224:227]
    v_sub_f32 v76, v76, v132
    v_sub_f32 v77, v77, v132
    v_mfma_f32_16x16x32_bf16 v[224:227], v[184:187], a[144:147], v[224:227]
    v_cvt_pk_bf16_f32 v233, v202, v203
    v_sub_f32 v78, v78, v132
    v_mfma_f32_16x16x32_bf16 v[220:223], v[184:187], a[20:23], v[220:223]
    ds_read_b64_tr_b16 v[180:181], v250 offset:28672
    v_sub_f32 v79, v79, v132
    v_mfma_f32_16x16x32_bf16 v[220:223], v[188:191], a[28:31], v[220:223]
    ds_read_b64_tr_b16 v[182:183], v250 offset:29184
    s_waitcnt lgkmcnt(4)
    v_mfma_f32_16x16x32_bf16 v[216:219], v[188:191], a[24:27], v[216:219]
    v_sub_f32 v135, 0, v132
    v_sub_f32 v134, 0, v132
    v_mfma_f32_16x16x32_bf16 v[216:219], v[184:187], a[16:19], v[216:219]
    v_pk_max_i16 v232, v232, 0
    v_sub_f32 v133, 0, v132
    v_mfma_f32_16x16x32_bf16 v[216:219], v[192:195], a[32:35], v[216:219]
    ds_read_b64_tr_b16 v[184:185], v250 offset:32768
    v_bfe_u32 v14, v1, 4, 2
    v_mfma_f32_16x16x32_bf16 v[216:219], v[196:199], a[40:43], v[216:219]
    ds_read_b64_tr_b16 v[186:187], v250 offset:33280
    v_sub_f32 v132, 0, v132
    v_mfma_f32_16x16x32_bf16 v[220:223], v[196:199], a[44:47], v[220:223]
    v_pk_max_i16 v233, v233, 0
    v_sub_f32 v96, v96, v136
    v_mfma_f32_16x16x32_bf16 v[220:223], v[192:195], a[36:39], v[220:223]
    v_sub_f32 v97, v97, v136
    v_sub_f32 v98, v98, v136
    v_mfma_f32_16x16x32_bf16 v[224:227], v[192:195], a[160:163], v[224:227]
    ds_read_b64_tr_b16 v[188:189], v251 offset:0
    v_sub_f32 v99, v99, v136
    v_mfma_f32_16x16x32_bf16 v[224:227], v[196:199], a[168:171], v[224:227]
    ds_read_b64_tr_b16 v[190:191], v251 offset:512
    s_waitcnt lgkmcnt(4)
    v_mfma_f32_16x16x32_bf16 v[228:231], v[196:199], a[172:175], v[228:231]
    v_cvt_pk_bf16_f32 v236, v204, v205
    v_sub_f32 v100, v100, v136
    v_mfma_f32_16x16x32_bf16 v[228:231], v[192:195], a[164:167], v[228:231]
    v_sub_f32 v101, v101, v136
    v_sub_f32 v102, v102, v136
    v_mfma_f32_16x16x32_bf16 v[228:231], v[176:179], a[180:183], v[228:231]
    ds_read_b64_tr_b16 v[192:193], v251 offset:4096
    v_sub_f32 v103, v103, v136
    v_mfma_f32_16x16x32_bf16 v[228:231], v[180:183], a[188:191], v[228:231]
    ds_read_b64_tr_b16 v[194:195], v251 offset:4608
    v_cvt_pk_bf16_f32 v237, v206, v207
    v_mfma_f32_16x16x32_bf16 v[224:227], v[180:183], a[184:187], v[224:227]
    v_sub_f32 v139, 0, v136
    v_sub_f32 v138, 0, v136
    v_mfma_f32_16x16x32_bf16 v[224:227], v[176:179], a[176:179], v[224:227]
    v_sub_f32 v137, 0, v136
    v_sub_f32 v136, 0, v136
    v_mfma_f32_16x16x32_bf16 v[220:223], v[176:179], a[52:55], v[220:223]
    ds_read_b64_tr_b16 v[196:197], v251 offset:8192
    v_sub_f32 v104, v104, v140
    v_mfma_f32_16x16x32_bf16 v[220:223], v[180:183], a[60:63], v[220:223]
    ds_read_b64_tr_b16 v[198:199], v251 offset:8704
    s_waitcnt lgkmcnt(4)
    v_mfma_f32_16x16x32_bf16 v[216:219], v[180:183], a[56:59], v[216:219]
    v_pk_max_i16 v236, v236, 0
    v_sub_f32 v105, v105, v140
    v_mfma_f32_16x16x32_bf16 v[216:219], v[176:179], a[48:51], v[216:219]
    v_sub_f32 v106, v106, v140
    v_sub_f32 v107, v107, v140
    v_mfma_f32_16x16x32_bf16 v[216:219], v[184:187], a[64:67], v[216:219]
    ds_read_b64_tr_b16 v[176:177], v251 offset:12288
    v_lshl_add_u32 v5, v14, 3, v5
    v_mfma_f32_16x16x32_bf16 v[216:219], v[188:191], a[72:75], v[216:219]
    ds_read_b64_tr_b16 v[178:179], v251 offset:12800
    v_pk_max_i16 v237, v237, 0
    v_mfma_f32_16x16x32_bf16 v[220:223], v[188:191], a[76:79], v[220:223]
    v_sub_f32 v108, v108, v140
    v_sub_f32 v109, v109, v140
    v_mfma_f32_16x16x32_bf16 v[220:223], v[184:187], a[68:71], v[220:223]
    v_sub_f32 v110, v110, v140
    v_sub_f32 v111, v111, v140
    v_mfma_f32_16x16x32_bf16 v[224:227], v[184:187], a[192:195], v[224:227]
    ds_read_b64_tr_b16 v[180:181], v251 offset:16384
    v_cvt_pk_bf16_f32 v240, v208, v209
    v_mfma_f32_16x16x32_bf16 v[224:227], v[188:191], a[200:203], v[224:227]
    ds_read_b64_tr_b16 v[182:183], v251 offset:16896
    s_waitcnt lgkmcnt(4)
    v_mfma_f32_16x16x32_bf16 v[228:231], v[188:191], a[204:207], v[228:231]
    v_sub_f32 v143, 0, v140
    v_sub_f32 v142, 0, v140
    v_mfma_f32_16x16x32_bf16 v[228:231], v[184:187], a[196:199], v[228:231]
    v_cvt_pk_bf16_f32 v241, v210, v211
    v_sub_f32 v141, 0, v140
    v_mfma_f32_16x16x32_bf16 v[228:231], v[192:195], a[212:215], v[228:231]
    ds_read_b64_tr_b16 v[184:185], v251 offset:20480
    v_sub_f32 v140, 0, v140
    v_mfma_f32_16x16x32_bf16 v[228:231], v[196:199], a[220:223], v[228:231]
    ds_read_b64_tr_b16 v[186:187], v251 offset:20992
    v_exp_f32 v64, v64
    v_mfma_f32_16x16x32_bf16 v[224:227], v[196:199], a[216:219], v[224:227]
    s_waitcnt vmcnt(4)
    s_barrier
    v_mfma_f32_16x16x32_bf16 v[224:227], v[192:195], a[208:211], v[224:227]
    v_pk_max_i16 v240, v240, 0
    v_exp_f32 v65, v65
    v_exp_f32 v66, v66
    v_mfma_f32_16x16x32_bf16 v[220:223], v[192:195], a[84:87], v[220:223]
    ds_read_b64_tr_b16 v[188:189], v251 offset:24576
    v_exp_f32 v67, v67
    v_exp_f32 v68, v68
    v_mfma_f32_16x16x32_bf16 v[220:223], v[196:199], a[92:95], v[220:223]
    ds_read_b64_tr_b16 v[190:191], v251 offset:25088
    s_waitcnt lgkmcnt(4)
    v_mfma_f32_16x16x32_bf16 v[216:219], v[196:199], a[88:91], v[216:219]
    v_pk_max_i16 v241, v241, 0
    v_exp_f32 v69, v69
    v_mfma_f32_16x16x32_bf16 v[216:219], v[192:195], a[80:83], v[216:219]
    v_exp_f32 v70, v70
    v_mfma_f32_16x16x32_bf16 v[216:219], v[176:179], a[96:99], v[216:219]
    ds_read_b64_tr_b16 v[192:193], v251 offset:28672
    v_exp_f32 v71, v71
    v_mfma_f32_16x16x32_bf16 v[216:219], v[180:183], a[104:107], v[216:219]
    ds_read_b64_tr_b16 v[194:195], v251 offset:29184
    v_exp_f32 v72, v72
    v_mfma_f32_16x16x32_bf16 v[220:223], v[180:183], a[108:111], v[220:223]
    v_cvt_pk_bf16_f32 v244, v212, v213
    v_exp_f32 v73, v73
    v_mfma_f32_16x16x32_bf16 v[220:223], v[176:179], a[100:103], v[220:223]
    v_exp_f32 v74, v74
    v_exp_f32 v75, v75
    v_mfma_f32_16x16x32_bf16 v[224:227], v[176:179], a[224:227], v[224:227]
    ds_read_b64_tr_b16 v[196:197], v251 offset:32768
    v_exp_f32 v76, v76
    v_exp_f32 v77, v77
    v_mfma_f32_16x16x32_bf16 v[224:227], v[180:183], a[232:235], v[224:227]
    ds_read_b64_tr_b16 v[198:199], v251 offset:33280
    s_waitcnt lgkmcnt(4)
    v_mfma_f32_16x16x32_bf16 v[228:231], v[180:183], a[236:239], v[228:231]
    v_cvt_pk_bf16_f32 v245, v214, v215
    v_exp_f32 v78, v78
    v_mfma_f32_16x16x32_bf16 v[228:231], v[176:179], a[228:231], v[228:231]
    v_exp_f32 v79, v79
    v_mfma_f32_16x16x32_bf16 v[228:231], v[184:187], a[244:247], v[228:231]
    ds_read_b64_tr_b16 v[176:177], v248 offset:0
    v_exp_f32 v96, v96
    v_exp_f32 v97, v97
    v_mfma_f32_16x16x32_bf16 v[228:231], v[188:191], a[252:255], v[228:231]
    ds_read_b64_tr_b16 v[178:179], v248 offset:256
    v_pk_max_i16 v244, v244, 0
    v_mfma_f32_16x16x32_bf16 v[224:227], v[188:191], a[248:251], v[224:227]
    v_exp_f32 v98, v98
    v_mfma_f32_16x16x32_bf16 v[224:227], v[184:187], a[240:243], v[224:227]
    v_exp_f32 v99, v99
    v_exp_f32 v100, v100
    v_exp_f32 v101, v101
    v_exp_f32 v102, v102
    v_mfma_f32_16x16x32_bf16 v[220:223], v[184:187], a[116:119], v[220:223]
    ds_read_b64_tr_b16 v[180:181], v248 offset:2048
    v_pk_max_i16 v245, v245, 0
    v_mfma_f32_16x16x32_bf16 v[220:223], v[188:191], a[124:127], v[220:223]
    ds_read_b64_tr_b16 v[182:183], v248 offset:2304
    s_waitcnt lgkmcnt(4)
    v_mfma_f32_16x16x32_bf16 v[216:219], v[188:191], a[120:123], v[216:219]
    v_exp_f32 v103, v103
    v_mfma_f32_16x16x32_bf16 v[216:219], v[184:187], a[112:115], v[216:219]
    v_exp_f32 v104, v104
    v_mfma_f32_16x16x32_bf16 v[216:219], v[192:195], v[16:19], v[216:219]
    ds_read_b64_tr_b16 v[184:185], v248 offset:4096
    v_exp_f32 v105, v105
    v_mfma_f32_16x16x32_bf16 v[216:219], v[196:199], v[24:27], v[216:219]
    ds_read_b64_tr_b16 v[186:187], v248 offset:4352
    v_exp_f32 v106, v106
    v_mfma_f32_16x16x32_bf16 v[220:223], v[196:199], v[28:31], v[220:223]
    v_exp_f32 v107, v107
    v_mfma_f32_16x16x32_bf16 v[220:223], v[192:195], v[20:23], v[220:223]
    v_exp_f32 v108, v108
    v_exp_f32 v109, v109
    v_mfma_f32_16x16x32_bf16 v[224:227], v[192:195], v[32:35], v[224:227]
    ds_read_b64_tr_b16 v[188:189], v248 offset:6144
    v_exp_f32 v110, v110
    v_exp_f32 v111, v111
    v_mfma_f32_16x16x32_bf16 v[224:227], v[196:199], v[40:43], v[224:227]
    ds_read_b64_tr_b16 v[190:191], v248 offset:6400
    s_waitcnt lgkmcnt(4)
    v_mfma_f32_16x16x32_bf16 v[228:231], v[196:199], v[44:47], v[228:231]
    v_cvt_pk_bf16_f32 v160, v64, v65
    v_cvt_pk_bf16_f32 v161, v66, v67
    v_mfma_f32_16x16x32_bf16 v[228:231], v[192:195], v[36:39], v[228:231]
    v_cvt_pk_bf16_f32 v162, v68, v69
    v_cvt_pk_bf16_f32 v163, v70, v71
    v_mfma_f32_16x16x32_bf16 v[200:203], v[176:179], a[0:3], 0
    ds_read_b64_tr_b16 v[192:193], v248 offset:8192
    v_cvt_pk_bf16_f32 v164, v72, v73
    v_mfma_f32_16x16x32_bf16 v[200:203], v[180:183], a[8:11], v[200:203]
    ds_read_b64_tr_b16 v[194:195], v248 offset:8448
    v_cvt_pk_bf16_f32 v165, v74, v75
    v_mfma_f32_16x16x32_bf16 v[204:207], v[176:179], a[4:7], 0
    ds_read_b64_tr_b16 v[196:197], v248 offset:10240
    v_cvt_pk_bf16_f32 v166, v76, v77
    v_cvt_pk_bf16_f32 v167, v78, v79
    v_mfma_f32_16x16x32_bf16 v[204:207], v[180:183], a[12:15], v[204:207]
    ds_read_b64_tr_b16 v[198:199], v248 offset:10496
    s_waitcnt lgkmcnt(4)
    v_mfma_f32_16x16x32_bf16 v[204:207], v[184:187], a[20:23], v[204:207]
    ds_read_b64_tr_b16 v[176:177], v248 offset:12288
    s_barrier
    v_mfma_f32_16x16x32_bf16 v[204:207], v[188:191], a[28:31], v[204:207]
    ds_read_b64_tr_b16 v[178:179], v248 offset:12544
    v_cvt_pk_bf16_f32 v168, v96, v97
    v_cvt_pk_bf16_f32 v169, v98, v99
    v_cvt_pk_bf16_f32 v170, v100, v101
    v_cvt_pk_bf16_f32 v171, v102, v103
    v_cvt_pk_bf16_f32 v172, v104, v105
    v_cvt_pk_bf16_f32 v173, v106, v107
    v_cvt_pk_bf16_f32 v174, v108, v109
    v_cvt_pk_bf16_f32 v175, v110, v111
    v_mfma_f32_16x16x32_bf16 v[200:203], v[188:191], a[24:27], v[200:203]
    ds_read_b64_tr_b16 v[180:181], v248 offset:14336
    s_add_u32 m0, s81, 73728
    s_add_u32 s68, s92, 49152
    v_mfma_f32_16x16x32_bf16 v[200:203], v[184:187], a[16:19], v[200:203]
    ds_read_b64_tr_b16 v[182:183], v248 offset:14592
    s_waitcnt lgkmcnt(4)
    v_mfma_f32_16x16x32_bf16 v[200:203], v[192:195], a[32:35], v[200:203]
    ds_read_b64_tr_b16 v[184:185], v248 offset:16384
    v_cvt_pk_bf16_f32 v234, v216, v217
    v_mov_b32 v208, 0x3f803f80
    v_mfma_f32_16x16x32_bf16 v[200:203], v[196:199], a[40:43], v[200:203]
    ds_read_b64_tr_b16 v[186:187], v248 offset:16640
    v_cvt_pk_bf16_f32 v235, v218, v219
    v_mfma_f32_16x16x32_bf16 v[204:207], v[196:199], a[44:47], v[204:207]
    ds_read_b64_tr_b16 v[188:189], v248 offset:18432
    buffer_load_dwordx4 v1, s[20:23], s68 offen offset:0 sc1 lds
    v_pk_max_i16 v234, v234, 0
    v_mfma_f32_16x16x32_bf16 v[204:207], v[192:195], a[36:39], v[204:207]
    ds_read_b64_tr_b16 v[190:191], v248 offset:18688
    s_waitcnt lgkmcnt(4)
    v_mfma_f32_16x16x32_bf16 v[204:207], v[176:179], a[52:55], v[204:207]
    ds_read_b64_tr_b16 v[192:193], v248 offset:20480
    v_pk_max_i16 v235, v235, 0
    v_mfma_f32_16x16x32_bf16 v[204:207], v[180:183], a[60:63], v[204:207]
    ds_read_b64_tr_b16 v[194:195], v248 offset:20736
    buffer_store_dwordx4 v[232:235], v10, s[16:19], s84 offen offset:3072 sc1
    v_mfma_f32_16x16x32_bf16 v[200:203], v[180:183], a[56:59], v[200:203]
    ds_read_b64_tr_b16 v[196:197], v248 offset:22528
    v_cvt_pk_bf16_f32 v238, v220, v221
    v_mfma_f32_16x16x32_bf16 v[200:203], v[176:179], a[48:51], v[200:203]
    ds_read_b64_tr_b16 v[198:199], v248 offset:22784
    s_waitcnt lgkmcnt(4)
    v_cvt_pk_bf16_f32 v239, v222, v223
    v_mfma_f32_16x16x32_bf16 v[200:203], v[184:187], a[64:67], v[200:203]
    ds_read_b64_tr_b16 v[176:177], v248 offset:24576
    buffer_load_dwordx4 v1, s[20:23], s68 offen offset:1024 sc1 lds
    v_mov_b32 v209, 0x3f803f80
    v_mfma_f32_16x16x32_bf16 v[200:203], v[188:191], a[72:75], v[200:203]
    ds_read_b64_tr_b16 v[178:179], v248 offset:24832
    v_pk_max_i16 v238, v238, 0
    v_mfma_f32_16x16x32_bf16 v[204:207], v[188:191], a[76:79], v[204:207]
    ds_read_b64_tr_b16 v[180:181], v248 offset:26624
    v_pk_max_i16 v239, v239, 0
    v_mfma_f32_16x16x32_bf16 v[204:207], v[184:187], a[68:71], v[204:207]
    ds_read_b64_tr_b16 v[182:183], v248 offset:26880
    s_waitcnt lgkmcnt(4)
    buffer_store_dwordx4 v[236:239], v11, s[16:19], s84 offen offset:3072 sc1
    v_mfma_f32_16x16x32_bf16 v[204:207], v[192:195], a[84:87], v[204:207]
    ds_read_b64_tr_b16 v[184:185], v248 offset:28672
    buffer_load_dwordx4 v1, s[20:23], s68 offen offset:2048 sc1 lds
    v_mfma_f32_16x16x32_bf16 v[204:207], v[196:199], a[92:95], v[204:207]
    ds_read_b64_tr_b16 v[186:187], v248 offset:28928
    v_cvt_pk_bf16_f32 v242, v224, v225
    v_mfma_f32_16x16x32_bf16 v[200:203], v[196:199], a[88:91], v[200:203]
    ds_read_b64_tr_b16 v[188:189], v248 offset:30720
    v_cvt_pk_bf16_f32 v243, v226, v227
    v_pk_max_i16 v242, v242, 0
    v_mfma_f32_16x16x32_bf16 v[200:203], v[192:195], a[80:83], v[200:203]
    ds_read_b64_tr_b16 v[190:191], v248 offset:30976
    s_waitcnt lgkmcnt(4)
    v_pk_max_i16 v243, v243, 0
    v_mfma_f32_16x16x32_bf16 v[200:203], v[176:179], a[96:99], v[200:203]
    ds_read_b64_tr_b16 v[192:193], v248 offset:32768
    buffer_load_dwordx4 v1, s[20:23], s68 offen offset:3072 sc1 lds
    v_mov_b32 v210, 0x3f803f80
    v_mfma_f32_16x16x32_bf16 v[200:203], v[180:183], a[104:107], v[200:203]
    ds_read_b64_tr_b16 v[194:195], v248 offset:33024
    buffer_store_dwordx4 v[240:243], v12, s[16:19], s84 offen offset:3072 sc1
    v_mfma_f32_16x16x32_bf16 v[204:207], v[180:183], a[108:111], v[204:207]
    ds_read_b64_tr_b16 v[196:197], v248 offset:34816
    v_cvt_pk_bf16_f32 v246, v228, v229
    v_mfma_f32_16x16x32_bf16 v[204:207], v[176:179], a[100:103], v[204:207]
    ds_read_b64_tr_b16 v[198:199], v248 offset:35072
    s_waitcnt lgkmcnt(4)
    v_cvt_pk_bf16_f32 v247, v230, v231
    v_mfma_f32_16x16x32_bf16 v[204:207], v[184:187], a[116:119], v[204:207]
    ds_read_b64_tr_b16 v[176:177], v249 offset:0
    s_add_u32 m0, s81, 77824
    s_add_u32 s68, s92, 53248
    v_mfma_f32_16x16x32_bf16 v[204:207], v[188:191], a[124:127], v[204:207]
    ds_read_b64_tr_b16 v[178:179], v249 offset:256
    v_pk_max_i16 v246, v246, 0
    v_mfma_f32_16x16x32_bf16 v[200:203], v[188:191], a[120:123], v[200:203]
    ds_read_b64_tr_b16 v[180:181], v249 offset:2048
    v_pk_max_i16 v247, v247, 0
    v_mfma_f32_16x16x32_bf16 v[200:203], v[184:187], a[112:115], v[200:203]
    ds_read_b64_tr_b16 v[182:183], v249 offset:2304
    s_waitcnt lgkmcnt(4)
    buffer_store_dwordx4 v[244:247], v13, s[16:19], s84 offen offset:3072 sc1
    v_mfma_f32_16x16x32_bf16 v[200:203], v[192:195], v[16:19], v[200:203]
    ds_read_b64_tr_b16 v[184:185], v249 offset:4096
    v_mov_b32 v211, 0x3f803f80
    v_mfma_f32_16x16x32_bf16 v[200:203], v[196:199], v[24:27], v[200:203]
    ds_read_b64_tr_b16 v[186:187], v249 offset:4352
    buffer_load_dwordx4 v1, s[20:23], s68 offen offset:0 sc1 lds
    v_mfma_f32_16x16x32_bf16 v[204:207], v[196:199], v[28:31], v[204:207]
    ds_read_b64_tr_b16 v[188:189], v249 offset:6144
    v_mfma_f32_16x16x32_bf16 v[204:207], v[192:195], v[20:23], v[204:207]
    ds_read_b64_tr_b16 v[190:191], v249 offset:6400
    s_waitcnt lgkmcnt(4)
    v_mfma_f32_16x16x32_bf16 v[216:219], v[176:179], a[0:3], 0
    ds_read_b64_tr_b16 v[192:193], v249 offset:8192
    v_mfma_f32_16x16x32_bf16 v[216:219], v[180:183], a[8:11], v[216:219]
    ds_read_b64_tr_b16 v[194:195], v249 offset:8448
    buffer_load_dwordx4 v1, s[20:23], s68 offen offset:1024 sc1 lds
    v_mfma_f32_16x16x32_bf16 v[220:223], v[176:179], a[4:7], 0
    ds_read_b64_tr_b16 v[196:197], v249 offset:10240
    v_mfma_f32_16x16x32_bf16 v[220:223], v[180:183], a[12:15], v[220:223]
    ds_read_b64_tr_b16 v[198:199], v249 offset:10496
    s_waitcnt lgkmcnt(4)
    v_mfma_f32_16x16x32_bf16 v[220:223], v[184:187], a[20:23], v[220:223]
    ds_read_b64_tr_b16 v[176:177], v249 offset:12288
    v_mfma_f32_16x16x32_bf16 v[220:223], v[188:191], a[28:31], v[220:223]
    ds_read_b64_tr_b16 v[178:179], v249 offset:12544
    v_mfma_f32_16x16x32_bf16 v[216:219], v[188:191], a[24:27], v[216:219]
    ds_read_b64_tr_b16 v[180:181], v249 offset:14336
    buffer_load_dwordx4 v1, s[20:23], s68 offen offset:2048 sc1 lds
    v_mfma_f32_16x16x32_bf16 v[216:219], v[184:187], a[16:19], v[216:219]
    ds_read_b64_tr_b16 v[182:183], v249 offset:14592
    s_waitcnt lgkmcnt(4)
    v_mfma_f32_16x16x32_bf16 v[216:219], v[192:195], a[32:35], v[216:219]
    ds_read_b64_tr_b16 v[184:185], v249 offset:16384
    v_cvt_pk_bf16_f32 v232, v200, v201
    v_mfma_f32_16x16x32_bf16 v[216:219], v[196:199], a[40:43], v[216:219]
    ds_read_b64_tr_b16 v[186:187], v249 offset:16640
    v_mfma_f32_16x16x32_bf16 v[220:223], v[196:199], a[44:47], v[220:223]
    ds_read_b64_tr_b16 v[188:189], v249 offset:18432
    buffer_load_dwordx4 v1, s[20:23], s68 offen offset:3072 sc1 lds
    v_mfma_f32_16x16x32_bf16 v[220:223], v[192:195], a[36:39], v[220:223]
    ds_read_b64_tr_b16 v[190:191], v249 offset:18688
    s_waitcnt lgkmcnt(4)
    v_mfma_f32_16x16x32_bf16 v[220:223], v[176:179], a[52:55], v[220:223]
    ds_read_b64_tr_b16 v[192:193], v249 offset:20480
    v_cvt_pk_bf16_f32 v233, v202, v203
    v_mfma_f32_16x16x32_bf16 v[220:223], v[180:183], a[60:63], v[220:223]
    ds_read_b64_tr_b16 v[194:195], v249 offset:20736
    v_mfma_f32_16x16x32_bf16 v[216:219], v[180:183], a[56:59], v[216:219]
    ds_read_b64_tr_b16 v[196:197], v249 offset:22528
    v_pk_max_i16 v232, v232, 0
    v_mfma_f32_16x16x32_bf16 v[216:219], v[176:179], a[48:51], v[216:219]
    ds_read_b64_tr_b16 v[198:199], v249 offset:22784
    s_waitcnt lgkmcnt(4)
    v_mfma_f32_16x16x32_bf16 v[216:219], v[184:187], a[64:67], v[216:219]
    ds_read_b64_tr_b16 v[176:177], v249 offset:24576
    s_add_u32 m0, s81, 81920
    s_add_u32 s68, s92, 57344
    v_mfma_f32_16x16x32_bf16 v[216:219], v[188:191], a[72:75], v[216:219]
    ds_read_b64_tr_b16 v[178:179], v249 offset:24832
    v_pk_max_i16 v233, v233, 0
    v_mfma_f32_16x16x32_bf16 v[220:223], v[188:191], a[76:79], v[220:223]
    ds_read_b64_tr_b16 v[180:181], v249 offset:26624
    v_mfma_f32_16x16x32_bf16 v[220:223], v[184:187], a[68:71], v[220:223]
    ds_read_b64_tr_b16 v[182:183], v249 offset:26880
    s_waitcnt lgkmcnt(4)
    v_mfma_f32_16x16x32_bf16 v[220:223], v[192:195], a[84:87], v[220:223]
    ds_read_b64_tr_b16 v[184:185], v249 offset:28672
    buffer_load_dwordx4 v1, s[20:23], s68 offen offset:0 sc1 lds
    v_mfma_f32_16x16x32_bf16 v[220:223], v[196:199], a[92:95], v[220:223]
    ds_read_b64_tr_b16 v[186:187], v249 offset:28928
    v_cvt_pk_bf16_f32 v236, v204, v205
    v_mfma_f32_16x16x32_bf16 v[216:219], v[196:199], a[88:91], v[216:219]
    ds_read_b64_tr_b16 v[188:189], v249 offset:30720
    v_mfma_f32_16x16x32_bf16 v[216:219], v[192:195], a[80:83], v[216:219]
    ds_read_b64_tr_b16 v[190:191], v249 offset:30976
    s_waitcnt lgkmcnt(4)
    v_mfma_f32_16x16x32_bf16 v[216:219], v[176:179], a[96:99], v[216:219]
    ds_read_b64_tr_b16 v[192:193], v249 offset:32768
    v_cvt_pk_bf16_f32 v237, v206, v207
    v_mfma_f32_16x16x32_bf16 v[216:219], v[180:183], a[104:107], v[216:219]
    ds_read_b64_tr_b16 v[194:195], v249 offset:33024
    v_mfma_f32_16x16x32_bf16 v[220:223], v[180:183], a[108:111], v[220:223]
    ds_read_b64_tr_b16 v[196:197], v249 offset:34816
    v_pk_max_i16 v236, v236, 0
    v_mfma_f32_16x16x32_bf16 v[220:223], v[176:179], a[100:103], v[220:223]
    ds_read_b64_tr_b16 v[198:199], v249 offset:35072
    s_waitcnt lgkmcnt(4)
    v_mfma_f32_16x16x32_bf16 v[220:223], v[184:187], a[116:119], v[220:223]
    ds_read_b128 a[192:195], v8 offset:8192
    v_mfma_f32_16x16x32_bf16 v[220:223], v[188:191], a[124:127], v[220:223]
    ds_read_b128 a[196:199], v8 offset:9216
    v_pk_max_i16 v237, v237, 0
    v_mfma_f32_16x16x32_bf16 v[216:219], v[188:191], a[120:123], v[216:219]
    ds_read_b128 a[200:203], v8 offset:10240
    v_mfma_f32_16x16x32_bf16 v[216:219], v[184:187], a[112:115], v[216:219]
    s_waitcnt lgkmcnt(3)
    ds_read_b128 a[204:207], v8 offset:11264
    v_mfma_f32_16x16x32_bf16 v[216:219], v[192:195], v[16:19], v[216:219]
    ds_read_b128 a[208:211], v8 offset:12288
    v_mfma_f32_16x16x32_bf16 v[216:219], v[196:199], v[24:27], v[216:219]
    ds_read_b128 a[212:215], v8 offset:13312
    v_mfma_f32_16x16x32_bf16 v[220:223], v[196:199], v[28:31], v[220:223]
    ds_read_b128 a[216:219], v8 offset:14336
    v_mfma_f32_16x16x32_bf16 v[220:223], v[192:195], v[20:23], v[220:223]
    ds_read_b128 a[220:223], v8 offset:15360
    s_add_u32 s93, s92, 81920
    s_mov_b32 s97, 32768
    s_mov_b32 s88, 0
    s_mov_b32 s36, s85
    s_mov_b32 s85, 0
    s_add_u32 s94, s81, 110592
    s_mov_b32 s96, 36864
    s_mov_b32 s4, 1
    s_mov_b32 s28, s60
    s_mov_b32 s29, s61
    s_mov_b32 s30, 0
    s_cmp_eq_u32 s3, 3
    s_cselect_b32 s72, s18, 0x1000
    s_cselect_b32 s73, s18, 0x2000
    v_add_u32 v8, s96, v1
    s_waitcnt lgkmcnt(7)
    v_mfma_f32_16x16x32_bf16 a[0:3], a[192:195], v[160:163], 0
    ds_read_b128 a[160:163], v8 offset:0
    s_waitcnt lgkmcnt(7)
    v_mfma_f32_16x16x32_bf16 a[16:19], a[196:199], v[160:163], 0
    ds_read_b128 a[164:167], v8 offset:1024
    v_mov_b32 v188, -1
    v_add_u32 v16, 0, v1
    v_add_u32 v17, 0, v1
    v_add_u32 v18, 0, v1
    v_lshrrev_b32 v14, 4, v1
    v_add_u32 v9, 0, v14
    v_mul_u32_u24 v176, 3641, v9
    v_lshrrev_b32 v176, 16, v176
    s_waitcnt lgkmcnt(7)
    v_mfma_f32_16x16x32_bf16 a[32:35], a[200:203], v[160:163], 0
    ds_read_b128 a[168:171], v8 offset:2048
    v_mov_b32 v189, -1
    s_waitcnt lgkmcnt(7)
    v_mfma_f32_16x16x32_bf16 a[48:51], a[204:207], v[160:163], 0
    ds_read_b128 a[172:175], v8 offset:3072
    v_mov_b32 v190, -1
    s_waitcnt lgkmcnt(7)
    v_mfma_f32_16x16x32_bf16 a[64:67], a[208:211], v[160:163], 0
    ds_read_b128 a[176:179], v8 offset:4096
    v_mov_b32 v191, -1
    s_waitcnt lgkmcnt(7)
    v_mfma_f32_16x16x32_bf16 a[80:83], a[212:215], v[160:163], 0
    ds_read_b128 a[180:183], v8 offset:5120
    v_add_u32 v19, 0, v1
    s_waitcnt lgkmcnt(7)
    v_mfma_f32_16x16x32_bf16 a[96:99], a[216:219], v[160:163], 0
    ds_read_b128 a[184:187], v8 offset:6144
    v_add_u32 v20, 4096, v1
    s_waitcnt lgkmcnt(7)
    v_mfma_f32_16x16x32_bf16 a[112:115], a[220:223], v[160:163], 0
    ds_read_b128 a[188:191], v8 offset:7168
    v_add_u32 v21, s72, v1
    v_mfma_f32_16x16x32_bf16 v[192:195], v[208:211], v[160:163], 0
    v_add_u32 v22, s72, v1
    v_add_u32 v23, s72, v1
    v_mfma_f32_16x16x32_bf16 a[4:7], a[192:195], v[164:167], 0
    v_add_u32 v24, s73, v1
    v_cvt_pk_bf16_f32 v234, v216, v217
    v_mfma_f32_16x16x32_bf16 a[20:23], a[196:199], v[164:167], 0
    v_cvt_pk_bf16_f32 v235, v218, v219
    v_mul_u32_u24 v176, 864, v176
    v_mfma_f32_16x16x32_bf16 a[36:39], a[200:203], v[164:167], 0
    v_lshl_add_u32 v176, v9, 4, v176
    v_add_u32 v9, 64, v14
    v_mfma_f32_16x16x32_bf16 a[52:55], a[204:207], v[164:167], 0
    s_xor_b32 s92, s88, s85
    v_mul_u32_u24 v177, 3641, v9
    v_lshrrev_b32 v177, 16, v177
    v_mfma_f32_16x16x32_bf16 a[68:71], a[208:211], v[164:167], 0
    v_mul_u32_u24 v177, 864, v177
    v_lshl_add_u32 v177, v9, 4, v177
    v_mfma_f32_16x16x32_bf16 a[84:87], a[212:215], v[164:167], 0
    s_mul_i32 s92, s92, s97
    s_mov_b32 s12, s54
    s_mov_b32 s13, s55
    v_mfma_f32_16x16x32_bf16 a[100:103], a[216:219], v[164:167], 0
    v_pk_max_i16 v234, v234, 0
    v_subrev_u32 v177, 1024, v177
    v_mfma_f32_16x16x32_bf16 a[116:119], a[220:223], v[164:167], 0
    s_add_u32 s92, s92, s93
    v_add_u32 v9, 128, v14
    v_mul_u32_u24 v178, 3641, v9
    v_mfma_f32_16x16x32_bf16 v[196:199], v[208:211], v[164:167], 0
    s_waitcnt lgkmcnt(0)
    s_add_u32 s70, s64, 1
    s_mul_i32 s14, s70, 1327104
    v_mfma_f32_16x16x32_bf16 v[64:67], a[160:163], v[48:51], v[128:131]
    s_add_u32 m0, s94, 0
    v_lshrrev_b32 v178, 16, v178
    v_mul_u32_u24 v178, 864, v178
    v_mfma_f32_16x16x32_bf16 v[64:67], a[164:167], v[80:83], v[64:67]
    v_lshl_add_u32 v178, v9, 4, v178
    v_subrev_u32 v178, 2048, v178
    v_mfma_f32_16x16x32_bf16 v[64:67], a[168:171], v[112:115], v[64:67]
    buffer_load_dwordx4 v16, s[20:23], s92 offen offset:0 sc1 lds
    v_mfma_f32_16x16x32_bf16 v[64:67], a[172:175], v[144:147], v[64:67]
    ds_read_b128 a[224:227], v8 offset:8192
    s_sub_u32 s70, s39, s7
    s_sub_u32 s67, s14, 1327104
    v_mfma_f32_16x16x32_bf16 v[68:71], a[176:179], v[48:51], v[128:131]
    buffer_load_dwordx4 v17, s[20:23], s92 offen offset:1024 sc1 lds
    v_mfma_f32_16x16x32_bf16 v[68:71], a[180:183], v[80:83], v[68:71]
    s_add_u32 s70, s70, s67
    v_pk_max_i16 v235, v235, 0
    v_add_u32 v9, 192, v14
    v_mfma_f32_16x16x32_bf16 v[68:71], a[184:187], v[112:115], v[68:71]
    buffer_store_dwordx4 v[232:235], v10, s[16:19], s36 offen offset:0 sc1
    v_mfma_f32_16x16x32_bf16 v[68:71], a[188:191], v[144:147], v[68:71]
    ds_read_b128 a[228:231], v8 offset:9216
    v_mul_u32_u24 v179, 3641, v9
    v_mfma_f32_16x16x32_bf16 a[8:11], a[192:195], v[168:171], 0
    buffer_load_dwordx4 v18, s[20:23], s92 offen offset:2048 sc1 lds
    v_mfma_f32_16x16x32_bf16 a[24:27], a[196:199], v[168:171], 0
    buffer_load_dwordx4 v19, s[20:23], s92 offen offset:3072 sc1 lds
    v_mfma_f32_16x16x32_bf16 a[40:43], a[200:203], v[168:171], 0
    s_add_u32 s38, s39, 344064
    s_add_u32 s67, s39, 688128
    v_lshrrev_b32 v179, 16, v179
    v_mfma_f32_16x16x32_bf16 a[56:59], a[204:207], v[168:171], 0
    ds_read_b128 a[232:235], v8 offset:10240
    s_add_u32 m0, s94, 4096
    v_mfma_f32_16x16x32_bf16 a[72:75], a[208:211], v[168:171], 0
    s_cmp_eq_u32 s5, 0
    s_cselect_b32 s14, s14, 0
    s_cselect_b32 s67, s67, s39
    v_mfma_f32_16x16x32_bf16 a[88:91], a[212:215], v[168:171], 0
    buffer_load_dwordx4 v20, s[20:23], s92 offen offset:0 sc1 lds
    v_mfma_f32_16x16x32_bf16 a[104:107], a[216:219], v[168:171], 0
    s_cmp_eq_u32 s5, 0
    s_cselect_b32 s38, s38, s18
    s_cselect_b32 s39, s39, s18
    v_mfma_f32_16x16x32_bf16 a[120:123], a[220:223], v[168:171], 0
    ds_read_b128 a[236:239], v8 offset:11264
    v_cvt_pk_bf16_f32 v238, v220, v221
    v_mfma_f32_16x16x32_bf16 v[200:203], v[208:211], v[168:171], 0
    buffer_load_dwordx4 v21, s[20:23], s92 offen offset:1024 sc1 lds
    v_mfma_f32_16x16x32_bf16 v[72:75], a[160:163], v[52:55], v[132:135]
    buffer_load_dwordx4 v22, s[20:23], s92 offen offset:2048 sc1 lds
    v_mfma_f32_16x16x32_bf16 v[72:75], a[164:167], v[84:87], v[72:75]
    s_lshl_b32 s72, s63, 14
    s_lshl_b32 s73, s3, 7
    v_cvt_pk_bf16_f32 v239, v222, v223
    v_exp_f32 v64, v64
    v_mfma_f32_16x16x32_bf16 v[72:75], a[168:171], v[116:119], v[72:75]
    v_exp_f32 v65, v65
    v_mfma_f32_16x16x32_bf16 v[72:75], a[172:175], v[148:151], v[72:75]
    ds_read_b128 a[240:243], v8 offset:12288
    v_pk_max_i16 v238, v238, 0
    v_mfma_f32_16x16x32_bf16 v[76:79], a[176:179], v[52:55], v[132:135]
    buffer_load_dwordx4 v23, s[20:23], s92 offen offset:3072 sc1 lds
    v_mfma_f32_16x16x32_bf16 v[76:79], a[180:183], v[84:87], v[76:79]
    s_add_u32 m0, s94, 8192
    v_exp_f32 v66, v66
    v_mfma_f32_16x16x32_bf16 v[76:79], a[184:187], v[116:119], v[76:79]
    s_add_u32 s72, s72, s73
    s_add_u32 s72, s72, 3276800
    v_exp_f32 v67, v67
    v_mfma_f32_16x16x32_bf16 v[76:79], a[188:191], v[148:151], v[76:79]
    ds_read_b128 a[244:247], v8 offset:13312
    v_cvt_pk_bf16_f32 v160, v64, v65
    v_mfma_f32_16x16x32_bf16 a[12:15], a[192:195], v[172:175], 0
    buffer_load_dwordx4 v24, s[20:23], s92 offen offset:0 sc1 lds
    v_mfma_f32_16x16x32_bf16 a[28:31], a[196:199], v[172:175], 0
    s_add_u32 s88, s88, 1
    v_pk_max_i16 v239, v239, 0
    v_mul_u32_u24 v179, 864, v179
    v_lshl_add_u32 v179, v9, 4, v179
    v_subrev_u32 v179, 3072, v179
    v_add_u32 v9, 256, v14
    v_mul_u32_u24 v180, 3641, v9
    v_lshrrev_b32 v180, 16, v180
    v_mul_u32_u24 v180, 864, v180
    v_mfma_f32_16x16x32_bf16 a[44:47], a[200:203], v[172:175], 0
    s_lshl_b32 s73, s62, 2
    s_add_u32 s91, s72, s73
    v_exp_f32 v68, v68
    v_mfma_f32_16x16x32_bf16 a[60:63], a[204:207], v[172:175], 0
    ds_read_b128 a[248:251], v8 offset:14336
    s_add_u32 s94, s94, 36864
    v_mfma_f32_16x16x32_bf16 a[76:79], a[208:211], v[172:175], 0
    s_add_u32 s91, s91, 8192
    v_exp_f32 v69, v69
    v_mfma_f32_16x16x32_bf16 a[92:95], a[212:215], v[172:175], 0
    s_cmp_ge_u32 s94, 147456
    s_cselect_b32 s94, s81, s94
    v_cvt_pk_bf16_f32 v161, v66, v67
    v_mfma_f32_16x16x32_bf16 a[108:111], a[216:219], v[172:175], 0
    buffer_store_dwordx4 v[236:239], v11, s[16:19], s36 offen offset:0 sc1
    v_mfma_f32_16x16x32_bf16 a[124:127], a[220:223], v[172:175], 0
    ds_read_b128 a[252:255], v8 offset:15360
    v_exp_f32 v70, v70
    v_mfma_f32_16x16x32_bf16 v[204:207], v[208:211], v[172:175], 0
    s_lshr_b32 s73, s62, 3
    s_lshl_b32 s73, s73, 11
    v_exp_f32 v71, v71
    v_mfma_f32_16x16x32_bf16 v[96:99], a[160:163], v[56:59], v[136:139]
    v_cvt_pk_bf16_f32 v162, v68, v69
    v_cvt_pk_bf16_f32 v163, v70, v71
    v_exp_f32 v72, v72
    v_mfma_f32_16x16x32_bf16 v[96:99], a[164:167], v[88:91], v[96:99]
    s_waitcnt vmcnt(11)
    s_barrier
    v_mfma_f32_16x16x32_bf16 v[96:99], a[168:171], v[120:123], v[96:99]
    s_xor_b32 s92, s88, s85
    v_exp_f32 v73, v73
    v_mfma_f32_16x16x32_bf16 v[96:99], a[172:175], v[152:155], v[96:99]
    ds_read_b128 a[128:131], v8 offset:16384
    v_exp_f32 v74, v74
    v_mfma_f32_16x16x32_bf16 v[100:103], a[176:179], v[56:59], v[136:139]
    buffer_store_dwordx4 v[188:191], v1, s[16:19], s95 offen offset:0 sc1
    v_mfma_f32_16x16x32_bf16 v[100:103], a[180:183], v[88:91], v[100:103]
    s_waitcnt lgkmcnt(1)
    s_mul_i32 s92, s92, s97
    v_lshl_add_u32 v180, v9, 4, v180
    v_add_u32 v9, 320, v14
    v_mul_u32_u24 v181, 3641, v9
    v_mfma_f32_16x16x32_bf16 v[100:103], a[184:187], v[120:123], v[100:103]
    s_add_u32 s90, s72, s73
    s_and_b32 s73, s62, 7
    v_exp_f32 v75, v75
    v_mfma_f32_16x16x32_bf16 v[100:103], a[188:191], v[152:155], v[100:103]
    ds_read_b128 a[132:135], v8 offset:17408
    v_cvt_pk_bf16_f32 v164, v72, v73
    v_mfma_f32_16x16x32_bf16 a[0:3], a[224:227], v[160:163], a[0:3]
    s_add_u32 s92, s92, s93
    v_exp_f32 v76, v76
    v_mfma_f32_16x16x32_bf16 a[16:19], a[228:231], v[160:163], a[16:19]
    s_lshl_b32 s73, s73, 2
    s_add_u32 s90, s90, s73
    v_exp_f32 v77, v77
    v_mfma_f32_16x16x32_bf16 a[32:35], a[232:235], v[160:163], a[32:35]
    s_lshl_b32 s73, s64, 2
    s_add_u32 s73, s73, s65
    v_cvt_pk_bf16_f32 v165, v74, v75
    v_lshrrev_b32 v181, 16, v181
    v_mul_u32_u24 v181, 864, v181
    v_lshl_add_u32 v181, v9, 4, v181
    v_mfma_f32_16x16x32_bf16 a[48:51], a[236:239], v[160:163], a[48:51]
    ds_read_b128 a[136:139], v8 offset:18432
    s_add_u32 m0, s94, 0
    v_mfma_f32_16x16x32_bf16 a[64:67], a[240:243], v[160:163], a[64:67]
    v_exp_f32 v78, v78
    v_mfma_f32_16x16x32_bf16 a[80:83], a[244:247], v[160:163], a[80:83]
    v_exp_f32 v79, v79
    v_mfma_f32_16x16x32_bf16 a[96:99], a[248:251], v[160:163], a[96:99]
    buffer_load_dwordx4 v16, s[20:23], s92 offen offset:0 sc1 lds
    v_mfma_f32_16x16x32_bf16 a[112:115], a[252:255], v[160:163], a[112:115]
    ds_read_b128 a[140:143], v8 offset:19456
    v_cvt_pk_bf16_f32 v166, v76, v77
    v_mfma_f32_16x16x32_bf16 v[192:195], v[208:211], v[160:163], v[192:195]
    s_lshl_b32 s73, s73, 9
    s_add_u32 s84, s72, s73
    v_cvt_pk_bf16_f32 v167, v78, v79
    v_subrev_u32 v181, 1024, v181
    v_add_u32 v9, 384, v14
    v_mul_u32_u24 v182, 3641, v9
    v_lshrrev_b32 v182, 16, v182
    v_mul_u32_u24 v182, 864, v182
    v_lshl_add_u32 v182, v9, 4, v182
    v_mfma_f32_16x16x32_bf16 v[104:107], a[160:163], v[60:63], v[140:143]
    v_exp_f32 v96, v96
    v_mfma_f32_16x16x32_bf16 v[104:107], a[164:167], v[92:95], v[104:107]
    buffer_store_dwordx4 v[188:191], v1, s[16:19], s95 offen offset:1024 sc1
    s_add_u32 s37, s84, 131072
    s_lshl_b32 s73, s64, 11
    v_mfma_f32_16x16x32_bf16 v[104:107], a[168:171], v[124:127], v[104:107]
    ds_read_b128 a[144:147], v8 offset:20480
    v_exp_f32 v97, v97
    v_mfma_f32_16x16x32_bf16 v[104:107], a[172:175], v[156:159], v[104:107]
    ds_read_b128 a[148:151], v8 offset:21504
    v_exp_f32 v98, v98
    v_mfma_f32_16x16x32_bf16 v[108:111], a[176:179], v[60:63], v[140:143]
    buffer_load_dwordx4 v17, s[20:23], s92 offen offset:1024 sc1 lds
    v_mfma_f32_16x16x32_bf16 v[108:111], a[180:183], v[92:95], v[108:111]
    buffer_load_dwordx4 v18, s[20:23], s92 offen offset:2048 sc1 lds
    v_mfma_f32_16x16x32_bf16 v[108:111], a[184:187], v[124:127], v[108:111]
    ds_read_b128 a[152:155], v8 offset:22528
    v_exp_f32 v99, v99
    v_mfma_f32_16x16x32_bf16 v[108:111], a[188:191], v[156:159], v[108:111]
    ds_read_b128 a[156:159], v8 offset:23552
    v_cvt_pk_bf16_f32 v168, v96, v97
    v_mfma_f32_16x16x32_bf16 a[4:7], a[224:227], v[164:167], a[4:7]
    buffer_load_dwordx4 v19, s[20:23], s92 offen offset:3072 sc1 lds
    v_mfma_f32_16x16x32_bf16 a[20:23], a[228:231], v[164:167], a[20:23]
    s_sub_u32 s89, s37, s73
    s_lshl_b32 s73, s64, 2
    v_exp_f32 v100, v100
    v_mfma_f32_16x16x32_bf16 a[36:39], a[232:235], v[164:167], a[36:39]
    s_add_u32 m0, s94, 4096
    v_exp_f32 v101, v101
    v_mfma_f32_16x16x32_bf16 a[52:55], a[236:239], v[164:167], a[52:55]
    s_add_u32 s89, s89, s73
    v_cvt_pk_bf16_f32 v169, v98, v99
    v_subrev_u32 v182, 2048, v182
    v_add_u32 v9, 448, v14
    v_mul_u32_u24 v183, 3641, v9
    v_lshrrev_b32 v183, 16, v183
    v_mfma_f32_16x16x32_bf16 a[68:71], a[240:243], v[164:167], a[68:71]
    v_exp_f32 v102, v102
    v_mfma_f32_16x16x32_bf16 a[84:87], a[244:247], v[164:167], a[84:87]
    buffer_load_dwordx4 v20, s[20:23], s92 offen offset:0 sc1 lds
    v_mfma_f32_16x16x32_bf16 a[100:103], a[248:251], v[164:167], a[100:103]
    s_waitcnt lgkmcnt(0)
    v_exp_f32 v103, v103
    v_mfma_f32_16x16x32_bf16 a[116:119], a[252:255], v[164:167], a[116:119]
    s_movk_i32 s73, 0x30
    s_cmp_eq_u32 s5, 0
    s_cselect_b32 s73, s73, 0x1f0
    v_cvt_pk_bf16_f32 v170, v100, v101
    v_cvt_pk_bf16_f32 v171, v102, v103
    v_mfma_f32_16x16x32_bf16 v[196:199], v[208:211], v[164:167], v[196:199]
    buffer_store_dwordx4 v[188:191], v1, s[16:19], s95 offen offset:2048 sc1
    v_mfma_f32_16x16x32_bf16 v[64:67], a[128:131], v[48:51], v[128:131]
    buffer_load_dwordx4 v21, s[20:23], s92 offen offset:1024 sc1 lds
    v_mfma_f32_16x16x32_bf16 v[64:67], a[132:135], v[80:83], v[64:67]
    v_exp_f32 v104, v104
    v_mfma_f32_16x16x32_bf16 v[64:67], a[136:139], v[112:115], v[64:67]
    v_exp_f32 v105, v105
    v_mfma_f32_16x16x32_bf16 v[64:67], a[140:143], v[144:147], v[64:67]
    ds_read_b128 a[192:195], v8 offset:24576
    v_mul_u32_u24 v183, 864, v183
    v_lshl_add_u32 v183, v9, 4, v183
    v_subrev_u32 v183, 3072, v183
    v_add_u32 v9, 512, v14
    v_mfma_f32_16x16x32_bf16 v[68:71], a[144:147], v[48:51], v[128:131]
    buffer_load_dwordx4 v22, s[20:23], s92 offen offset:2048 sc1 lds
    v_mfma_f32_16x16x32_bf16 v[68:71], a[148:151], v[80:83], v[68:71]
    v_exp_f32 v106, v106
    v_exp_f32 v107, v107
    v_mfma_f32_16x16x32_bf16 v[68:71], a[152:155], v[112:115], v[68:71]
    buffer_load_dwordx4 v23, s[20:23], s92 offen offset:3072 sc1 lds
    v_mfma_f32_16x16x32_bf16 v[68:71], a[156:159], v[144:147], v[68:71]
    ds_read_b128 a[196:199], v8 offset:25600
    v_cvt_pk_bf16_f32 v172, v104, v105
    v_mfma_f32_16x16x32_bf16 a[8:11], a[224:227], v[168:171], a[8:11]
    v_exp_f32 v108, v108
    v_mfma_f32_16x16x32_bf16 a[24:27], a[228:231], v[168:171], a[24:27]
    s_add_u32 m0, s94, 8192
    v_exp_f32 v109, v109
    v_mfma_f32_16x16x32_bf16 a[40:43], a[232:235], v[168:171], a[40:43]
    v_cvt_pk_bf16_f32 v173, v106, v107
    v_mul_u32_u24 v184, 3641, v9
    v_mfma_f32_16x16x32_bf16 a[56:59], a[236:239], v[168:171], a[56:59]
    ds_read_b128 a[200:203], v8 offset:26624
    v_lshrrev_b32 v184, 16, v184
    v_mul_u32_u24 v184, 864, v184
    v_mfma_f32_16x16x32_bf16 a[72:75], a[240:243], v[168:171], a[72:75]
    buffer_load_dwordx4 v24, s[20:23], s92 offen offset:0 sc1 lds
    v_mfma_f32_16x16x32_bf16 a[88:91], a[244:247], v[168:171], a[88:91]
    v_exp_f32 v110, v110
    v_mfma_f32_16x16x32_bf16 a[104:107], a[248:251], v[168:171], a[104:107]
    s_add_u32 s95, s95, 3072
    v_exp_f32 v111, v111
    v_mfma_f32_16x16x32_bf16 a[120:123], a[252:255], v[168:171], a[120:123]
    ds_read_b128 a[204:207], v8 offset:27648
    v_cvt_pk_bf16_f32 v174, v108, v109
    v_mfma_f32_16x16x32_bf16 v[200:203], v[208:211], v[168:171], v[200:203]
    s_add_u32 s88, s88, 1
    v_cvt_pk_bf16_f32 v175, v110, v111
    v_lshl_add_u32 v184, v9, 4, v184
    v_mfma_f32_16x16x32_bf16 v[72:75], a[128:131], v[52:55], v[132:135]
    v_exp_f32 v64, v64
    v_mfma_f32_16x16x32_bf16 v[72:75], a[132:135], v[84:87], v[72:75]
    v_exp_f32 v65, v65
    v_mfma_f32_16x16x32_bf16 v[72:75], a[136:139], v[116:119], v[72:75]
    s_add_u32 s94, s94, 36864
    v_exp_f32 v66, v66
    v_mfma_f32_16x16x32_bf16 v[72:75], a[140:143], v[148:151], v[72:75]
    ds_read_b128 a[208:211], v8 offset:28672
    v_and_b32 v9, s73, v1
    v_mfma_f32_16x16x32_bf16 v[76:79], a[144:147], v[52:55], v[132:135]
    v_exp_f32 v67, v67
    v_mfma_f32_16x16x32_bf16 v[76:79], a[148:151], v[84:87], v[76:79]
    s_cmp_ge_u32 s94, 147456
    s_cselect_b32 s94, s81, s94
    v_cvt_pk_bf16_f32 v160, v64, v65
    v_mfma_f32_16x16x32_bf16 v[76:79], a[152:155], v[116:119], v[76:79]
    v_exp_f32 v68, v68
    v_mfma_f32_16x16x32_bf16 v[76:79], a[156:159], v[148:151], v[76:79]
    ds_read_b128 a[212:215], v8 offset:29696
    v_lshrrev_b32 v9, 2, v9
    v_mfma_f32_16x16x32_bf16 a[12:15], a[224:227], v[172:175], a[12:15]
    s_add_u32 s96, s96, 36864
    v_exp_f32 v69, v69
    v_mfma_f32_16x16x32_bf16 a[28:31], a[228:231], v[172:175], a[28:31]
    v_cvt_pk_bf16_f32 v161, v66, v67
    v_lshlrev_b32 v14, 5, v1
    v_mfma_f32_16x16x32_bf16 a[44:47], a[232:235], v[172:175], a[44:47]
    v_exp_f32 v70, v70
    v_mfma_f32_16x16x32_bf16 a[60:63], a[236:239], v[172:175], a[60:63]
    ds_read_b128 a[216:219], v8 offset:30720
    v_mfma_f32_16x16x32_bf16 a[76:79], a[240:243], v[172:175], a[76:79]
    s_cmp_eq_u32 s96, 147456
    s_cselect_b32 s96, 0, s96
    v_mfma_f32_16x16x32_bf16 a[92:95], a[244:247], v[172:175], a[92:95]
    v_exp_f32 v71, v71
    v_mfma_f32_16x16x32_bf16 a[108:111], a[248:251], v[172:175], a[108:111]
    v_cvt_pk_bf16_f32 v162, v68, v69
    v_cvt_pk_bf16_f32 v163, v70, v71
    v_mfma_f32_16x16x32_bf16 a[124:127], a[252:255], v[172:175], a[124:127]
    ds_read_b128 a[220:223], v8 offset:31744
    v_mfma_f32_16x16x32_bf16 v[204:207], v[208:211], v[172:175], v[204:207]
    s_waitcnt vmcnt(12)
    s_mov_b64 exec, 0xffff
    buffer_store_dword v7, v14, s[16:19], s91 offen sc1
    s_mov_b64 exec, -1
.p2align 3
KF_aloop:
    s_cmp_eq_u32 s4, 5
    s_cbranch_scc1 KF_sw
KF_oolr:
    v_add_u32 v8, s96, v1
    v_mfma_f32_16x16x32_bf16 v[96:99], a[128:131], v[56:59], v[136:139]
    v_exp_f32 v72, v72
    v_mfma_f32_16x16x32_bf16 v[96:99], a[132:135], v[88:91], v[96:99]
    v_exp_f32 v73, v73
    v_mfma_f32_16x16x32_bf16 v[96:99], a[136:139], v[120:123], v[96:99]
    buffer_store_dwordx4 v[188:191], v1, s[16:19], s95 offen offset:0 sc1
    v_mfma_f32_16x16x32_bf16 v[96:99], a[140:143], v[152:155], v[96:99]
    ds_read_b128 a[160:163], v8 offset:0
    v_mfma_f32_16x16x32_bf16 v[100:103], a[144:147], v[56:59], v[136:139]
    v_exp_f32 v74, v74
    v_mfma_f32_16x16x32_bf16 v[100:103], a[148:151], v[88:91], v[100:103]
    s_waitcnt lgkmcnt(1)
    v_exp_f32 v75, v75
    v_mfma_f32_16x16x32_bf16 v[100:103], a[152:155], v[120:123], v[100:103]
    v_cvt_pk_bf16_f32 v164, v72, v73
    v_mfma_f32_16x16x32_bf16 v[100:103], a[156:159], v[152:155], v[100:103]
    ds_read_b128 a[164:167], v8 offset:1024
    v_mfma_f32_16x16x32_bf16 a[0:3], a[192:195], v[160:163], a[0:3]
    v_exp_f32 v76, v76
    v_mfma_f32_16x16x32_bf16 a[16:19], a[196:199], v[160:163], a[16:19]
    v_exp_f32 v77, v77
    v_mfma_f32_16x16x32_bf16 a[32:35], a[200:203], v[160:163], a[32:35]
    v_cvt_pk_bf16_f32 v165, v74, v75
    v_mfma_f32_16x16x32_bf16 a[48:51], a[204:207], v[160:163], a[48:51]
    ds_read_b128 a[168:171], v8 offset:2048
    v_mfma_f32_16x16x32_bf16 a[64:67], a[208:211], v[160:163], a[64:67]
    v_exp_f32 v78, v78
    v_mfma_f32_16x16x32_bf16 a[80:83], a[212:215], v[160:163], a[80:83]
    v_exp_f32 v79, v79
    v_mfma_f32_16x16x32_bf16 a[96:99], a[216:219], v[160:163], a[96:99]
    v_cvt_pk_bf16_f32 v166, v76, v77
    v_cvt_pk_bf16_f32 v167, v78, v79
    v_mfma_f32_16x16x32_bf16 a[112:115], a[220:223], v[160:163], a[112:115]
    ds_read_b128 a[172:175], v8 offset:3072
    v_mfma_f32_16x16x32_bf16 v[192:195], v[208:211], v[160:163], v[192:195]
    v_mfma_f32_16x16x32_bf16 v[104:107], a[128:131], v[60:63], v[140:143]
    v_exp_f32 v96, v96
    v_mfma_f32_16x16x32_bf16 v[104:107], a[132:135], v[92:95], v[104:107]
    v_exp_f32 v97, v97
    v_mfma_f32_16x16x32_bf16 v[104:107], a[136:139], v[124:127], v[104:107]
    ds_read_b128 a[176:179], v8 offset:4096
    v_mfma_f32_16x16x32_bf16 v[104:107], a[140:143], v[156:159], v[104:107]
    ds_read_b128 a[180:183], v8 offset:5120
    v_mfma_f32_16x16x32_bf16 v[108:111], a[144:147], v[60:63], v[140:143]
    v_exp_f32 v98, v98
    v_mfma_f32_16x16x32_bf16 v[108:111], a[148:151], v[92:95], v[108:111]
    v_exp_f32 v99, v99
    v_mfma_f32_16x16x32_bf16 v[108:111], a[152:155], v[124:127], v[108:111]
    ds_read_b128 a[184:187], v8 offset:6144
    v_cvt_pk_bf16_f32 v168, v96, v97
    v_mfma_f32_16x16x32_bf16 v[108:111], a[156:159], v[156:159], v[108:111]
    ds_read_b128 a[188:191], v8 offset:7168
    v_mfma_f32_16x16x32_bf16 a[4:7], a[192:195], v[164:167], a[4:7]
    v_exp_f32 v100, v100
    v_mfma_f32_16x16x32_bf16 a[20:23], a[196:199], v[164:167], a[20:23]
    v_exp_f32 v101, v101
    v_mfma_f32_16x16x32_bf16 a[36:39], a[200:203], v[164:167], a[36:39]
    v_cvt_pk_bf16_f32 v169, v98, v99
    v_mfma_f32_16x16x32_bf16 a[52:55], a[204:207], v[164:167], a[52:55]
    s_waitcnt vmcnt(16)
    s_barrier
    v_mfma_f32_16x16x32_bf16 a[68:71], a[208:211], v[164:167], a[68:71]
    s_xor_b32 s92, s88, s85
    v_exp_f32 v102, v102
    v_mfma_f32_16x16x32_bf16 a[84:87], a[212:215], v[164:167], a[84:87]
    v_exp_f32 v103, v103
    v_mfma_f32_16x16x32_bf16 a[100:103], a[216:219], v[164:167], a[100:103]
    s_waitcnt lgkmcnt(0)
    v_cvt_pk_bf16_f32 v170, v100, v101
    v_cvt_pk_bf16_f32 v171, v102, v103
    v_mfma_f32_16x16x32_bf16 a[116:119], a[220:223], v[164:167], a[116:119]
    v_mfma_f32_16x16x32_bf16 v[196:199], v[208:211], v[164:167], v[196:199]
    s_mul_i32 s92, s92, s97
    v_mfma_f32_16x16x32_bf16 v[64:67], a[160:163], v[48:51], v[128:131]
    buffer_store_dwordx4 v[188:191], v1, s[16:19], s95 offen offset:1024 sc1
    v_mfma_f32_16x16x32_bf16 v[64:67], a[164:167], v[80:83], v[64:67]
    v_exp_f32 v104, v104
    v_mfma_f32_16x16x32_bf16 v[64:67], a[168:171], v[112:115], v[64:67]
    v_exp_f32 v105, v105
    v_mfma_f32_16x16x32_bf16 v[64:67], a[172:175], v[144:147], v[64:67]
    ds_read_b128 a[224:227], v8 offset:8192
    s_add_u32 s92, s92, s93
    v_mfma_f32_16x16x32_bf16 v[68:71], a[176:179], v[48:51], v[128:131]
    v_exp_f32 v106, v106
    v_mfma_f32_16x16x32_bf16 v[68:71], a[180:183], v[80:83], v[68:71]
    v_exp_f32 v107, v107
    v_mfma_f32_16x16x32_bf16 v[68:71], a[184:187], v[112:115], v[68:71]
    v_cvt_pk_bf16_f32 v172, v104, v105
    v_mfma_f32_16x16x32_bf16 v[68:71], a[188:191], v[144:147], v[68:71]
    ds_read_b128 a[228:231], v8 offset:9216
    s_add_u32 m0, s94, 0
    v_mfma_f32_16x16x32_bf16 a[8:11], a[192:195], v[168:171], a[8:11]
    v_exp_f32 v108, v108
    v_mfma_f32_16x16x32_bf16 a[24:27], a[196:199], v[168:171], a[24:27]
    v_exp_f32 v109, v109
    v_mfma_f32_16x16x32_bf16 a[40:43], a[200:203], v[168:171], a[40:43]
    v_cvt_pk_bf16_f32 v173, v106, v107
    v_mfma_f32_16x16x32_bf16 a[56:59], a[204:207], v[168:171], a[56:59]
    ds_read_b128 a[232:235], v8 offset:10240
    v_mfma_f32_16x16x32_bf16 a[72:75], a[208:211], v[168:171], a[72:75]
    buffer_load_dwordx4 v16, s[20:23], s92 offen offset:0 sc1 lds
    v_mfma_f32_16x16x32_bf16 a[88:91], a[212:215], v[168:171], a[88:91]
    v_exp_f32 v110, v110
    v_mfma_f32_16x16x32_bf16 a[104:107], a[216:219], v[168:171], a[104:107]
    v_exp_f32 v111, v111
    v_mfma_f32_16x16x32_bf16 a[120:123], a[220:223], v[168:171], a[120:123]
    ds_read_b128 a[236:239], v8 offset:11264
    v_cvt_pk_bf16_f32 v174, v108, v109
    v_mfma_f32_16x16x32_bf16 v[200:203], v[208:211], v[168:171], v[200:203]
    buffer_load_dwordx4 v17, s[20:23], s92 offen offset:1024 sc1 lds
    v_mfma_f32_16x16x32_bf16 v[72:75], a[160:163], v[52:55], v[132:135]
    v_cvt_pk_bf16_f32 v175, v110, v111
    v_mfma_f32_16x16x32_bf16 v[72:75], a[164:167], v[84:87], v[72:75]
    v_exp_f32 v64, v64
    v_mfma_f32_16x16x32_bf16 v[72:75], a[168:171], v[116:119], v[72:75]
    v_exp_f32 v65, v65
    v_mfma_f32_16x16x32_bf16 v[72:75], a[172:175], v[148:151], v[72:75]
    ds_read_b128 a[240:243], v8 offset:12288
    v_mfma_f32_16x16x32_bf16 v[76:79], a[176:179], v[52:55], v[132:135]
    buffer_load_dwordx4 v18, s[20:23], s92 offen offset:2048 sc1 lds
    v_mfma_f32_16x16x32_bf16 v[76:79], a[180:183], v[84:87], v[76:79]
    v_exp_f32 v66, v66
    v_mfma_f32_16x16x32_bf16 v[76:79], a[184:187], v[116:119], v[76:79]
    v_exp_f32 v67, v67
    v_mfma_f32_16x16x32_bf16 v[76:79], a[188:191], v[148:151], v[76:79]
    ds_read_b128 a[244:247], v8 offset:13312
    v_cvt_pk_bf16_f32 v160, v64, v65
    v_mfma_f32_16x16x32_bf16 a[12:15], a[192:195], v[172:175], a[12:15]
    buffer_load_dwordx4 v19, s[20:23], s92 offen offset:3072 sc1 lds
    v_mfma_f32_16x16x32_bf16 a[28:31], a[196:199], v[172:175], a[28:31]
    v_exp_f32 v68, v68
    v_mfma_f32_16x16x32_bf16 a[44:47], a[200:203], v[172:175], a[44:47]
    v_exp_f32 v69, v69
    v_mfma_f32_16x16x32_bf16 a[60:63], a[204:207], v[172:175], a[60:63]
    ds_read_b128 a[248:251], v8 offset:14336
    s_add_u32 m0, s94, 4096
    v_mfma_f32_16x16x32_bf16 a[76:79], a[208:211], v[172:175], a[76:79]
    v_cvt_pk_bf16_f32 v161, v66, v67
    v_mfma_f32_16x16x32_bf16 a[92:95], a[212:215], v[172:175], a[92:95]
    v_exp_f32 v70, v70
    v_mfma_f32_16x16x32_bf16 a[108:111], a[216:219], v[172:175], a[108:111]
    v_exp_f32 v71, v71
    v_mfma_f32_16x16x32_bf16 a[124:127], a[220:223], v[172:175], a[124:127]
    ds_read_b128 a[252:255], v8 offset:15360
    v_cvt_pk_bf16_f32 v162, v68, v69
    v_mfma_f32_16x16x32_bf16 v[204:207], v[208:211], v[172:175], v[204:207]
    buffer_store_dwordx4 v[188:191], v1, s[16:19], s95 offen offset:2048 sc1
    v_mfma_f32_16x16x32_bf16 v[96:99], a[160:163], v[56:59], v[136:139]
    buffer_load_dwordx4 v20, s[20:23], s92 offen offset:0 sc1 lds
    v_mfma_f32_16x16x32_bf16 v[96:99], a[164:167], v[88:91], v[96:99]
    v_cvt_pk_bf16_f32 v163, v70, v71
    v_exp_f32 v72, v72
    v_mfma_f32_16x16x32_bf16 v[96:99], a[168:171], v[120:123], v[96:99]
    v_exp_f32 v73, v73
    v_mfma_f32_16x16x32_bf16 v[96:99], a[172:175], v[152:155], v[96:99]
    ds_read_b128 a[128:131], v8 offset:16384
    v_mfma_f32_16x16x32_bf16 v[100:103], a[176:179], v[56:59], v[136:139]
    buffer_load_dwordx4 v21, s[20:23], s92 offen offset:1024 sc1 lds
    v_mfma_f32_16x16x32_bf16 v[100:103], a[180:183], v[88:91], v[100:103]
    s_waitcnt lgkmcnt(1)
    v_exp_f32 v74, v74
    v_mfma_f32_16x16x32_bf16 v[100:103], a[184:187], v[120:123], v[100:103]
    v_exp_f32 v75, v75
    v_mfma_f32_16x16x32_bf16 v[100:103], a[188:191], v[152:155], v[100:103]
    ds_read_b128 a[132:135], v8 offset:17408
    v_cvt_pk_bf16_f32 v164, v72, v73
    v_mfma_f32_16x16x32_bf16 a[0:3], a[224:227], v[160:163], a[0:3]
    buffer_load_dwordx4 v22, s[20:23], s92 offen offset:2048 sc1 lds
    v_mfma_f32_16x16x32_bf16 a[16:19], a[228:231], v[160:163], a[16:19]
    v_exp_f32 v76, v76
    v_mfma_f32_16x16x32_bf16 a[32:35], a[232:235], v[160:163], a[32:35]
    v_exp_f32 v77, v77
    v_mfma_f32_16x16x32_bf16 a[48:51], a[236:239], v[160:163], a[48:51]
    ds_read_b128 a[136:139], v8 offset:18432
    v_cvt_pk_bf16_f32 v165, v74, v75
    v_mfma_f32_16x16x32_bf16 a[64:67], a[240:243], v[160:163], a[64:67]
    buffer_load_dwordx4 v23, s[20:23], s92 offen offset:3072 sc1 lds
    v_mfma_f32_16x16x32_bf16 a[80:83], a[244:247], v[160:163], a[80:83]
    v_exp_f32 v78, v78
    v_mfma_f32_16x16x32_bf16 a[96:99], a[248:251], v[160:163], a[96:99]
    v_exp_f32 v79, v79
    v_mfma_f32_16x16x32_bf16 a[112:115], a[252:255], v[160:163], a[112:115]
    ds_read_b128 a[140:143], v8 offset:19456
    s_add_u32 m0, s94, 8192
    v_mfma_f32_16x16x32_bf16 v[192:195], v[208:211], v[160:163], v[192:195]
    v_cvt_pk_bf16_f32 v166, v76, v77
    v_cvt_pk_bf16_f32 v167, v78, v79
    v_mfma_f32_16x16x32_bf16 v[104:107], a[160:163], v[60:63], v[140:143]
    v_exp_f32 v96, v96
    v_mfma_f32_16x16x32_bf16 v[104:107], a[164:167], v[92:95], v[104:107]
    v_exp_f32 v97, v97
    v_mfma_f32_16x16x32_bf16 v[104:107], a[168:171], v[124:127], v[104:107]
    ds_read_b128 a[144:147], v8 offset:20480
    v_mfma_f32_16x16x32_bf16 v[104:107], a[172:175], v[156:159], v[104:107]
    ds_read_b128 a[148:151], v8 offset:21504
    v_mfma_f32_16x16x32_bf16 v[108:111], a[176:179], v[60:63], v[140:143]
    buffer_load_dwordx4 v24, s[20:23], s92 offen offset:0 sc1 lds
    v_mfma_f32_16x16x32_bf16 v[108:111], a[180:183], v[92:95], v[108:111]
    v_exp_f32 v98, v98
    v_mfma_f32_16x16x32_bf16 v[108:111], a[184:187], v[124:127], v[108:111]
    ds_read_b128 a[152:155], v8 offset:22528
    v_exp_f32 v99, v99
    v_mfma_f32_16x16x32_bf16 v[108:111], a[188:191], v[156:159], v[108:111]
    ds_read_b128 a[156:159], v8 offset:23552
    s_add_u32 s88, s88, 1
    v_mfma_f32_16x16x32_bf16 a[4:7], a[224:227], v[164:167], a[4:7]
    v_cvt_pk_bf16_f32 v168, v96, v97
    v_mfma_f32_16x16x32_bf16 a[20:23], a[228:231], v[164:167], a[20:23]
    v_exp_f32 v100, v100
    v_mfma_f32_16x16x32_bf16 a[36:39], a[232:235], v[164:167], a[36:39]
    v_exp_f32 v101, v101
    v_mfma_f32_16x16x32_bf16 a[52:55], a[236:239], v[164:167], a[52:55]
    s_add_u32 s94, s94, 36864
    v_cvt_pk_bf16_f32 v169, v98, v99
    v_mfma_f32_16x16x32_bf16 a[68:71], a[240:243], v[164:167], a[68:71]
    v_exp_f32 v102, v102
    v_mfma_f32_16x16x32_bf16 a[84:87], a[244:247], v[164:167], a[84:87]
    v_exp_f32 v103, v103
    v_mfma_f32_16x16x32_bf16 a[100:103], a[248:251], v[164:167], a[100:103]
    s_waitcnt lgkmcnt(0)
    s_add_u32 s95, s95, 3072
    v_cvt_pk_bf16_f32 v170, v100, v101
    v_mfma_f32_16x16x32_bf16 a[116:119], a[252:255], v[164:167], a[116:119]
    s_cmp_ge_u32 s94, 147456
    s_cselect_b32 s94, s81, s94
    v_cvt_pk_bf16_f32 v171, v102, v103
    v_mfma_f32_16x16x32_bf16 v[196:199], v[208:211], v[164:167], v[196:199]
    v_mfma_f32_16x16x32_bf16 v[64:67], a[128:131], v[48:51], v[128:131]
    v_exp_f32 v104, v104
    v_mfma_f32_16x16x32_bf16 v[64:67], a[132:135], v[80:83], v[64:67]
    v_exp_f32 v105, v105
    v_mfma_f32_16x16x32_bf16 v[64:67], a[136:139], v[112:115], v[64:67]
    s_add_u32 s96, s96, 36864
    v_exp_f32 v106, v106
    v_mfma_f32_16x16x32_bf16 v[64:67], a[140:143], v[144:147], v[64:67]
    ds_read_b128 a[192:195], v8 offset:24576
    v_mfma_f32_16x16x32_bf16 v[68:71], a[144:147], v[48:51], v[128:131]
    v_exp_f32 v107, v107
    v_mfma_f32_16x16x32_bf16 v[68:71], a[148:151], v[80:83], v[68:71]
    v_cvt_pk_bf16_f32 v172, v104, v105
    v_mfma_f32_16x16x32_bf16 v[68:71], a[152:155], v[112:115], v[68:71]
    s_cmp_eq_u32 s96, 147456
    s_cselect_b32 s96, 0, s96
    v_mfma_f32_16x16x32_bf16 v[68:71], a[156:159], v[144:147], v[68:71]
    ds_read_b128 a[196:199], v8 offset:25600
    v_mfma_f32_16x16x32_bf16 a[8:11], a[224:227], v[168:171], a[8:11]
    v_exp_f32 v108, v108
    v_mfma_f32_16x16x32_bf16 a[24:27], a[228:231], v[168:171], a[24:27]
    v_exp_f32 v109, v109
    v_mfma_f32_16x16x32_bf16 a[40:43], a[232:235], v[168:171], a[40:43]
    v_cvt_pk_bf16_f32 v173, v106, v107
    v_mfma_f32_16x16x32_bf16 a[56:59], a[236:239], v[168:171], a[56:59]
    ds_read_b128 a[200:203], v8 offset:26624
    v_mfma_f32_16x16x32_bf16 a[72:75], a[240:243], v[168:171], a[72:75]
    s_mov_b64 exec, 0x1fffff
    buffer_load_dword v0, v254, s[24:27], s39 offen
    buffer_load_dword v0, v254, s[12:15], s70 offen
    s_mov_b64 exec, -1
    v_mfma_f32_16x16x32_bf16 a[88:91], a[244:247], v[168:171], a[88:91]
    v_exp_f32 v110, v110
    v_mfma_f32_16x16x32_bf16 a[104:107], a[248:251], v[168:171], a[104:107]
    v_exp_f32 v111, v111
    v_mfma_f32_16x16x32_bf16 a[120:123], a[252:255], v[168:171], a[120:123]
    ds_read_b128 a[204:207], v8 offset:27648
    s_mov_b32 s39, s38
    v_mfma_f32_16x16x32_bf16 v[200:203], v[208:211], v[168:171], v[200:203]
    v_cvt_pk_bf16_f32 v174, v108, v109
    v_cvt_pk_bf16_f32 v175, v110, v111
    v_mfma_f32_16x16x32_bf16 v[72:75], a[128:131], v[52:55], v[132:135]
    v_exp_f32 v64, v64
    v_mfma_f32_16x16x32_bf16 v[72:75], a[132:135], v[84:87], v[72:75]
    v_exp_f32 v65, v65
    v_mfma_f32_16x16x32_bf16 v[72:75], a[136:139], v[116:119], v[72:75]
    s_mov_b32 s38, s67
    v_exp_f32 v66, v66
    v_mfma_f32_16x16x32_bf16 v[72:75], a[140:143], v[148:151], v[72:75]
    ds_read_b128 a[208:211], v8 offset:28672
    v_mfma_f32_16x16x32_bf16 v[76:79], a[144:147], v[52:55], v[132:135]
    v_exp_f32 v67, v67
    v_mfma_f32_16x16x32_bf16 v[76:79], a[148:151], v[84:87], v[76:79]
    v_cvt_pk_bf16_f32 v160, v64, v65
    v_mfma_f32_16x16x32_bf16 v[76:79], a[152:155], v[116:119], v[76:79]
    s_add_u32 s67, s67, 344064
    v_exp_f32 v68, v68
    v_mfma_f32_16x16x32_bf16 v[76:79], a[156:159], v[148:151], v[76:79]
    ds_read_b128 a[212:215], v8 offset:29696
    v_mfma_f32_16x16x32_bf16 a[12:15], a[224:227], v[172:175], a[12:15]
    v_exp_f32 v69, v69
    v_mfma_f32_16x16x32_bf16 a[28:31], a[228:231], v[172:175], a[28:31]
    v_cvt_pk_bf16_f32 v161, v66, v67
    v_mfma_f32_16x16x32_bf16 a[44:47], a[232:235], v[172:175], a[44:47]
    s_add_u32 s70, s70, 344064
    v_exp_f32 v70, v70
    v_mfma_f32_16x16x32_bf16 a[60:63], a[236:239], v[172:175], a[60:63]
    ds_read_b128 a[216:219], v8 offset:30720
    v_mfma_f32_16x16x32_bf16 a[76:79], a[240:243], v[172:175], a[76:79]
    v_exp_f32 v71, v71
    v_mfma_f32_16x16x32_bf16 a[92:95], a[244:247], v[172:175], a[92:95]
    v_cvt_pk_bf16_f32 v162, v68, v69
    v_cvt_pk_bf16_f32 v163, v70, v71
    v_mfma_f32_16x16x32_bf16 a[108:111], a[248:251], v[172:175], a[108:111]
    v_mfma_f32_16x16x32_bf16 a[124:127], a[252:255], v[172:175], a[124:127]
    ds_read_b128 a[220:223], v8 offset:31744
    v_mfma_f32_16x16x32_bf16 v[204:207], v[208:211], v[172:175], v[204:207]
    s_add_u32 s4, s4, 1
    s_cmp_lt_u32 s4, 7
    s_cbranch_scc1 KF_aloop
    s_cmp_eq_u32 s5, 0
    s_cbranch_scc1 KF_nock
    s_waitcnt vmcnt(18)
    v_cmp_ne_u32 vcc, v40, v7
    s_nop 0
    s_nop 0
    s_cbranch_vccnz KF_ck10
KF_cr11:
KF_nock:
    v_add_u32 v8, s96, v1
    v_mfma_f32_16x16x32_bf16 v[96:99], a[128:131], v[56:59], v[136:139]
    v_exp_f32 v72, v72
    v_mfma_f32_16x16x32_bf16 v[96:99], a[132:135], v[88:91], v[96:99]
    v_exp_f32 v73, v73
    v_mfma_f32_16x16x32_bf16 v[96:99], a[136:139], v[120:123], v[96:99]
    v_exp_f32 v74, v74
    v_mfma_f32_16x16x32_bf16 v[96:99], a[140:143], v[152:155], v[96:99]
    ds_read_b128 a[160:163], v8 offset:0
    v_mfma_f32_16x16x32_bf16 v[100:103], a[144:147], v[56:59], v[136:139]
    v_exp_f32 v75, v75
    v_mfma_f32_16x16x32_bf16 v[100:103], a[148:151], v[88:91], v[100:103]
    s_waitcnt lgkmcnt(1)
    v_cvt_pk_bf16_f32 v164, v72, v73
    v_mfma_f32_16x16x32_bf16 v[100:103], a[152:155], v[120:123], v[100:103]
    v_exp_f32 v76, v76
    v_mfma_f32_16x16x32_bf16 v[100:103], a[156:159], v[152:155], v[100:103]
    ds_read_b128 a[164:167], v8 offset:1024
    v_mfma_f32_16x16x32_bf16 a[0:3], a[192:195], v[160:163], a[0:3]
    v_exp_f32 v77, v77
    v_mfma_f32_16x16x32_bf16 a[16:19], a[196:199], v[160:163], a[16:19]
    v_cvt_pk_bf16_f32 v165, v74, v75
    v_mfma_f32_16x16x32_bf16 a[32:35], a[200:203], v[160:163], a[32:35]
    v_exp_f32 v78, v78
    v_mfma_f32_16x16x32_bf16 a[48:51], a[204:207], v[160:163], a[48:51]
    ds_read_b128 a[168:171], v8 offset:2048
    v_mfma_f32_16x16x32_bf16 a[64:67], a[208:211], v[160:163], a[64:67]
    v_exp_f32 v79, v79
    v_mfma_f32_16x16x32_bf16 a[80:83], a[212:215], v[160:163], a[80:83]
    v_cvt_pk_bf16_f32 v166, v76, v77
    v_cvt_pk_bf16_f32 v167, v78, v79
    v_mfma_f32_16x16x32_bf16 a[96:99], a[216:219], v[160:163], a[96:99]
    v_mfma_f32_16x16x32_bf16 a[112:115], a[220:223], v[160:163], a[112:115]
    ds_read_b128 a[172:175], v8 offset:3072
    v_mfma_f32_16x16x32_bf16 v[192:195], v[208:211], v[160:163], v[192:195]
    v_mfma_f32_16x16x32_bf16 v[104:107], a[128:131], v[60:63], v[140:143]
    v_exp_f32 v96, v96
    v_mfma_f32_16x16x32_bf16 v[104:107], a[132:135], v[92:95], v[104:107]
    v_exp_f32 v97, v97
    v_mfma_f32_16x16x32_bf16 v[104:107], a[136:139], v[124:127], v[104:107]
    ds_read_b128 a[176:179], v8 offset:4096
    v_mfma_f32_16x16x32_bf16 v[104:107], a[140:143], v[156:159], v[104:107]
    ds_read_b128 a[180:183], v8 offset:5120
    v_mfma_f32_16x16x32_bf16 v[108:111], a[144:147], v[60:63], v[140:143]
    v_exp_f32 v98, v98
    v_mfma_f32_16x16x32_bf16 v[108:111], a[148:151], v[92:95], v[108:111]
    v_exp_f32 v99, v99
    v_mfma_f32_16x16x32_bf16 v[108:111], a[152:155], v[124:127], v[108:111]
    ds_read_b128 a[184:187], v8 offset:6144
    v_cvt_pk_bf16_f32 v168, v96, v97
    v_mfma_f32_16x16x32_bf16 v[108:111], a[156:159], v[156:159], v[108:111]
    ds_read_b128 a[188:191], v8 offset:7168
    v_mfma_f32_16x16x32_bf16 a[4:7], a[192:195], v[164:167], a[4:7]
    v_exp_f32 v100, v100
    v_mfma_f32_16x16x32_bf16 a[20:23], a[196:199], v[164:167], a[20:23]
    v_exp_f32 v101, v101
    v_mfma_f32_16x16x32_bf16 a[36:39], a[200:203], v[164:167], a[36:39]
    v_cvt_pk_bf16_f32 v169, v98, v99
    v_mfma_f32_16x16x32_bf16 a[52:55], a[204:207], v[164:167], a[52:55]
    s_waitcnt vmcnt(15)
    s_barrier
    v_mfma_f32_16x16x32_bf16 a[68:71], a[208:211], v[164:167], a[68:71]
    s_xor_b32 s92, s88, s85
    v_exp_f32 v102, v102
    v_mfma_f32_16x16x32_bf16 a[84:87], a[212:215], v[164:167], a[84:87]
    v_exp_f32 v103, v103
    v_mfma_f32_16x16x32_bf16 a[100:103], a[216:219], v[164:167], a[100:103]
    s_waitcnt lgkmcnt(0)
    v_cvt_pk_bf16_f32 v170, v100, v101
    v_cvt_pk_bf16_f32 v171, v102, v103
    v_mfma_f32_16x16x32_bf16 a[116:119], a[220:223], v[164:167], a[116:119]
    v_mfma_f32_16x16x32_bf16 v[196:199], v[208:211], v[164:167], v[196:199]
    s_mul_i32 s92, s92, s97
    v_mfma_f32_16x16x32_bf16 v[64:67], a[160:163], v[48:51], v[128:131]
    v_exp_f32 v104, v104
    v_mfma_f32_16x16x32_bf16 v[64:67], a[164:167], v[80:83], v[64:67]
    buffer_load_dwordx4 a[128:131], v10, s[28:31], s79 offen offset:0 sc1
    v_mfma_f32_16x16x32_bf16 v[64:67], a[168:171], v[112:115], v[64:67]
    v_exp_f32 v105, v105
    v_mfma_f32_16x16x32_bf16 v[64:67], a[172:175], v[144:147], v[64:67]
    ds_read_b128 a[224:227], v8 offset:8192
    s_add_u32 s92, s92, s93
    v_mfma_f32_16x16x32_bf16 v[68:71], a[176:179], v[48:51], v[128:131]
    v_exp_f32 v106, v106
    v_mfma_f32_16x16x32_bf16 v[68:71], a[180:183], v[80:83], v[68:71]
    v_exp_f32 v107, v107
    v_mfma_f32_16x16x32_bf16 v[68:71], a[184:187], v[112:115], v[68:71]
    v_cvt_pk_bf16_f32 v172, v104, v105
    v_mfma_f32_16x16x32_bf16 v[68:71], a[188:191], v[144:147], v[68:71]
    ds_read_b128 a[228:231], v8 offset:9216
    v_mfma_f32_16x16x32_bf16 a[8:11], a[192:195], v[168:171], a[8:11]
    buffer_load_dwordx4 a[132:135], v11, s[28:31], s79 offen offset:0 sc1
    v_mfma_f32_16x16x32_bf16 a[24:27], a[196:199], v[168:171], a[24:27]
    s_add_u32 m0, s94, 0
    v_exp_f32 v108, v108
    v_mfma_f32_16x16x32_bf16 a[40:43], a[200:203], v[168:171], a[40:43]
    v_exp_f32 v109, v109
    v_mfma_f32_16x16x32_bf16 a[56:59], a[204:207], v[168:171], a[56:59]
    ds_read_b128 a[232:235], v8 offset:10240
    v_cvt_pk_bf16_f32 v173, v106, v107
    v_mfma_f32_16x16x32_bf16 a[72:75], a[208:211], v[168:171], a[72:75]
    buffer_load_dwordx4 v16, s[20:23], s92 offen offset:0 sc1 lds
    v_mfma_f32_16x16x32_bf16 a[88:91], a[212:215], v[168:171], a[88:91]
    buffer_load_dwordx4 a[136:139], v12, s[28:31], s79 offen offset:0 sc1
    v_mfma_f32_16x16x32_bf16 a[104:107], a[216:219], v[168:171], a[104:107]
    v_exp_f32 v110, v110
    v_mfma_f32_16x16x32_bf16 a[120:123], a[220:223], v[168:171], a[120:123]
    ds_read_b128 a[236:239], v8 offset:11264
    v_mfma_f32_16x16x32_bf16 v[200:203], v[208:211], v[168:171], v[200:203]
    v_exp_f32 v111, v111
    v_cvt_pk_bf16_f32 v174, v108, v109
    v_mfma_f32_16x16x32_bf16 v[72:75], a[160:163], v[52:55], v[132:135]
    buffer_load_dwordx4 v17, s[20:23], s92 offen offset:1024 sc1 lds
    v_exp_f32 v64, v64
    v_exp_f32 v65, v65
    v_mfma_f32_16x16x32_bf16 v[72:75], a[164:167], v[84:87], v[72:75]
    buffer_load_dwordx4 a[144:147], v10, s[28:31], s79 offen offset:1024 sc1
    v_mfma_f32_16x16x32_bf16 v[72:75], a[168:171], v[116:119], v[72:75]
    buffer_load_dwordx4 a[140:143], v13, s[28:31], s79 offen offset:0 sc1
    v_mfma_f32_16x16x32_bf16 v[72:75], a[172:175], v[148:151], v[72:75]
    ds_read_b128 a[240:243], v8 offset:12288
    v_cvt_pk_bf16_f32 v175, v110, v111
    v_mfma_f32_16x16x32_bf16 v[76:79], a[176:179], v[52:55], v[132:135]
    buffer_load_dwordx4 v18, s[20:23], s92 offen offset:2048 sc1 lds
    v_mfma_f32_16x16x32_bf16 v[76:79], a[180:183], v[84:87], v[76:79]
    v_exp_f32 v66, v66
    v_mfma_f32_16x16x32_bf16 v[76:79], a[184:187], v[116:119], v[76:79]
    v_exp_f32 v67, v67
    v_mfma_f32_16x16x32_bf16 v[76:79], a[188:191], v[148:151], v[76:79]
    ds_read_b128 a[244:247], v8 offset:13312
    v_cvt_pk_bf16_f32 v160, v64, v65
    v_mfma_f32_16x16x32_bf16 a[12:15], a[192:195], v[172:175], a[12:15]
    buffer_load_dwordx4 a[148:151], v11, s[28:31], s79 offen offset:1024 sc1
    v_mfma_f32_16x16x32_bf16 a[28:31], a[196:199], v[172:175], a[28:31]
    buffer_load_dwordx4 v19, s[20:23], s92 offen offset:3072 sc1 lds
    v_mfma_f32_16x16x32_bf16 a[44:47], a[200:203], v[172:175], a[44:47]
    v_exp_f32 v68, v68
    v_mfma_f32_16x16x32_bf16 a[60:63], a[204:207], v[172:175], a[60:63]
    ds_read_b128 a[248:251], v8 offset:14336
    v_mfma_f32_16x16x32_bf16 a[76:79], a[208:211], v[172:175], a[76:79]
    v_exp_f32 v69, v69
    v_cvt_pk_bf16_f32 v161, v66, v67
    v_mfma_f32_16x16x32_bf16 a[92:95], a[212:215], v[172:175], a[92:95]
    buffer_load_dwordx4 a[152:155], v12, s[28:31], s79 offen offset:1024 sc1
    v_mfma_f32_16x16x32_bf16 a[108:111], a[216:219], v[172:175], a[108:111]
    s_add_u32 m0, s94, 4096
    v_exp_f32 v70, v70
    v_mfma_f32_16x16x32_bf16 a[124:127], a[220:223], v[172:175], a[124:127]
    ds_read_b128 a[252:255], v8 offset:15360
    v_mfma_f32_16x16x32_bf16 v[204:207], v[208:211], v[172:175], v[204:207]
    v_exp_f32 v71, v71
    v_mfma_f32_16x16x32_bf16 v[96:99], a[160:163], v[56:59], v[136:139]
    v_cvt_pk_bf16_f32 v162, v68, v69
    v_cvt_pk_bf16_f32 v163, v70, v71
    v_exp_f32 v72, v72
    v_exp_f32 v73, v73
    v_mfma_f32_16x16x32_bf16 v[96:99], a[164:167], v[88:91], v[96:99]
    buffer_load_dwordx4 a[192:195], v10, s[28:31], s79 offen offset:2048 sc1
    v_mfma_f32_16x16x32_bf16 v[96:99], a[168:171], v[120:123], v[96:99]
    buffer_load_dwordx4 a[156:159], v13, s[28:31], s79 offen offset:1024 sc1
    v_mfma_f32_16x16x32_bf16 v[96:99], a[172:175], v[152:155], v[96:99]
    buffer_load_dwordx4 v20, s[20:23], s92 offen offset:0 sc1 lds
    v_mfma_f32_16x16x32_bf16 v[100:103], a[176:179], v[56:59], v[136:139]
    v_exp_f32 v74, v74
    v_mfma_f32_16x16x32_bf16 v[100:103], a[180:183], v[88:91], v[100:103]
    s_waitcnt lgkmcnt(0)
    v_exp_f32 v75, v75
    v_mfma_f32_16x16x32_bf16 v[100:103], a[184:187], v[120:123], v[100:103]
    buffer_load_dwordx4 v21, s[20:23], s92 offen offset:1024 sc1 lds
    v_mfma_f32_16x16x32_bf16 v[100:103], a[188:191], v[152:155], v[100:103]
    buffer_load_dwordx4 a[196:199], v11, s[28:31], s79 offen offset:2048 sc1
    v_mfma_f32_16x16x32_bf16 a[0:3], a[224:227], v[160:163], a[0:3]
    v_cvt_pk_bf16_f32 v164, v72, v73
    v_mfma_f32_16x16x32_bf16 a[16:19], a[228:231], v[160:163], a[16:19]
    buffer_load_dwordx4 v22, s[20:23], s92 offen offset:2048 sc1 lds
    v_mfma_f32_16x16x32_bf16 a[32:35], a[232:235], v[160:163], a[32:35]
    v_exp_f32 v76, v76
    v_mfma_f32_16x16x32_bf16 a[48:51], a[236:239], v[160:163], a[48:51]
    v_exp_f32 v77, v77
    v_mfma_f32_16x16x32_bf16 a[64:67], a[240:243], v[160:163], a[64:67]
    v_cvt_pk_bf16_f32 v165, v74, v75
    v_mfma_f32_16x16x32_bf16 a[80:83], a[244:247], v[160:163], a[80:83]
    buffer_load_dwordx4 a[200:203], v12, s[28:31], s79 offen offset:2048 sc1
    v_mfma_f32_16x16x32_bf16 a[96:99], a[248:251], v[160:163], a[96:99]
    buffer_load_dwordx4 v23, s[20:23], s92 offen offset:3072 sc1 lds
    v_mfma_f32_16x16x32_bf16 a[112:115], a[252:255], v[160:163], a[112:115]
    v_exp_f32 v78, v78
    v_mfma_f32_16x16x32_bf16 v[192:195], v[208:211], v[160:163], v[192:195]
    v_exp_f32 v79, v79
    v_mfma_f32_16x16x32_bf16 v[104:107], a[160:163], v[60:63], v[140:143]
    v_cvt_pk_bf16_f32 v166, v76, v77
    v_cvt_pk_bf16_f32 v167, v78, v79
    v_exp_f32 v96, v96
    v_exp_f32 v97, v97
    v_mfma_f32_16x16x32_bf16 v[104:107], a[164:167], v[92:95], v[104:107]
    buffer_load_dwordx4 a[208:211], v10, s[28:31], s79 offen offset:3072 sc1
    v_mfma_f32_16x16x32_bf16 v[104:107], a[168:171], v[124:127], v[104:107]
    buffer_load_dwordx4 a[204:207], v13, s[28:31], s79 offen offset:2048 sc1
    v_mfma_f32_16x16x32_bf16 v[104:107], a[172:175], v[156:159], v[104:107]
    s_add_u32 m0, s94, 8192
    v_exp_f32 v98, v98
    v_mfma_f32_16x16x32_bf16 v[108:111], a[176:179], v[60:63], v[140:143]
    v_exp_f32 v99, v99
    v_mfma_f32_16x16x32_bf16 v[108:111], a[180:183], v[92:95], v[108:111]
    v_cvt_pk_bf16_f32 v168, v96, v97
    v_mfma_f32_16x16x32_bf16 v[108:111], a[184:187], v[124:127], v[108:111]
    buffer_load_dwordx4 v24, s[20:23], s92 offen offset:0 sc1 lds
    v_mfma_f32_16x16x32_bf16 v[108:111], a[188:191], v[156:159], v[108:111]
    buffer_load_dwordx4 a[212:215], v11, s[28:31], s79 offen offset:3072 sc1
    v_mfma_f32_16x16x32_bf16 a[4:7], a[224:227], v[164:167], a[4:7]
    v_exp_f32 v100, v100
    v_mfma_f32_16x16x32_bf16 a[20:23], a[228:231], v[164:167], a[20:23]
    v_exp_f32 v101, v101
    v_mfma_f32_16x16x32_bf16 a[36:39], a[232:235], v[164:167], a[36:39]
    s_add_u32 s88, s88, 1
    v_cvt_pk_bf16_f32 v169, v98, v99
    v_mfma_f32_16x16x32_bf16 a[52:55], a[236:239], v[164:167], a[52:55]
    v_exp_f32 v102, v102
    v_mfma_f32_16x16x32_bf16 a[68:71], a[240:243], v[164:167], a[68:71]
    v_exp_f32 v103, v103
    v_mfma_f32_16x16x32_bf16 a[84:87], a[244:247], v[164:167], a[84:87]
    buffer_load_dwordx4 a[216:219], v12, s[28:31], s79 offen offset:3072 sc1
    v_mfma_f32_16x16x32_bf16 a[100:103], a[248:251], v[164:167], a[100:103]
    v_cvt_pk_bf16_f32 v170, v100, v101
    v_cvt_pk_bf16_f32 v171, v102, v103
    v_mfma_f32_16x16x32_bf16 a[116:119], a[252:255], v[164:167], a[116:119]
    s_add_u32 s94, s94, 36864
    v_mfma_f32_16x16x32_bf16 v[196:199], v[208:211], v[164:167], v[196:199]
    v_mfma_f32_16x16x32_bf16 a[8:11], a[224:227], v[168:171], a[8:11]
    v_lshlrev_b32 v188, 7, v1
    v_exp_f32 v104, v104
    v_mfma_f32_16x16x32_bf16 a[24:27], a[228:231], v[168:171], a[24:27]
    v_exp_f32 v105, v105
    v_exp_f32 v106, v106
    v_exp_f32 v107, v107
    v_mfma_f32_16x16x32_bf16 a[40:43], a[232:235], v[168:171], a[40:43]
    buffer_load_dwordx4 a[220:223], v13, s[28:31], s79 offen offset:3072 sc1
    v_mfma_f32_16x16x32_bf16 a[56:59], a[236:239], v[168:171], a[56:59]
    s_cmp_ge_u32 s94, 147456
    s_cselect_b32 s94, s81, s94
    v_cvt_pk_bf16_f32 v172, v104, v105
    v_mfma_f32_16x16x32_bf16 a[72:75], a[240:243], v[168:171], a[72:75]
    v_exp_f32 v108, v108
    v_mfma_f32_16x16x32_bf16 a[88:91], a[244:247], v[168:171], a[88:91]
    v_exp_f32 v109, v109
    v_cvt_pk_bf16_f32 v173, v106, v107
    v_mfma_f32_16x16x32_bf16 a[104:107], a[248:251], v[168:171], a[104:107]
    v_exp_f32 v110, v110
    v_mfma_f32_16x16x32_bf16 a[120:123], a[252:255], v[168:171], a[120:123]
    s_add_u32 s96, s96, 36864
    v_exp_f32 v111, v111
    v_mfma_f32_16x16x32_bf16 v[200:203], v[208:211], v[168:171], v[200:203]
    v_cvt_pk_bf16_f32 v174, v108, v109
    v_cvt_pk_bf16_f32 v175, v110, v111
    s_nop 1
    v_mfma_f32_16x16x32_bf16 a[12:15], a[224:227], v[172:175], a[12:15]
    s_waitcnt vmcnt(32)
    s_mov_b64 exec, 0xff
    buffer_store_dword v7, v188, s[16:19], s89 offen sc1
    s_mov_b64 exec, -1
    v_mfma_f32_16x16x32_bf16 a[28:31], a[228:231], v[172:175], a[28:31]
    v_mfma_f32_16x16x32_bf16 a[44:47], a[232:235], v[172:175], a[44:47]
    s_cmp_eq_u32 s96, 147456
    s_cselect_b32 s96, 0, s96
    v_mfma_f32_16x16x32_bf16 a[60:63], a[236:239], v[172:175], a[60:63]
    v_mfma_f32_16x16x32_bf16 a[76:79], a[240:243], v[172:175], a[76:79]
    v_mfma_f32_16x16x32_bf16 a[92:95], a[244:247], v[172:175], a[92:95]
    v_mfma_f32_16x16x32_bf16 a[108:111], a[248:251], v[172:175], a[108:111]
    v_mfma_f32_16x16x32_bf16 a[124:127], a[252:255], v[172:175], a[124:127]
    v_mfma_f32_16x16x32_bf16 v[204:207], v[208:211], v[172:175], v[204:207]
    v_mov_b32 v32, v192
    v_mov_b32 v33, v196
    v_mov_b32 v34, v200
    s_nop 4
    v_mov_b32 v35, v204
    v_add_f32 v217, v32, v33
    v_add_f32 v218, v34, v35
    v_add_f32 v216, v217, v218
    v_cmp_nge_f32 vcc, 0x4e800000, v216
    s_nop 0
    s_cbranch_vccnz KF_slow
KF_epi:
    v_add_u32 v8, s96, v5
    v_rcp_f32 v32, v32
    v_rcp_f32 v33, v33
    v_rcp_f32 v34, v34
    v_rcp_f32 v35, v35
    s_mov_b32 s4, 0
    s_mov_b32 s101, s5
    s_mov_b32 s82, 0x70000000
    s_cmp_eq_u32 s5, 0
    s_cbranch_scc1 KF_spre
    ds_read_b64_tr_b16 v[192:193], v8 offset:0
    ds_read_b64_tr_b16 v[194:195], v8 offset:4608
    ds_read_b64_tr_b16 v[196:197], v8 offset:9216
    ds_read_b64_tr_b16 v[198:199], v8 offset:13824
    ds_read_b64_tr_b16 v[200:201], v8 offset:32
    ds_read_b64_tr_b16 v[202:203], v8 offset:4640
    ds_read_b64_tr_b16 v[204:205], v8 offset:9248
    ds_read_b64_tr_b16 v[206:207], v8 offset:13856
    s_waitcnt vmcnt(25) lgkmcnt(6)
    v_mfma_f32_16x16x32_bf16 v[48:51], v[192:195], a[128:131], 0
    ds_read_b64_tr_b16 v[208:209], v8 offset:64
    v_accvgpr_read_b32 v248, a0
    v_accvgpr_read_b32 v249, a1
    s_waitcnt vmcnt(20) lgkmcnt(5)
    v_mfma_f32_16x16x32_bf16 v[48:51], v[196:199], a[144:147], v[48:51]
    ds_read_b64_tr_b16 v[210:211], v8 offset:4672
    v_accvgpr_read_b32 v250, a2
    v_accvgpr_read_b32 v251, a3
    v_mfma_f32_16x16x32_bf16 v[52:55], v[192:195], a[132:135], 0
    s_xor_b32 s79, s87, s85
    s_lshl_b32 s79, s79, 12
    v_accvgpr_read_b32 v252, a16
    v_accvgpr_read_b32 v253, a17
    v_accvgpr_read_b32 v254, a18
    s_waitcnt vmcnt(17)
    v_mfma_f32_16x16x32_bf16 v[52:55], v[196:199], a[148:151], v[52:55]
    s_add_u32 s79, s79, s80
    s_add_u32 s87, s87, 1
    v_accvgpr_read_b32 v255, a19
    v_mul_f32 v248, v248, v32
    v_mfma_f32_16x16x32_bf16 v[56:59], v[192:195], a[136:139], 0
    ds_read_b64_tr_b16 v[212:213], v8 offset:9280
    v_mul_f32 v249, v249, v32
    v_mul_f32 v250, v250, v32
    v_mul_f32 v251, v251, v32
    s_waitcnt vmcnt(15)
    v_mfma_f32_16x16x32_bf16 v[56:59], v[196:199], a[152:155], v[56:59]
    ds_read_b64_tr_b16 v[214:215], v8 offset:13888
    s_waitcnt lgkmcnt(4)
    v_mul_f32 v252, v252, v32
    v_mul_f32 v253, v253, v32
    v_mul_f32 v254, v254, v32
    v_mfma_f32_16x16x32_bf16 v[60:63], v[192:195], a[140:143], 0
    s_barrier
    v_mul_f32 v255, v255, v32
    v_cvt_pk_bf16_f32 v216, v248, v249
    s_waitcnt vmcnt(13)
    v_mfma_f32_16x16x32_bf16 v[60:63], v[196:199], a[156:159], v[60:63]
    s_add_u32 s96, s96, 36864
    s_cmp_eq_u32 s96, 147456
    s_cselect_b32 s96, 0, s96
    v_cvt_pk_bf16_f32 v217, v250, v251
    v_cvt_pk_bf16_f32 v218, v252, v253
    v_cvt_pk_bf16_f32 v219, v254, v255
    v_mfma_f32_16x16x32_bf16 v[64:67], v[200:203], a[128:131], 0
    ds_read_b64_tr_b16 v[192:193], v8 offset:96
    buffer_load_dwordx4 a[160:163], v10, s[28:31], s79 offen offset:0 sc1
    buffer_store_dwordx4 v[216:219], v10, s[16:19], s83 offen offset:0 sc1
    v_mfma_f32_16x16x32_bf16 v[64:67], v[204:207], a[144:147], v[64:67]
    ds_read_b64_tr_b16 v[194:195], v8 offset:4704
    v_accvgpr_read_b32 v248, a4
    v_accvgpr_read_b32 v249, a5
    v_accvgpr_read_b32 v250, a6
    v_mfma_f32_16x16x32_bf16 v[68:71], v[200:203], a[132:135], 0
    buffer_load_dwordx4 a[164:167], v11, s[28:31], s79 offen offset:0 sc1
    v_accvgpr_read_b32 v251, a7
    v_accvgpr_read_b32 v252, a20
    v_mfma_f32_16x16x32_bf16 v[68:71], v[204:207], a[148:151], v[68:71]
    v_accvgpr_read_b32 v253, a21
    v_accvgpr_read_b32 v254, a22
    v_accvgpr_read_b32 v255, a23
    v_mfma_f32_16x16x32_bf16 v[72:75], v[200:203], a[136:139], 0
    ds_read_b64_tr_b16 v[196:197], v8 offset:9312
    s_xor_b32 s92, s88, s85
    v_mul_f32 v248, v248, v33
    v_mul_f32 v249, v249, v33
    v_mul_f32 v250, v250, v33
    v_mfma_f32_16x16x32_bf16 v[72:75], v[204:207], a[152:155], v[72:75]
    ds_read_b64_tr_b16 v[198:199], v8 offset:13920
    s_waitcnt lgkmcnt(4)
    v_mul_f32 v251, v251, v33
    v_mul_f32 v252, v252, v33
    v_mfma_f32_16x16x32_bf16 v[76:79], v[200:203], a[140:143], 0
    buffer_load_dwordx4 a[168:171], v12, s[28:31], s79 offen offset:0 sc1
    v_mul_f32 v253, v253, v33
    v_mul_f32 v254, v254, v33
    v_mfma_f32_16x16x32_bf16 v[76:79], v[204:207], a[156:159], v[76:79]
    v_mul_f32 v255, v255, v33
    v_cvt_pk_bf16_f32 v220, v248, v249
    v_mfma_f32_16x16x32_bf16 v[80:83], v[208:211], a[128:131], 0
    ds_read_b64_tr_b16 v[200:201], v8 offset:128
    v_cvt_pk_bf16_f32 v221, v250, v251
    v_cvt_pk_bf16_f32 v222, v252, v253
    v_mfma_f32_16x16x32_bf16 v[80:83], v[212:215], a[144:147], v[80:83]
    ds_read_b64_tr_b16 v[202:203], v8 offset:4736
    v_cvt_pk_bf16_f32 v223, v254, v255
    buffer_store_dwordx4 v[220:223], v11, s[16:19], s83 offen offset:0 sc1
    v_accvgpr_read_b32 v248, a8
    v_accvgpr_read_b32 v249, a9
    v_mfma_f32_16x16x32_bf16 v[84:87], v[208:211], a[132:135], 0
    buffer_load_dwordx4 a[172:175], v13, s[28:31], s79 offen offset:0 sc1
    v_accvgpr_read_b32 v250, a10
    v_mfma_f32_16x16x32_bf16 v[84:87], v[212:215], a[148:151], v[84:87]
    s_mul_i32 s92, s92, s97
    v_accvgpr_read_b32 v251, a11
    v_accvgpr_read_b32 v252, a24
    v_accvgpr_read_b32 v253, a25
    v_mfma_f32_16x16x32_bf16 v[88:91], v[208:211], a[136:139], 0
    ds_read_b64_tr_b16 v[204:205], v8 offset:9344
    v_accvgpr_read_b32 v254, a26
    v_accvgpr_read_b32 v255, a27
    v_mul_f32 v248, v248, v34
    v_mfma_f32_16x16x32_bf16 v[88:91], v[212:215], a[152:155], v[88:91]
    ds_read_b64_tr_b16 v[206:207], v8 offset:13952
    s_waitcnt lgkmcnt(4)
    v_mul_f32 v249, v249, v34
    v_mul_f32 v250, v250, v34
    v_mfma_f32_16x16x32_bf16 v[92:95], v[208:211], a[140:143], 0
    buffer_load_dwordx4 a[176:179], v10, s[28:31], s79 offen offset:1024 sc1
    v_mul_f32 v251, v251, v34
    v_mul_f32 v252, v252, v34
    v_mul_f32 v253, v253, v34
    v_mfma_f32_16x16x32_bf16 v[92:95], v[212:215], a[156:159], v[92:95]
    buffer_load_dwordx4 a[180:183], v11, s[28:31], s79 offen offset:1024 sc1
    v_mul_f32 v254, v254, v34
    v_mfma_f32_16x16x32_bf16 v[96:99], v[192:195], a[128:131], 0
    ds_read_b64_tr_b16 v[208:209], v8 offset:160
    v_mul_f32 v255, v255, v34
    v_cvt_pk_bf16_f32 v224, v248, v249
    v_cvt_pk_bf16_f32 v225, v250, v251
    v_mfma_f32_16x16x32_bf16 v[96:99], v[196:199], a[144:147], v[96:99]
    ds_read_b64_tr_b16 v[210:211], v8 offset:4768
    v_cvt_pk_bf16_f32 v226, v252, v253
    v_cvt_pk_bf16_f32 v227, v254, v255
    v_mfma_f32_16x16x32_bf16 v[100:103], v[192:195], a[132:135], 0
    buffer_load_dwordx4 a[184:187], v12, s[28:31], s79 offen offset:1024 sc1
    buffer_store_dwordx4 v[224:227], v12, s[16:19], s83 offen offset:0 sc1
    v_accvgpr_read_b32 v248, a12
    v_mfma_f32_16x16x32_bf16 v[100:103], v[196:199], a[148:151], v[100:103]
    s_add_u32 s92, s92, s93
    v_accvgpr_read_b32 v249, a13
    v_accvgpr_read_b32 v250, a14
    v_accvgpr_read_b32 v251, a15
    v_mfma_f32_16x16x32_bf16 v[104:107], v[192:195], a[136:139], 0
    ds_read_b64_tr_b16 v[212:213], v8 offset:9376
    v_accvgpr_read_b32 v252, a28
    v_accvgpr_read_b32 v253, a29
    v_accvgpr_read_b32 v254, a30
    v_mfma_f32_16x16x32_bf16 v[104:107], v[196:199], a[152:155], v[104:107]
    ds_read_b64_tr_b16 v[214:215], v8 offset:13984
    s_waitcnt lgkmcnt(4)
    v_accvgpr_read_b32 v255, a31
    v_mul_f32 v248, v248, v35
    v_mfma_f32_16x16x32_bf16 v[108:111], v[192:195], a[140:143], 0
    buffer_load_dwordx4 a[188:191], v13, s[28:31], s79 offen offset:1024 sc1
    v_mul_f32 v249, v249, v35
    v_mul_f32 v250, v250, v35
    v_mfma_f32_16x16x32_bf16 v[108:111], v[196:199], a[156:159], v[108:111]
    v_mul_f32 v251, v251, v35
    v_mul_f32 v252, v252, v35
    v_mfma_f32_16x16x32_bf16 v[112:115], v[200:203], a[128:131], 0
    ds_read_b64_tr_b16 v[192:193], v8 offset:192
    v_mul_f32 v253, v253, v35
    v_mul_f32 v254, v254, v35
    v_mul_f32 v255, v255, v35
    v_cvt_pk_bf16_f32 v228, v248, v249
    v_mfma_f32_16x16x32_bf16 v[112:115], v[204:207], a[144:147], v[112:115]
    ds_read_b64_tr_b16 v[194:195], v8 offset:4800
    s_add_u32 m0, s94, 0
    v_cvt_pk_bf16_f32 v229, v250, v251
    v_cvt_pk_bf16_f32 v230, v252, v253
    v_mfma_f32_16x16x32_bf16 v[116:119], v[200:203], a[132:135], 0
    buffer_load_dwordx4 a[224:227], v10, s[28:31], s79 offen offset:2048 sc1
    v_cvt_pk_bf16_f32 v231, v254, v255
    buffer_store_dwordx4 v[228:231], v13, s[16:19], s83 offen offset:0 sc1
    v_mfma_f32_16x16x32_bf16 v[116:119], v[204:207], a[148:151], v[116:119]
    v_accvgpr_read_b32 v248, a32
    v_accvgpr_read_b32 v249, a33
    v_mfma_f32_16x16x32_bf16 v[120:123], v[200:203], a[136:139], 0
    ds_read_b64_tr_b16 v[196:197], v8 offset:9408
    v_accvgpr_read_b32 v250, a34
    v_accvgpr_read_b32 v251, a35
    v_accvgpr_read_b32 v252, a48
    v_mfma_f32_16x16x32_bf16 v[120:123], v[204:207], a[152:155], v[120:123]
    ds_read_b64_tr_b16 v[198:199], v8 offset:14016
    s_waitcnt lgkmcnt(4)
    v_accvgpr_read_b32 v253, a49
    v_accvgpr_read_b32 v254, a50
    v_accvgpr_read_b32 v255, a51
    v_mfma_f32_16x16x32_bf16 v[124:127], v[200:203], a[140:143], 0
    buffer_load_dwordx4 a[228:231], v11, s[28:31], s79 offen offset:2048 sc1
    v_mul_f32 v248, v248, v32
    v_mfma_f32_16x16x32_bf16 v[124:127], v[204:207], a[156:159], v[124:127]
    v_mul_f32 v249, v249, v32
    v_mul_f32 v250, v250, v32
    v_mul_f32 v251, v251, v32
    v_mfma_f32_16x16x32_bf16 v[128:131], v[208:211], a[128:131], 0
    ds_read_b64_tr_b16 v[200:201], v8 offset:224
    v_mul_f32 v252, v252, v32
    v_mul_f32 v253, v253, v32
    v_mfma_f32_16x16x32_bf16 v[128:131], v[212:215], a[144:147], v[128:131]
    ds_read_b64_tr_b16 v[202:203], v8 offset:4832
    v_mul_f32 v254, v254, v32
    v_mul_f32 v255, v255, v32
    v_cvt_pk_bf16_f32 v232, v248, v249
    v_mfma_f32_16x16x32_bf16 v[132:135], v[208:211], a[132:135], 0
    buffer_load_dwordx4 a[232:235], v12, s[28:31], s79 offen offset:2048 sc1
    v_cvt_pk_bf16_f32 v233, v250, v251
    v_cvt_pk_bf16_f32 v234, v252, v253
    v_cvt_pk_bf16_f32 v235, v254, v255
    v_mfma_f32_16x16x32_bf16 v[132:135], v[212:215], a[148:151], v[132:135]
    buffer_load_dwordx4 a[236:239], v13, s[28:31], s79 offen offset:2048 sc1
    buffer_store_dwordx4 v[232:235], v10, s[16:19], s83 offen offset:1024 sc1
    v_mfma_f32_16x16x32_bf16 v[136:139], v[208:211], a[136:139], 0
    ds_read_b64_tr_b16 v[204:205], v8 offset:9440
    v_accvgpr_read_b32 v248, a36
    v_accvgpr_read_b32 v249, a37
    v_accvgpr_read_b32 v250, a38
    v_mfma_f32_16x16x32_bf16 v[136:139], v[212:215], a[152:155], v[136:139]
    ds_read_b64_tr_b16 v[206:207], v8 offset:14048
    s_waitcnt lgkmcnt(4)
    v_accvgpr_read_b32 v251, a39
    v_accvgpr_read_b32 v252, a52
    v_accvgpr_read_b32 v253, a53
    v_mfma_f32_16x16x32_bf16 v[140:143], v[208:211], a[140:143], 0
    buffer_load_dwordx4 a[240:243], v10, s[28:31], s79 offen offset:3072 sc1
    v_accvgpr_read_b32 v254, a54
    v_accvgpr_read_b32 v255, a55
    v_mfma_f32_16x16x32_bf16 v[140:143], v[212:215], a[156:159], v[140:143]
    buffer_load_dwordx4 v16, s[20:23], s92 offen offset:0 sc1 lds
    v_mul_f32 v248, v248, v33
    v_mul_f32 v249, v249, v33
    v_mfma_f32_16x16x32_bf16 v[144:147], v[192:195], a[128:131], 0
    ds_read_b64_tr_b16 v[208:209], v8 offset:256
    v_mul_f32 v250, v250, v33
    v_mul_f32 v251, v251, v33
    v_mfma_f32_16x16x32_bf16 v[144:147], v[196:199], a[144:147], v[144:147]
    ds_read_b64_tr_b16 v[210:211], v8 offset:4864
    v_mul_f32 v252, v252, v33
    v_mul_f32 v253, v253, v33
    v_mul_f32 v254, v254, v33
    v_mfma_f32_16x16x32_bf16 v[148:151], v[192:195], a[132:135], 0
    buffer_load_dwordx4 a[244:247], v11, s[28:31], s79 offen offset:3072 sc1
    v_mul_f32 v255, v255, v33
    v_cvt_pk_bf16_f32 v236, v248, v249
    v_cvt_pk_bf16_f32 v237, v250, v251
    v_mfma_f32_16x16x32_bf16 v[148:151], v[196:199], a[148:151], v[148:151]
    buffer_load_dwordx4 v17, s[20:23], s92 offen offset:1024 sc1 lds
    v_cvt_pk_bf16_f32 v238, v252, v253
    v_mfma_f32_16x16x32_bf16 v[152:155], v[192:195], a[136:139], 0
    ds_read_b64_tr_b16 v[212:213], v8 offset:9472
    v_cvt_pk_bf16_f32 v239, v254, v255
    buffer_store_dwordx4 v[236:239], v11, s[16:19], s83 offen offset:1024 sc1
    v_accvgpr_read_b32 v248, a40
    v_accvgpr_read_b32 v249, a41
    v_mfma_f32_16x16x32_bf16 v[152:155], v[196:199], a[152:155], v[152:155]
    ds_read_b64_tr_b16 v[214:215], v8 offset:14080
    s_waitcnt lgkmcnt(4)
    v_accvgpr_read_b32 v250, a42
    v_accvgpr_read_b32 v251, a43
    v_mfma_f32_16x16x32_bf16 v[156:159], v[192:195], a[140:143], 0
    buffer_load_dwordx4 a[248:251], v12, s[28:31], s79 offen offset:3072 sc1
    v_accvgpr_read_b32 v252, a56
    v_accvgpr_read_b32 v253, a57
    v_mfma_f32_16x16x32_bf16 v[156:159], v[196:199], a[156:159], v[156:159]
    buffer_load_dwordx4 v18, s[20:23], s92 offen offset:2048 sc1 lds
    v_accvgpr_read_b32 v254, a58
    v_accvgpr_read_b32 v255, a59
    v_mfma_f32_16x16x32_bf16 v[160:163], v[200:203], a[128:131], 0
    ds_read_b64_tr_b16 v[192:193], v8 offset:18432
    v_mul_f32 v248, v248, v34
    v_mul_f32 v249, v249, v34
    v_mfma_f32_16x16x32_bf16 v[160:163], v[204:207], a[144:147], v[160:163]
    ds_read_b64_tr_b16 v[194:195], v8 offset:23040
    v_mul_f32 v250, v250, v34
    v_mul_f32 v251, v251, v34
    v_mul_f32 v252, v252, v34
    v_mul_f32 v253, v253, v34
    v_mfma_f32_16x16x32_bf16 v[164:167], v[200:203], a[132:135], 0
    buffer_load_dwordx4 a[252:255], v13, s[28:31], s79 offen offset:3072 sc1
    v_mul_f32 v254, v254, v34
    v_mfma_f32_16x16x32_bf16 v[164:167], v[204:207], a[148:151], v[164:167]
    v_mul_f32 v255, v255, v34
    v_cvt_pk_bf16_f32 v240, v248, v249
    v_cvt_pk_bf16_f32 v241, v250, v251
    v_mfma_f32_16x16x32_bf16 v[168:171], v[200:203], a[136:139], 0
    ds_read_b64_tr_b16 v[196:197], v8 offset:27648
    v_cvt_pk_bf16_f32 v242, v252, v253
    v_cvt_pk_bf16_f32 v243, v254, v255
    v_mfma_f32_16x16x32_bf16 v[168:171], v[204:207], a[152:155], v[168:171]
    ds_read_b64_tr_b16 v[198:199], v8 offset:32256
    s_waitcnt lgkmcnt(4)
    buffer_store_dwordx4 v[240:243], v12, s[16:19], s83 offen offset:1024 sc1
    v_accvgpr_read_b32 v248, a44
    v_mfma_f32_16x16x32_bf16 v[172:175], v[200:203], a[140:143], 0
    s_xor_b32 s79, s87, s85
    s_lshl_b32 s79, s79, 12
    v_accvgpr_read_b32 v249, a45
    v_accvgpr_read_b32 v250, a46
    v_accvgpr_read_b32 v251, a47
    v_mfma_f32_16x16x32_bf16 v[172:175], v[204:207], a[156:159], v[172:175]
    s_add_u32 s79, s79, s80
    s_add_u32 s87, s87, 1
    v_accvgpr_read_b32 v252, a60
    v_accvgpr_read_b32 v253, a61
    v_mfma_f32_16x16x32_bf16 v[176:179], v[208:211], a[128:131], 0
    ds_read_b64_tr_b16 v[200:201], v8 offset:18464
    v_accvgpr_read_b32 v254, a62
    v_accvgpr_read_b32 v255, a63
    v_mul_f32 v248, v248, v35
    v_mfma_f32_16x16x32_bf16 v[176:179], v[212:215], a[144:147], v[176:179]
    ds_read_b64_tr_b16 v[202:203], v8 offset:23072
    v_mul_f32 v249, v249, v35
    v_mul_f32 v250, v250, v35
    v_mfma_f32_16x16x32_bf16 v[180:183], v[208:211], a[132:135], 0
    s_add_u32 s86, s79, 4096
    v_mul_f32 v251, v251, v35
    v_mul_f32 v252, v252, v35
    v_mul_f32 v253, v253, v35
    v_mfma_f32_16x16x32_bf16 v[180:183], v[212:215], a[148:151], v[180:183]
    buffer_load_dwordx4 v19, s[20:23], s92 offen offset:3072 sc1 lds
    v_mul_f32 v254, v254, v35
    v_mul_f32 v255, v255, v35
    v_cvt_pk_bf16_f32 v244, v248, v249
    v_mfma_f32_16x16x32_bf16 v[184:187], v[208:211], a[136:139], 0
    ds_read_b64_tr_b16 v[204:205], v8 offset:27680
    s_waitcnt vmcnt(28)
    v_cvt_pk_bf16_f32 v245, v250, v251
    v_cvt_pk_bf16_f32 v246, v252, v253
    v_mfma_f32_16x16x32_bf16 v[184:187], v[212:215], a[152:155], v[184:187]
    ds_read_b64_tr_b16 v[206:207], v8 offset:32288
    s_waitcnt lgkmcnt(4)
    v_cvt_pk_bf16_f32 v247, v254, v255
    buffer_store_dwordx4 v[244:247], v13, s[16:19], s83 offen offset:1024 sc1
    v_mfma_f32_16x16x32_bf16 v[188:191], v[208:211], a[140:143], 0
    s_add_u32 m0, s94, 4096
    v_accvgpr_read_b32 v248, a64
    v_accvgpr_read_b32 v249, a65
    v_mfma_f32_16x16x32_bf16 v[188:191], v[212:215], a[156:159], v[188:191]
    v_accvgpr_read_b32 v250, a66
    v_accvgpr_read_b32 v251, a67
    v_mfma_f32_16x16x32_bf16 v[48:51], v[192:195], a[192:195], v[48:51]
    ds_read_b64_tr_b16 v[208:209], v8 offset:18496
    v_accvgpr_read_b32 v252, a80
    v_accvgpr_read_b32 v253, a81
    v_accvgpr_read_b32 v254, a82
    v_mfma_f32_16x16x32_bf16 v[48:51], v[196:199], a[208:211], v[48:51]
    ds_read_b64_tr_b16 v[210:211], v8 offset:23104
    v_accvgpr_read_b32 v255, a83
    v_mul_f32 v248, v248, v32
    v_mfma_f32_16x16x32_bf16 v[52:55], v[196:199], a[212:215], v[52:55]
    v_mul_f32 v249, v249, v32
    v_mul_f32 v250, v250, v32
    v_mul_f32 v251, v251, v32
    v_mfma_f32_16x16x32_bf16 v[52:55], v[192:195], a[196:199], v[52:55]
    v_mul_f32 v252, v252, v32
    v_mul_f32 v253, v253, v32
    v_mfma_f32_16x16x32_bf16 v[56:59], v[192:195], a[200:203], v[56:59]
    ds_read_b64_tr_b16 v[212:213], v8 offset:27712
    v_mul_f32 v254, v254, v32
    v_mul_f32 v255, v255, v32
    v_cvt_pk_bf16_f32 v216, v248, v249
    v_mfma_f32_16x16x32_bf16 v[56:59], v[196:199], a[216:219], v[56:59]
    ds_read_b64_tr_b16 v[214:215], v8 offset:32320
    s_waitcnt lgkmcnt(4)
    v_cvt_pk_bf16_f32 v217, v250, v251
    v_cvt_pk_bf16_f32 v218, v252, v253
    v_cvt_pk_bf16_f32 v219, v254, v255
    v_mfma_f32_16x16x32_bf16 v[60:63], v[196:199], a[220:223], v[60:63]
    buffer_load_dwordx4 v20, s[20:23], s92 offen offset:0 sc1 lds
    buffer_store_dwordx4 v[216:219], v10, s[16:19], s83 offen offset:2048 sc1
    v_mfma_f32_16x16x32_bf16 v[60:63], v[192:195], a[204:207], v[60:63]
    v_accvgpr_read_b32 v248, a68
    v_accvgpr_read_b32 v249, a69
    v_accvgpr_read_b32 v250, a70
    v_mfma_f32_16x16x32_bf16 v[64:67], v[200:203], a[192:195], v[64:67]
    ds_read_b64_tr_b16 v[192:193], v8 offset:18528
    v_accvgpr_read_b32 v251, a71
    v_accvgpr_read_b32 v252, a84
    v_mfma_f32_16x16x32_bf16 v[64:67], v[204:207], a[208:211], v[64:67]
    ds_read_b64_tr_b16 v[194:195], v8 offset:23136
    v_accvgpr_read_b32 v253, a85
    v_accvgpr_read_b32 v254, a86
    v_accvgpr_read_b32 v255, a87
    v_mfma_f32_16x16x32_bf16 v[68:71], v[204:207], a[212:215], v[68:71]
    buffer_load_dwordx4 a[128:131], v10, s[28:31], s79 offen offset:0 sc1
    v_mul_f32 v248, v248, v33
    v_mul_f32 v249, v249, v33
    v_mul_f32 v250, v250, v33
    v_mfma_f32_16x16x32_bf16 v[68:71], v[200:203], a[196:199], v[68:71]
    buffer_load_dwordx4 v21, s[20:23], s92 offen offset:1024 sc1 lds
    v_mul_f32 v251, v251, v33
    v_mfma_f32_16x16x32_bf16 v[72:75], v[200:203], a[200:203], v[72:75]
    ds_read_b64_tr_b16 v[196:197], v8 offset:27744
    v_mul_f32 v252, v252, v33
    v_mul_f32 v253, v253, v33
    v_mul_f32 v254, v254, v33
    v_mfma_f32_16x16x32_bf16 v[72:75], v[204:207], a[216:219], v[72:75]
    ds_read_b64_tr_b16 v[198:199], v8 offset:32352
    s_waitcnt lgkmcnt(4)
    v_mul_f32 v255, v255, v33
    v_cvt_pk_bf16_f32 v220, v248, v249
    v_mfma_f32_16x16x32_bf16 v[76:79], v[204:207], a[220:223], v[76:79]
    v_cvt_pk_bf16_f32 v221, v250, v251
    v_cvt_pk_bf16_f32 v222, v252, v253
    v_mfma_f32_16x16x32_bf16 v[76:79], v[200:203], a[204:207], v[76:79]
    v_cvt_pk_bf16_f32 v223, v254, v255
    buffer_store_dwordx4 v[220:223], v11, s[16:19], s83 offen offset:2048 sc1
    v_accvgpr_read_b32 v248, a72
    v_mfma_f32_16x16x32_bf16 v[80:83], v[208:211], a[192:195], v[80:83]
    ds_read_b64_tr_b16 v[200:201], v8 offset:18560
    v_accvgpr_read_b32 v249, a73
    v_accvgpr_read_b32 v250, a74
    v_mfma_f32_16x16x32_bf16 v[80:83], v[212:215], a[208:211], v[80:83]
    ds_read_b64_tr_b16 v[202:203], v8 offset:23168
    v_accvgpr_read_b32 v251, a75
    v_accvgpr_read_b32 v252, a88
    v_accvgpr_read_b32 v253, a89
    v_mfma_f32_16x16x32_bf16 v[84:87], v[212:215], a[212:215], v[84:87]
    buffer_load_dwordx4 a[132:135], v11, s[28:31], s79 offen offset:0 sc1
    v_accvgpr_read_b32 v254, a90
    v_accvgpr_read_b32 v255, a91
    v_mul_f32 v248, v248, v34
    v_mfma_f32_16x16x32_bf16 v[84:87], v[208:211], a[196:199], v[84:87]
    buffer_load_dwordx4 v22, s[20:23], s92 offen offset:2048 sc1 lds
    v_mul_f32 v249, v249, v34
    v_mfma_f32_16x16x32_bf16 v[88:91], v[208:211], a[200:203], v[88:91]
    ds_read_b64_tr_b16 v[204:205], v8 offset:27776
    v_mul_f32 v250, v250, v34
    v_mul_f32 v251, v251, v34
    v_mul_f32 v252, v252, v34
    v_mul_f32 v253, v253, v34
    v_mfma_f32_16x16x32_bf16 v[88:91], v[212:215], a[216:219], v[88:91]
    ds_read_b64_tr_b16 v[206:207], v8 offset:32384
    s_waitcnt lgkmcnt(4)
    v_mul_f32 v254, v254, v34
    v_mfma_f32_16x16x32_bf16 v[92:95], v[212:215], a[220:223], v[92:95]
    v_mul_f32 v255, v255, v34
    v_cvt_pk_bf16_f32 v224, v248, v249
    v_cvt_pk_bf16_f32 v225, v250, v251
    v_mfma_f32_16x16x32_bf16 v[92:95], v[208:211], a[204:207], v[92:95]
    v_cvt_pk_bf16_f32 v226, v252, v253
    v_cvt_pk_bf16_f32 v227, v254, v255
    v_mfma_f32_16x16x32_bf16 v[96:99], v[192:195], a[192:195], v[96:99]
    ds_read_b64_tr_b16 v[208:209], v8 offset:18592
    buffer_store_dwordx4 v[224:227], v12, s[16:19], s83 offen offset:2048 sc1
    v_accvgpr_read_b32 v248, a76
    v_mfma_f32_16x16x32_bf16 v[96:99], v[196:199], a[208:211], v[96:99]
    ds_read_b64_tr_b16 v[210:211], v8 offset:23200
    v_accvgpr_read_b32 v249, a77
    v_accvgpr_read_b32 v250, a78
    v_accvgpr_read_b32 v251, a79
    v_accvgpr_read_b32 v252, a92
    v_mfma_f32_16x16x32_bf16 v[100:103], v[196:199], a[212:215], v[100:103]
    buffer_load_dwordx4 a[136:139], v12, s[28:31], s79 offen offset:0 sc1
    v_accvgpr_read_b32 v253, a93
    v_accvgpr_read_b32 v254, a94
    v_mfma_f32_16x16x32_bf16 v[100:103], v[192:195], a[196:199], v[100:103]
    buffer_load_dwordx4 v23, s[20:23], s92 offen offset:3072 sc1 lds
    v_accvgpr_read_b32 v255, a95
    v_mul_f32 v248, v248, v35
    v_mfma_f32_16x16x32_bf16 v[104:107], v[192:195], a[200:203], v[104:107]
    ds_read_b64_tr_b16 v[212:213], v8 offset:27808
    v_mul_f32 v249, v249, v35
    v_mul_f32 v250, v250, v35
    v_mul_f32 v251, v251, v35
    v_mfma_f32_16x16x32_bf16 v[104:107], v[196:199], a[216:219], v[104:107]
    ds_read_b64_tr_b16 v[214:215], v8 offset:32416
    s_waitcnt lgkmcnt(4)
    v_mul_f32 v252, v252, v35
    v_mfma_f32_16x16x32_bf16 v[108:111], v[196:199], a[220:223], v[108:111]
    v_mul_f32 v253, v253, v35
    v_mul_f32 v254, v254, v35
    v_mul_f32 v255, v255, v35
    v_mfma_f32_16x16x32_bf16 v[108:111], v[192:195], a[204:207], v[108:111]
    v_cvt_pk_bf16_f32 v228, v248, v249
    v_cvt_pk_bf16_f32 v229, v250, v251
    v_cvt_pk_bf16_f32 v230, v252, v253
    v_mfma_f32_16x16x32_bf16 v[112:115], v[200:203], a[192:195], v[112:115]
    ds_read_b64_tr_b16 v[192:193], v8 offset:18624
    s_add_u32 m0, s94, 8192
    v_cvt_pk_bf16_f32 v231, v254, v255
    buffer_store_dwordx4 v[228:231], v13, s[16:19], s83 offen offset:2048 sc1
    v_mfma_f32_16x16x32_bf16 v[112:115], v[204:207], a[208:211], v[112:115]
    ds_read_b64_tr_b16 v[194:195], v8 offset:23232
    v_accvgpr_read_b32 v248, a96
    v_accvgpr_read_b32 v249, a97
    v_accvgpr_read_b32 v250, a98
    v_mfma_f32_16x16x32_bf16 v[116:119], v[204:207], a[212:215], v[116:119]
    buffer_load_dwordx4 a[140:143], v13, s[28:31], s79 offen offset:0 sc1
    v_accvgpr_read_b32 v251, a99
    v_mfma_f32_16x16x32_bf16 v[116:119], v[200:203], a[196:199], v[116:119]
    v_accvgpr_read_b32 v252, a112
    v_accvgpr_read_b32 v253, a113
    v_accvgpr_read_b32 v254, a114
    v_mfma_f32_16x16x32_bf16 v[120:123], v[200:203], a[200:203], v[120:123]
    ds_read_b64_tr_b16 v[196:197], v8 offset:27840
    v_accvgpr_read_b32 v255, a115
    v_mul_f32 v248, v248, v32
    v_mul_f32 v249, v249, v32
    v_mfma_f32_16x16x32_bf16 v[120:123], v[204:207], a[216:219], v[120:123]
    ds_read_b64_tr_b16 v[198:199], v8 offset:32448
    s_waitcnt lgkmcnt(4)
    v_mul_f32 v250, v250, v32
    v_mul_f32 v251, v251, v32
    v_mfma_f32_16x16x32_bf16 v[124:127], v[204:207], a[220:223], v[124:127]
    v_mul_f32 v252, v252, v32
    v_mul_f32 v253, v253, v32
    v_mul_f32 v254, v254, v32
    v_mfma_f32_16x16x32_bf16 v[124:127], v[200:203], a[204:207], v[124:127]
    buffer_load_dwordx4 v24, s[20:23], s92 offen offset:0 sc1 lds
    v_mul_f32 v255, v255, v32
    v_mfma_f32_16x16x32_bf16 v[128:131], v[208:211], a[192:195], v[128:131]
    ds_read_b64_tr_b16 v[200:201], v8 offset:18656
    v_cvt_pk_bf16_f32 v232, v248, v249
    v_cvt_pk_bf16_f32 v233, v250, v251
    v_cvt_pk_bf16_f32 v234, v252, v253
    v_mfma_f32_16x16x32_bf16 v[128:131], v[212:215], a[208:211], v[128:131]
    ds_read_b64_tr_b16 v[202:203], v8 offset:23264
    v_cvt_pk_bf16_f32 v235, v254, v255
    buffer_store_dwordx4 v[232:235], v10, s[16:19], s83 offen offset:3072 sc1
    v_accvgpr_read_b32 v248, a100
    v_mfma_f32_16x16x32_bf16 v[132:135], v[212:215], a[212:215], v[132:135]
    buffer_load_dwordx4 a[144:147], v10, s[28:31], s79 offen offset:1024 sc1
    v_accvgpr_read_b32 v249, a101
    v_accvgpr_read_b32 v250, a102
    v_mfma_f32_16x16x32_bf16 v[132:135], v[208:211], a[196:199], v[132:135]
    v_accvgpr_read_b32 v251, a103
    v_accvgpr_read_b32 v252, a116
    v_mfma_f32_16x16x32_bf16 v[136:139], v[208:211], a[200:203], v[136:139]
    ds_read_b64_tr_b16 v[204:205], v8 offset:27872
    v_accvgpr_read_b32 v253, a117
    v_accvgpr_read_b32 v254, a118
    v_accvgpr_read_b32 v255, a119
    v_mfma_f32_16x16x32_bf16 v[136:139], v[212:215], a[216:219], v[136:139]
    ds_read_b64_tr_b16 v[206:207], v8 offset:32480
    s_waitcnt lgkmcnt(4)
    v_mul_f32 v248, v248, v33
    v_mul_f32 v249, v249, v33
    v_mfma_f32_16x16x32_bf16 v[140:143], v[212:215], a[220:223], v[140:143]
    s_add_u32 s88, s88, 1
    v_mul_f32 v250, v250, v33
    v_mul_f32 v251, v251, v33
    v_mfma_f32_16x16x32_bf16 v[140:143], v[208:211], a[204:207], v[140:143]
    v_mul_f32 v252, v252, v33
    v_mul_f32 v253, v253, v33
    v_mul_f32 v254, v254, v33
    v_mfma_f32_16x16x32_bf16 v[144:147], v[192:195], a[192:195], v[144:147]
    ds_read_b64_tr_b16 v[208:209], v8 offset:18688
    v_mul_f32 v255, v255, v33
    v_cvt_pk_bf16_f32 v236, v248, v249
    v_mfma_f32_16x16x32_bf16 v[144:147], v[196:199], a[208:211], v[144:147]
    ds_read_b64_tr_b16 v[210:211], v8 offset:23296
    v_cvt_pk_bf16_f32 v237, v250, v251
    v_cvt_pk_bf16_f32 v238, v252, v253
    v_cvt_pk_bf16_f32 v239, v254, v255
    v_mfma_f32_16x16x32_bf16 v[148:151], v[196:199], a[212:215], v[148:151]
    buffer_load_dwordx4 a[148:151], v11, s[28:31], s79 offen offset:1024 sc1
    buffer_store_dwordx4 v[236:239], v11, s[16:19], s83 offen offset:3072 sc1
    v_accvgpr_read_b32 v248, a104
    v_mfma_f32_16x16x32_bf16 v[148:151], v[192:195], a[196:199], v[148:151]
    v_accvgpr_read_b32 v249, a105
    v_accvgpr_read_b32 v250, a106
    v_mfma_f32_16x16x32_bf16 v[152:155], v[192:195], a[200:203], v[152:155]
    ds_read_b64_tr_b16 v[212:213], v8 offset:27904
    v_accvgpr_read_b32 v251, a107
    v_accvgpr_read_b32 v252, a120
    v_accvgpr_read_b32 v253, a121
    v_mfma_f32_16x16x32_bf16 v[152:155], v[196:199], a[216:219], v[152:155]
    ds_read_b64_tr_b16 v[214:215], v8 offset:32512
    s_waitcnt lgkmcnt(4)
    v_accvgpr_read_b32 v254, a122
    v_accvgpr_read_b32 v255, a123
    v_mfma_f32_16x16x32_bf16 v[156:159], v[196:199], a[220:223], v[156:159]
    s_add_u32 s94, s94, 36864
    v_mul_f32 v248, v248, v34
    v_mul_f32 v249, v249, v34
    v_mfma_f32_16x16x32_bf16 v[156:159], v[192:195], a[204:207], v[156:159]
    v_add_u32 v8, s96, v5
    v_mul_f32 v250, v250, v34
    v_mul_f32 v251, v251, v34
    v_mul_f32 v252, v252, v34
    v_mfma_f32_16x16x32_bf16 v[160:163], v[200:203], a[192:195], v[160:163]
    ds_read_b64_tr_b16 v[192:193], v8 offset:0
    v_mul_f32 v253, v253, v34
    v_mul_f32 v254, v254, v34
    v_mfma_f32_16x16x32_bf16 v[160:163], v[204:207], a[208:211], v[160:163]
    ds_read_b64_tr_b16 v[194:195], v8 offset:4608
    v_mul_f32 v255, v255, v34
    v_cvt_pk_bf16_f32 v240, v248, v249
    v_cvt_pk_bf16_f32 v241, v250, v251
    v_mfma_f32_16x16x32_bf16 v[164:167], v[204:207], a[212:215], v[164:167]
    buffer_load_dwordx4 a[152:155], v12, s[28:31], s79 offen offset:1024 sc1
    v_cvt_pk_bf16_f32 v242, v252, v253
    v_cvt_pk_bf16_f32 v243, v254, v255
    v_mfma_f32_16x16x32_bf16 v[164:167], v[200:203], a[196:199], v[164:167]
    buffer_store_dwordx4 v[240:243], v12, s[16:19], s83 offen offset:3072 sc1
    v_accvgpr_read_b32 v248, a108
    v_mfma_f32_16x16x32_bf16 v[168:171], v[200:203], a[200:203], v[168:171]
    ds_read_b64_tr_b16 v[196:197], v8 offset:9216
    v_accvgpr_read_b32 v249, a109
    v_accvgpr_read_b32 v250, a110
    v_accvgpr_read_b32 v251, a111
    v_accvgpr_read_b32 v252, a124
    v_mfma_f32_16x16x32_bf16 v[168:171], v[204:207], a[216:219], v[168:171]
    ds_read_b64_tr_b16 v[198:199], v8 offset:13824
    s_waitcnt lgkmcnt(4)
    v_accvgpr_read_b32 v253, a125
    v_mfma_f32_16x16x32_bf16 v[172:175], v[204:207], a[220:223], v[172:175]
    s_cmp_ge_u32 s94, 147456
    s_cselect_b32 s94, s81, s94
    v_accvgpr_read_b32 v254, a126
    v_accvgpr_read_b32 v255, a127
    v_mul_f32 v248, v248, v35
    v_mfma_f32_16x16x32_bf16 v[172:175], v[200:203], a[204:207], v[172:175]
    v_mul_f32 v249, v249, v35
    v_mul_f32 v250, v250, v35
    v_mfma_f32_16x16x32_bf16 v[176:179], v[208:211], a[192:195], v[176:179]
    ds_read_b64_tr_b16 v[200:201], v8 offset:32
    v_mul_f32 v251, v251, v35
    v_mul_f32 v252, v252, v35
    v_mfma_f32_16x16x32_bf16 v[176:179], v[212:215], a[208:211], v[176:179]
    ds_read_b64_tr_b16 v[202:203], v8 offset:4640
    v_mul_f32 v253, v253, v35
    v_mul_f32 v254, v254, v35
    v_mul_f32 v255, v255, v35
    v_cvt_pk_bf16_f32 v244, v248, v249
    v_mfma_f32_16x16x32_bf16 v[180:183], v[212:215], a[212:215], v[180:183]
    buffer_load_dwordx4 a[156:159], v13, s[28:31], s79 offen offset:1024 sc1
    v_cvt_pk_bf16_f32 v245, v250, v251
    v_mfma_f32_16x16x32_bf16 v[180:183], v[208:211], a[196:199], v[180:183]
    v_cvt_pk_bf16_f32 v246, v252, v253
    v_cvt_pk_bf16_f32 v247, v254, v255
    buffer_store_dwordx4 v[244:247], v13, s[16:19], s83 offen offset:3072 sc1
    v_mfma_f32_16x16x32_bf16 v[184:187], v[208:211], a[200:203], v[184:187]
    ds_read_b64_tr_b16 v[204:205], v8 offset:9248
    s_waitcnt vmcnt(38)
    v_mfma_f32_16x16x32_bf16 v[184:187], v[212:215], a[216:219], v[184:187]
    ds_read_b64_tr_b16 v[206:207], v8 offset:13856
    s_waitcnt lgkmcnt(4)
    v_mfma_f32_16x16x32_bf16 v[188:191], v[212:215], a[220:223], v[188:191]
    v_mfma_f32_16x16x32_bf16 v[188:191], v[208:211], a[204:207], v[188:191]
    v_mfma_f32_16x16x32_bf16 v[48:51], v[192:195], a[160:163], v[48:51]
    ds_read_b64_tr_b16 v[208:209], v8 offset:64
    v_mfma_f32_16x16x32_bf16 v[48:51], v[196:199], a[176:179], v[48:51]
    ds_read_b64_tr_b16 v[210:211], v8 offset:4672
    v_mfma_f32_16x16x32_bf16 v[52:55], v[196:199], a[180:183], v[52:55]
    buffer_load_dwordx4 a[192:195], v10, s[28:31], s86 offen offset:0 sc1
    v_mfma_f32_16x16x32_bf16 v[52:55], v[192:195], a[164:167], v[52:55]
    v_mfma_f32_16x16x32_bf16 v[56:59], v[192:195], a[168:171], v[56:59]
    ds_read_b64_tr_b16 v[212:213], v8 offset:9280
    v_mfma_f32_16x16x32_bf16 v[56:59], v[196:199], a[184:187], v[56:59]
    ds_read_b64_tr_b16 v[214:215], v8 offset:13888
    s_waitcnt lgkmcnt(4)
    v_mfma_f32_16x16x32_bf16 v[60:63], v[196:199], a[188:191], v[60:63]
    s_barrier
    v_mfma_f32_16x16x32_bf16 v[60:63], v[192:195], a[172:175], v[60:63]
    s_add_u32 s96, s96, 36864
    s_cmp_eq_u32 s96, 147456
    s_cselect_b32 s96, 0, s96
    v_mfma_f32_16x16x32_bf16 v[64:67], v[200:203], a[160:163], v[64:67]
    ds_read_b64_tr_b16 v[192:193], v8 offset:96
    v_mfma_f32_16x16x32_bf16 v[64:67], v[204:207], a[176:179], v[64:67]
    ds_read_b64_tr_b16 v[194:195], v8 offset:4704
    v_mfma_f32_16x16x32_bf16 v[68:71], v[204:207], a[180:183], v[68:71]
    buffer_load_dwordx4 a[196:199], v11, s[28:31], s86 offen offset:0 sc1
    v_mfma_f32_16x16x32_bf16 v[68:71], v[200:203], a[164:167], v[68:71]
    v_mfma_f32_16x16x32_bf16 v[72:75], v[200:203], a[168:171], v[72:75]
    ds_read_b64_tr_b16 v[196:197], v8 offset:9312
    s_xor_b32 s92, s88, s85
    v_mfma_f32_16x16x32_bf16 v[72:75], v[204:207], a[184:187], v[72:75]
    ds_read_b64_tr_b16 v[198:199], v8 offset:13920
    s_waitcnt lgkmcnt(4)
    v_mfma_f32_16x16x32_bf16 v[76:79], v[204:207], a[188:191], v[76:79]
    v_mfma_f32_16x16x32_bf16 v[76:79], v[200:203], a[172:175], v[76:79]
    v_mfma_f32_16x16x32_bf16 v[80:83], v[208:211], a[160:163], v[80:83]
    ds_read_b64_tr_b16 v[200:201], v8 offset:128
    v_mfma_f32_16x16x32_bf16 v[80:83], v[212:215], a[176:179], v[80:83]
    ds_read_b64_tr_b16 v[202:203], v8 offset:4736
    v_mfma_f32_16x16x32_bf16 v[84:87], v[212:215], a[180:183], v[84:87]
    v_mfma_f32_16x16x32_bf16 v[84:87], v[208:211], a[164:167], v[84:87]
    buffer_load_dwordx4 a[200:203], v12, s[28:31], s86 offen offset:0 sc1
    v_mfma_f32_16x16x32_bf16 v[88:91], v[208:211], a[168:171], v[88:91]
    ds_read_b64_tr_b16 v[204:205], v8 offset:9344
    s_mul_i32 s92, s92, s97
    v_mfma_f32_16x16x32_bf16 v[88:91], v[212:215], a[184:187], v[88:91]
    ds_read_b64_tr_b16 v[206:207], v8 offset:13952
    s_waitcnt lgkmcnt(4)
    v_mfma_f32_16x16x32_bf16 v[92:95], v[212:215], a[188:191], v[92:95]
    v_mfma_f32_16x16x32_bf16 v[92:95], v[208:211], a[172:175], v[92:95]
    v_mfma_f32_16x16x32_bf16 v[96:99], v[192:195], a[160:163], v[96:99]
    ds_read_b64_tr_b16 v[208:209], v8 offset:160
    v_mfma_f32_16x16x32_bf16 v[96:99], v[196:199], a[176:179], v[96:99]
    ds_read_b64_tr_b16 v[210:211], v8 offset:4768
    v_mfma_f32_16x16x32_bf16 v[100:103], v[196:199], a[180:183], v[100:103]
    s_add_u32 s92, s92, s93
    v_mfma_f32_16x16x32_bf16 v[100:103], v[192:195], a[164:167], v[100:103]
    buffer_load_dwordx4 a[204:207], v13, s[28:31], s86 offen offset:0 sc1
    v_mfma_f32_16x16x32_bf16 v[104:107], v[192:195], a[168:171], v[104:107]
    ds_read_b64_tr_b16 v[212:213], v8 offset:9376
    v_mfma_f32_16x16x32_bf16 v[104:107], v[196:199], a[184:187], v[104:107]
    ds_read_b64_tr_b16 v[214:215], v8 offset:13984
    s_waitcnt lgkmcnt(4)
    v_mfma_f32_16x16x32_bf16 v[108:111], v[196:199], a[188:191], v[108:111]
    v_mfma_f32_16x16x32_bf16 v[108:111], v[192:195], a[172:175], v[108:111]
    v_mfma_f32_16x16x32_bf16 v[112:115], v[200:203], a[160:163], v[112:115]
    ds_read_b64_tr_b16 v[192:193], v8 offset:192
    v_mfma_f32_16x16x32_bf16 v[112:115], v[204:207], a[176:179], v[112:115]
    ds_read_b64_tr_b16 v[194:195], v8 offset:4800
    s_add_u32 m0, s94, 0
    v_mfma_f32_16x16x32_bf16 v[116:119], v[204:207], a[180:183], v[116:119]
    v_mfma_f32_16x16x32_bf16 v[116:119], v[200:203], a[164:167], v[116:119]
    v_mfma_f32_16x16x32_bf16 v[120:123], v[200:203], a[168:171], v[120:123]
    ds_read_b64_tr_b16 v[196:197], v8 offset:9408
    v_mfma_f32_16x16x32_bf16 v[120:123], v[204:207], a[184:187], v[120:123]
    ds_read_b64_tr_b16 v[198:199], v8 offset:14016
    s_waitcnt lgkmcnt(4)
    v_mfma_f32_16x16x32_bf16 v[124:127], v[204:207], a[188:191], v[124:127]
    buffer_load_dwordx4 a[208:211], v10, s[28:31], s86 offen offset:1024 sc1
    v_mfma_f32_16x16x32_bf16 v[124:127], v[200:203], a[172:175], v[124:127]
    v_mfma_f32_16x16x32_bf16 v[128:131], v[208:211], a[160:163], v[128:131]
    ds_read_b64_tr_b16 v[200:201], v8 offset:224
    v_mfma_f32_16x16x32_bf16 v[128:131], v[212:215], a[176:179], v[128:131]
    ds_read_b64_tr_b16 v[202:203], v8 offset:4832
    v_mfma_f32_16x16x32_bf16 v[132:135], v[212:215], a[180:183], v[132:135]
    buffer_load_dwordx4 v16, s[20:23], s92 offen offset:0 sc1 lds
    v_mfma_f32_16x16x32_bf16 v[132:135], v[208:211], a[164:167], v[132:135]
    v_mfma_f32_16x16x32_bf16 v[136:139], v[208:211], a[168:171], v[136:139]
    ds_read_b64_tr_b16 v[204:205], v8 offset:9440
    v_mfma_f32_16x16x32_bf16 v[136:139], v[212:215], a[184:187], v[136:139]
    ds_read_b64_tr_b16 v[206:207], v8 offset:14048
    s_waitcnt lgkmcnt(4)
    v_mfma_f32_16x16x32_bf16 v[140:143], v[212:215], a[188:191], v[140:143]
    buffer_load_dwordx4 a[212:215], v11, s[28:31], s86 offen offset:1024 sc1
    v_mfma_f32_16x16x32_bf16 v[140:143], v[208:211], a[172:175], v[140:143]
    buffer_load_dwordx4 v17, s[20:23], s92 offen offset:1024 sc1 lds
    v_mfma_f32_16x16x32_bf16 v[144:147], v[192:195], a[160:163], v[144:147]
    ds_read_b64_tr_b16 v[208:209], v8 offset:256
    v_mfma_f32_16x16x32_bf16 v[144:147], v[196:199], a[176:179], v[144:147]
    ds_read_b64_tr_b16 v[210:211], v8 offset:4864
    v_mfma_f32_16x16x32_bf16 v[148:151], v[196:199], a[180:183], v[148:151]
    v_mfma_f32_16x16x32_bf16 v[148:151], v[192:195], a[164:167], v[148:151]
    v_mfma_f32_16x16x32_bf16 v[152:155], v[192:195], a[168:171], v[152:155]
    ds_read_b64_tr_b16 v[212:213], v8 offset:9472
    v_mfma_f32_16x16x32_bf16 v[152:155], v[196:199], a[184:187], v[152:155]
    ds_read_b64_tr_b16 v[214:215], v8 offset:14080
    s_waitcnt lgkmcnt(4)
    v_mfma_f32_16x16x32_bf16 v[156:159], v[196:199], a[188:191], v[156:159]
    buffer_load_dwordx4 a[216:219], v12, s[28:31], s86 offen offset:1024 sc1
    v_mfma_f32_16x16x32_bf16 v[156:159], v[192:195], a[172:175], v[156:159]
    buffer_load_dwordx4 v18, s[20:23], s92 offen offset:2048 sc1 lds
    v_mfma_f32_16x16x32_bf16 v[160:163], v[200:203], a[160:163], v[160:163]
    ds_read_b64_tr_b16 v[192:193], v8 offset:18432
    v_mfma_f32_16x16x32_bf16 v[160:163], v[204:207], a[176:179], v[160:163]
    ds_read_b64_tr_b16 v[194:195], v8 offset:23040
    v_mfma_f32_16x16x32_bf16 v[164:167], v[204:207], a[180:183], v[164:167]
    s_waitcnt vmcnt(10)
    s_mov_b64 exec, 0xf
    buffer_store_dword v7, v14, s[16:19], s90 offen sc1
    s_mov_b64 exec, -1
    v_mfma_f32_16x16x32_bf16 v[164:167], v[200:203], a[164:167], v[164:167]
    v_mfma_f32_16x16x32_bf16 v[168:171], v[200:203], a[168:171], v[168:171]
    ds_read_b64_tr_b16 v[196:197], v8 offset:27648
    v_mfma_f32_16x16x32_bf16 v[168:171], v[204:207], a[184:187], v[168:171]
    ds_read_b64_tr_b16 v[198:199], v8 offset:32256
    s_waitcnt lgkmcnt(4)
    v_mfma_f32_16x16x32_bf16 v[172:175], v[204:207], a[188:191], v[172:175]
    buffer_load_dwordx4 a[220:223], v13, s[28:31], s86 offen offset:1024 sc1
    v_mfma_f32_16x16x32_bf16 v[172:175], v[200:203], a[172:175], v[172:175]
    buffer_load_dwordx4 v19, s[20:23], s92 offen offset:3072 sc1 lds
    v_mfma_f32_16x16x32_bf16 v[176:179], v[208:211], a[160:163], v[176:179]
    ds_read_b64_tr_b16 v[200:201], v8 offset:18464
    v_mfma_f32_16x16x32_bf16 v[176:179], v[212:215], a[176:179], v[176:179]
    ds_read_b64_tr_b16 v[202:203], v8 offset:23072
    v_mfma_f32_16x16x32_bf16 v[180:183], v[212:215], a[180:183], v[180:183]
    v_mfma_f32_16x16x32_bf16 v[180:183], v[208:211], a[164:167], v[180:183]
    v_mfma_f32_16x16x32_bf16 v[184:187], v[208:211], a[168:171], v[184:187]
    ds_read_b64_tr_b16 v[204:205], v8 offset:27680
    v_mfma_f32_16x16x32_bf16 v[184:187], v[212:215], a[184:187], v[184:187]
    ds_read_b64_tr_b16 v[206:207], v8 offset:32288
    s_waitcnt lgkmcnt(4)
    v_mfma_f32_16x16x32_bf16 v[188:191], v[212:215], a[188:191], v[188:191]
    s_add_u32 m0, s94, 4096
    v_mfma_f32_16x16x32_bf16 v[188:191], v[208:211], a[172:175], v[188:191]
    v_mfma_f32_16x16x32_bf16 v[48:51], v[192:195], a[224:227], v[48:51]
    ds_read_b64_tr_b16 v[208:209], v8 offset:18496
    v_mfma_f32_16x16x32_bf16 v[48:51], v[196:199], a[240:243], v[48:51]
    ds_read_b64_tr_b16 v[210:211], v8 offset:23104
    v_mfma_f32_16x16x32_bf16 v[52:55], v[196:199], a[244:247], v[52:55]
    buffer_load_dwordx4 a[160:163], v10, s[28:31], s79 offen offset:2048 sc1
    v_mfma_f32_16x16x32_bf16 v[52:55], v[192:195], a[228:231], v[52:55]
    v_mfma_f32_16x16x32_bf16 v[56:59], v[192:195], a[232:235], v[56:59]
    ds_read_b64_tr_b16 v[212:213], v8 offset:27712
    v_mfma_f32_16x16x32_bf16 v[56:59], v[196:199], a[248:251], v[56:59]
    ds_read_b64_tr_b16 v[214:215], v8 offset:32320
    s_waitcnt lgkmcnt(4)
    v_mfma_f32_16x16x32_bf16 v[60:63], v[196:199], a[252:255], v[60:63]
    buffer_load_dwordx4 a[164:167], v11, s[28:31], s79 offen offset:2048 sc1
    v_mfma_f32_16x16x32_bf16 v[60:63], v[192:195], a[236:239], v[60:63]
    buffer_load_dwordx4 v20, s[20:23], s92 offen offset:0 sc1 lds
    v_mfma_f32_16x16x32_bf16 v[64:67], v[200:203], a[224:227], v[64:67]
    ds_read_b64_tr_b16 v[192:193], v8 offset:18528
    v_mfma_f32_16x16x32_bf16 v[64:67], v[204:207], a[240:243], v[64:67]
    ds_read_b64_tr_b16 v[194:195], v8 offset:23136
    v_mfma_f32_16x16x32_bf16 v[68:71], v[204:207], a[244:247], v[68:71]
    v_mfma_f32_16x16x32_bf16 v[68:71], v[200:203], a[228:231], v[68:71]
    buffer_load_dwordx4 v21, s[20:23], s92 offen offset:1024 sc1 lds
    v_mfma_f32_16x16x32_bf16 v[72:75], v[200:203], a[232:235], v[72:75]
    ds_read_b64_tr_b16 v[196:197], v8 offset:27744
    v_mfma_f32_16x16x32_bf16 v[72:75], v[204:207], a[248:251], v[72:75]
    ds_read_b64_tr_b16 v[198:199], v8 offset:32352
    s_waitcnt lgkmcnt(4)
    v_mfma_f32_16x16x32_bf16 v[76:79], v[204:207], a[252:255], v[76:79]
    buffer_load_dwordx4 a[168:171], v12, s[28:31], s79 offen offset:2048 sc1
    v_mfma_f32_16x16x32_bf16 v[76:79], v[200:203], a[236:239], v[76:79]
    v_mfma_f32_16x16x32_bf16 v[80:83], v[208:211], a[224:227], v[80:83]
    ds_read_b64_tr_b16 v[200:201], v8 offset:18560
    v_mfma_f32_16x16x32_bf16 v[80:83], v[212:215], a[240:243], v[80:83]
    ds_read_b64_tr_b16 v[202:203], v8 offset:23168
    v_mfma_f32_16x16x32_bf16 v[84:87], v[212:215], a[244:247], v[84:87]
    buffer_load_dwordx4 v22, s[20:23], s92 offen offset:2048 sc1 lds
    v_mfma_f32_16x16x32_bf16 v[84:87], v[208:211], a[228:231], v[84:87]
    buffer_load_dwordx4 a[172:175], v13, s[28:31], s79 offen offset:2048 sc1
    v_mfma_f32_16x16x32_bf16 v[88:91], v[208:211], a[232:235], v[88:91]
    ds_read_b64_tr_b16 v[204:205], v8 offset:27776
    v_mfma_f32_16x16x32_bf16 v[88:91], v[212:215], a[248:251], v[88:91]
    ds_read_b64_tr_b16 v[206:207], v8 offset:32384
    s_waitcnt lgkmcnt(4)
    v_mfma_f32_16x16x32_bf16 v[92:95], v[212:215], a[252:255], v[92:95]
    v_mfma_f32_16x16x32_bf16 v[92:95], v[208:211], a[236:239], v[92:95]
    v_mfma_f32_16x16x32_bf16 v[96:99], v[192:195], a[224:227], v[96:99]
    ds_read_b64_tr_b16 v[208:209], v8 offset:18592
    v_mfma_f32_16x16x32_bf16 v[96:99], v[196:199], a[240:243], v[96:99]
    ds_read_b64_tr_b16 v[210:211], v8 offset:23200
    v_mfma_f32_16x16x32_bf16 v[100:103], v[196:199], a[244:247], v[100:103]
    buffer_load_dwordx4 a[176:179], v10, s[28:31], s79 offen offset:3072 sc1
    v_mfma_f32_16x16x32_bf16 v[100:103], v[192:195], a[228:231], v[100:103]
    buffer_load_dwordx4 v23, s[20:23], s92 offen offset:3072 sc1 lds
    v_mfma_f32_16x16x32_bf16 v[104:107], v[192:195], a[232:235], v[104:107]
    ds_read_b64_tr_b16 v[212:213], v8 offset:27808
    v_mfma_f32_16x16x32_bf16 v[104:107], v[196:199], a[248:251], v[104:107]
    ds_read_b64_tr_b16 v[214:215], v8 offset:32416
    s_waitcnt lgkmcnt(4)
    v_mfma_f32_16x16x32_bf16 v[108:111], v[196:199], a[252:255], v[108:111]
    v_mfma_f32_16x16x32_bf16 v[108:111], v[192:195], a[236:239], v[108:111]
    v_mfma_f32_16x16x32_bf16 v[112:115], v[200:203], a[224:227], v[112:115]
    ds_read_b64_tr_b16 v[192:193], v8 offset:18624
    s_add_u32 m0, s94, 8192
    v_mfma_f32_16x16x32_bf16 v[112:115], v[204:207], a[240:243], v[112:115]
    ds_read_b64_tr_b16 v[194:195], v8 offset:23232
    v_mfma_f32_16x16x32_bf16 v[116:119], v[204:207], a[244:247], v[116:119]
    buffer_load_dwordx4 a[180:183], v11, s[28:31], s79 offen offset:3072 sc1
    v_mfma_f32_16x16x32_bf16 v[116:119], v[200:203], a[228:231], v[116:119]
    v_mfma_f32_16x16x32_bf16 v[120:123], v[200:203], a[232:235], v[120:123]
    ds_read_b64_tr_b16 v[196:197], v8 offset:27840
    v_mfma_f32_16x16x32_bf16 v[120:123], v[204:207], a[248:251], v[120:123]
    ds_read_b64_tr_b16 v[198:199], v8 offset:32448
    s_waitcnt lgkmcnt(4)
    v_mfma_f32_16x16x32_bf16 v[124:127], v[204:207], a[252:255], v[124:127]
    buffer_load_dwordx4 a[184:187], v12, s[28:31], s79 offen offset:3072 sc1
    v_mfma_f32_16x16x32_bf16 v[124:127], v[200:203], a[236:239], v[124:127]
    buffer_load_dwordx4 v24, s[20:23], s92 offen offset:0 sc1 lds
    v_mfma_f32_16x16x32_bf16 v[128:131], v[208:211], a[224:227], v[128:131]
    ds_read_b64_tr_b16 v[200:201], v8 offset:18656
    v_mfma_f32_16x16x32_bf16 v[128:131], v[212:215], a[240:243], v[128:131]
    ds_read_b64_tr_b16 v[202:203], v8 offset:23264
    v_mfma_f32_16x16x32_bf16 v[132:135], v[212:215], a[244:247], v[132:135]
    v_mfma_f32_16x16x32_bf16 v[132:135], v[208:211], a[228:231], v[132:135]
    v_mfma_f32_16x16x32_bf16 v[136:139], v[208:211], a[232:235], v[136:139]
    ds_read_b64_tr_b16 v[204:205], v8 offset:27872
    v_mfma_f32_16x16x32_bf16 v[136:139], v[212:215], a[248:251], v[136:139]
    ds_read_b64_tr_b16 v[206:207], v8 offset:32480
    s_waitcnt lgkmcnt(4)
    v_mfma_f32_16x16x32_bf16 v[140:143], v[212:215], a[252:255], v[140:143]
    buffer_load_dwordx4 a[188:191], v13, s[28:31], s79 offen offset:3072 sc1
    v_mfma_f32_16x16x32_bf16 v[140:143], v[208:211], a[236:239], v[140:143]
    s_add_u32 s88, s88, 1
    v_mfma_f32_16x16x32_bf16 v[144:147], v[192:195], a[224:227], v[144:147]
    ds_read_b64_tr_b16 v[208:209], v8 offset:18688
    v_mfma_f32_16x16x32_bf16 v[144:147], v[196:199], a[240:243], v[144:147]
    ds_read_b64_tr_b16 v[210:211], v8 offset:23296
    v_mfma_f32_16x16x32_bf16 v[148:151], v[196:199], a[244:247], v[148:151]
    v_mfma_f32_16x16x32_bf16 v[148:151], v[192:195], a[228:231], v[148:151]
    s_xor_b32 s79, s87, s85
    s_lshl_b32 s79, s79, 12
    v_mfma_f32_16x16x32_bf16 v[152:155], v[192:195], a[232:235], v[152:155]
    ds_read_b64_tr_b16 v[212:213], v8 offset:27904
    v_mfma_f32_16x16x32_bf16 v[152:155], v[196:199], a[248:251], v[152:155]
    ds_read_b64_tr_b16 v[214:215], v8 offset:32512
    s_waitcnt lgkmcnt(4)
    v_mfma_f32_16x16x32_bf16 v[156:159], v[196:199], a[252:255], v[156:159]
    s_add_u32 s94, s94, 36864
    v_mfma_f32_16x16x32_bf16 v[156:159], v[192:195], a[236:239], v[156:159]
    v_add_u32 v8, s96, v5
    v_mfma_f32_16x16x32_bf16 v[160:163], v[200:203], a[224:227], v[160:163]
    ds_read_b64_tr_b16 v[192:193], v8 offset:0
    v_mfma_f32_16x16x32_bf16 v[160:163], v[204:207], a[240:243], v[160:163]
    ds_read_b64_tr_b16 v[194:195], v8 offset:4608
    v_mfma_f32_16x16x32_bf16 v[164:167], v[204:207], a[244:247], v[164:167]
    s_add_u32 s79, s79, s80
    s_add_u32 s87, s87, 1
    v_mfma_f32_16x16x32_bf16 v[164:167], v[200:203], a[228:231], v[164:167]
    v_mfma_f32_16x16x32_bf16 v[168:171], v[200:203], a[232:235], v[168:171]
    ds_read_b64_tr_b16 v[196:197], v8 offset:9216
    v_mfma_f32_16x16x32_bf16 v[168:171], v[204:207], a[248:251], v[168:171]
    ds_read_b64_tr_b16 v[198:199], v8 offset:13824
    s_waitcnt lgkmcnt(4)
    v_mfma_f32_16x16x32_bf16 v[172:175], v[204:207], a[252:255], v[172:175]
    s_cmp_ge_u32 s94, 147456
    s_cselect_b32 s94, s81, s94
    v_mfma_f32_16x16x32_bf16 v[172:175], v[200:203], a[236:239], v[172:175]
    v_mfma_f32_16x16x32_bf16 v[176:179], v[208:211], a[224:227], v[176:179]
    ds_read_b64_tr_b16 v[200:201], v8 offset:32
    v_mfma_f32_16x16x32_bf16 v[176:179], v[212:215], a[240:243], v[176:179]
    ds_read_b64_tr_b16 v[202:203], v8 offset:4640
    v_mfma_f32_16x16x32_bf16 v[180:183], v[212:215], a[244:247], v[180:183]
    v_mfma_f32_16x16x32_bf16 v[180:183], v[208:211], a[228:231], v[180:183]
    v_mfma_f32_16x16x32_bf16 v[184:187], v[208:211], a[232:235], v[184:187]
    ds_read_b64_tr_b16 v[204:205], v8 offset:9248
    v_mfma_f32_16x16x32_bf16 v[184:187], v[212:215], a[248:251], v[184:187]
    ds_read_b64_tr_b16 v[206:207], v8 offset:13856
    s_waitcnt lgkmcnt(4)
    v_mfma_f32_16x16x32_bf16 v[188:191], v[212:215], a[252:255], v[188:191]
    v_mfma_f32_16x16x32_bf16 v[188:191], v[208:211], a[236:239], v[188:191]
    s_branch KF_loop2
KF_spre:
    ds_read_b64_tr_b16 v[192:193], v8 offset:0
    ds_read_b64_tr_b16 v[194:195], v8 offset:4608
    ds_read_b64_tr_b16 v[196:197], v8 offset:32
    ds_read_b64_tr_b16 v[198:199], v8 offset:4640
    ds_read_b64_tr_b16 v[200:201], v8 offset:64
    ds_read_b64_tr_b16 v[202:203], v8 offset:4672
    ds_read_b64_tr_b16 v[204:205], v8 offset:96
    ds_read_b64_tr_b16 v[206:207], v8 offset:4704
    v_accvgpr_read_b32 v40, a0
    v_accvgpr_read_b32 v41, a1
    v_accvgpr_read_b32 v42, a2
    v_accvgpr_read_b32 v43, a3
    v_accvgpr_read_b32 v44, a16
    v_accvgpr_read_b32 v45, a17
    v_accvgpr_read_b32 v46, a18
    v_accvgpr_read_b32 v47, a19
    v_pk_mul_f32 v[40:41], v[40:41], v[32:33] op_sel:[0,0] op_sel_hi:[1,0]
    v_pk_mul_f32 v[42:43], v[42:43], v[32:33] op_sel:[0,0] op_sel_hi:[1,0]
    v_pk_mul_f32 v[44:45], v[44:45], v[32:33] op_sel:[0,0] op_sel_hi:[1,0]
    v_pk_mul_f32 v[46:47], v[46:47], v[32:33] op_sel:[0,0] op_sel_hi:[1,0]
    v_cvt_pk_bf16_f32 v216, v40, v41
    v_cvt_pk_bf16_f32 v217, v42, v43
    v_cvt_pk_bf16_f32 v218, v44, v45
    v_cvt_pk_bf16_f32 v219, v46, v47
    buffer_store_dwordx4 v[216:219], v10, s[16:19], s83 offen offset:0 sc1
    v_accvgpr_read_b32 v248, a4
    v_accvgpr_read_b32 v249, a5
    v_accvgpr_read_b32 v250, a6
    v_accvgpr_read_b32 v251, a7
    v_accvgpr_read_b32 v252, a20
    v_accvgpr_read_b32 v253, a21
    v_accvgpr_read_b32 v254, a22
    v_accvgpr_read_b32 v255, a23
    v_pk_mul_f32 v[248:249], v[248:249], v[32:33] op_sel:[0,1] op_sel_hi:[1,1]
    v_pk_mul_f32 v[250:251], v[250:251], v[32:33] op_sel:[0,1] op_sel_hi:[1,1]
    v_pk_mul_f32 v[252:253], v[252:253], v[32:33] op_sel:[0,1] op_sel_hi:[1,1]
    v_pk_mul_f32 v[254:255], v[254:255], v[32:33] op_sel:[0,1] op_sel_hi:[1,1]
    v_cvt_pk_bf16_f32 v220, v248, v249
    v_cvt_pk_bf16_f32 v221, v250, v251
    v_cvt_pk_bf16_f32 v222, v252, v253
    v_cvt_pk_bf16_f32 v223, v254, v255
    buffer_store_dwordx4 v[220:223], v11, s[16:19], s83 offen offset:0 sc1
    v_accvgpr_read_b32 v40, a8
    v_accvgpr_read_b32 v41, a9
    v_accvgpr_read_b32 v42, a10
    v_accvgpr_read_b32 v43, a11
    v_accvgpr_read_b32 v44, a24
    v_accvgpr_read_b32 v45, a25
    v_accvgpr_read_b32 v46, a26
    v_accvgpr_read_b32 v47, a27
    v_pk_mul_f32 v[40:41], v[40:41], v[34:35] op_sel:[0,0] op_sel_hi:[1,0]
    v_pk_mul_f32 v[42:43], v[42:43], v[34:35] op_sel:[0,0] op_sel_hi:[1,0]
    v_pk_mul_f32 v[44:45], v[44:45], v[34:35] op_sel:[0,0] op_sel_hi:[1,0]
    v_pk_mul_f32 v[46:47], v[46:47], v[34:35] op_sel:[0,0] op_sel_hi:[1,0]
    v_cvt_pk_bf16_f32 v224, v40, v41
    v_cvt_pk_bf16_f32 v225, v42, v43
    v_cvt_pk_bf16_f32 v226, v44, v45
    v_cvt_pk_bf16_f32 v227, v46, v47
    buffer_store_dwordx4 v[224:227], v12, s[16:19], s83 offen offset:0 sc1
    v_accvgpr_read_b32 v248, a12
    v_accvgpr_read_b32 v249, a13
    v_accvgpr_read_b32 v250, a14
    v_accvgpr_read_b32 v251, a15
    v_accvgpr_read_b32 v252, a28
    v_accvgpr_read_b32 v253, a29
    v_accvgpr_read_b32 v254, a30
    v_accvgpr_read_b32 v255, a31
    v_pk_mul_f32 v[248:249], v[248:249], v[34:35] op_sel:[0,1] op_sel_hi:[1,1]
    v_pk_mul_f32 v[250:251], v[250:251], v[34:35] op_sel:[0,1] op_sel_hi:[1,1]
    v_pk_mul_f32 v[252:253], v[252:253], v[34:35] op_sel:[0,1] op_sel_hi:[1,1]
    v_pk_mul_f32 v[254:255], v[254:255], v[34:35] op_sel:[0,1] op_sel_hi:[1,1]
    v_cvt_pk_bf16_f32 v228, v248, v249
    v_cvt_pk_bf16_f32 v229, v250, v251
    v_cvt_pk_bf16_f32 v230, v252, v253
    v_cvt_pk_bf16_f32 v231, v254, v255
    buffer_store_dwordx4 v[228:231], v13, s[16:19], s83 offen offset:0 sc1
    s_waitcnt lgkmcnt(6)
    v_mfma_f32_16x16x32_bf16 v[48:51], v[192:195], v[216:219], 0
    ds_read_b64_tr_b16 v[208:209], v8 offset:128
    v_accvgpr_read_b32 v248, a32
    v_accvgpr_read_b32 v249, a33
    v_accvgpr_read_b32 v250, a34
    v_mfma_f32_16x16x32_bf16 v[52:55], v[192:195], v[220:223], 0
    ds_read_b64_tr_b16 v[210:211], v8 offset:4736
    s_waitcnt lgkmcnt(6)
    v_accvgpr_read_b32 v251, a35
    v_mfma_f32_16x16x32_bf16 v[56:59], v[192:195], v[224:227], 0
    v_accvgpr_read_b32 v252, a48
    v_accvgpr_read_b32 v253, a49
    v_accvgpr_read_b32 v254, a50
    v_mfma_f32_16x16x32_bf16 v[60:63], v[192:195], v[228:231], 0
    v_accvgpr_read_b32 v255, a51
    v_mul_f32 v248, v248, v32
    v_mfma_f32_16x16x32_bf16 v[64:67], v[196:199], v[216:219], 0
    ds_read_b64_tr_b16 v[212:213], v8 offset:160
    v_mul_f32 v249, v249, v32
    v_mul_f32 v250, v250, v32
    v_mul_f32 v251, v251, v32
    v_mfma_f32_16x16x32_bf16 v[68:71], v[196:199], v[220:223], 0
    ds_read_b64_tr_b16 v[214:215], v8 offset:4768
    s_waitcnt lgkmcnt(6)
    v_mul_f32 v252, v252, v32
    v_mul_f32 v253, v253, v32
    v_mul_f32 v254, v254, v32
    v_mfma_f32_16x16x32_bf16 v[72:75], v[196:199], v[224:227], 0
    s_waitcnt vmcnt(32)
    s_barrier
    v_mul_f32 v255, v255, v32
    v_cvt_pk_bf16_f32 v232, v248, v249
    v_mfma_f32_16x16x32_bf16 v[76:79], v[196:199], v[228:231], 0
    s_add_u32 s96, s96, 36864
    s_cmp_eq_u32 s96, 147456
    s_cselect_b32 s96, 0, s96
    v_cvt_pk_bf16_f32 v233, v250, v251
    v_cvt_pk_bf16_f32 v234, v252, v253
    v_mfma_f32_16x16x32_bf16 v[80:83], v[200:203], v[216:219], 0
    ds_read_b64_tr_b16 v[192:193], v8 offset:192
    v_cvt_pk_bf16_f32 v235, v254, v255
    buffer_store_dwordx4 v[232:235], v10, s[16:19], s83 offen offset:1024 sc1
    v_accvgpr_read_b32 v248, a36
    v_mfma_f32_16x16x32_bf16 v[84:87], v[200:203], v[220:223], 0
    ds_read_b64_tr_b16 v[194:195], v8 offset:4800
    s_waitcnt lgkmcnt(6)
    v_accvgpr_read_b32 v249, a37
    v_accvgpr_read_b32 v250, a38
    v_mfma_f32_16x16x32_bf16 v[88:91], v[200:203], v[224:227], 0
    v_accvgpr_read_b32 v251, a39
    v_accvgpr_read_b32 v252, a52
    v_mfma_f32_16x16x32_bf16 v[92:95], v[200:203], v[228:231], 0
    v_accvgpr_read_b32 v253, a53
    v_accvgpr_read_b32 v254, a54
    v_mfma_f32_16x16x32_bf16 v[96:99], v[204:207], v[216:219], 0
    ds_read_b64_tr_b16 v[196:197], v8 offset:224
    v_accvgpr_read_b32 v255, a55
    v_mul_f32 v248, v248, v33
    v_mul_f32 v249, v249, v33
    v_mul_f32 v250, v250, v33
    v_mfma_f32_16x16x32_bf16 v[100:103], v[204:207], v[220:223], 0
    ds_read_b64_tr_b16 v[198:199], v8 offset:4832
    s_waitcnt lgkmcnt(6)
    v_mul_f32 v251, v251, v33
    v_mfma_f32_16x16x32_bf16 v[104:107], v[204:207], v[224:227], 0
    v_mul_f32 v252, v252, v33
    v_mul_f32 v253, v253, v33
    v_mul_f32 v254, v254, v33
    v_mfma_f32_16x16x32_bf16 v[108:111], v[204:207], v[228:231], 0
    v_mul_f32 v255, v255, v33
    v_cvt_pk_bf16_f32 v236, v248, v249
    v_mfma_f32_16x16x32_bf16 v[112:115], v[208:211], v[216:219], 0
    ds_read_b64_tr_b16 v[200:201], v8 offset:256
    v_cvt_pk_bf16_f32 v237, v250, v251
    v_cvt_pk_bf16_f32 v238, v252, v253
    v_cvt_pk_bf16_f32 v239, v254, v255
    v_mfma_f32_16x16x32_bf16 v[116:119], v[208:211], v[220:223], 0
    ds_read_b64_tr_b16 v[202:203], v8 offset:4864
    s_waitcnt lgkmcnt(6)
    buffer_store_dwordx4 v[236:239], v11, s[16:19], s83 offen offset:1024 sc1
    v_accvgpr_read_b32 v248, a40
    v_mfma_f32_16x16x32_bf16 v[120:123], v[208:211], v[224:227], 0
    v_accvgpr_read_b32 v249, a41
    v_accvgpr_read_b32 v250, a42
    v_mfma_f32_16x16x32_bf16 v[124:127], v[208:211], v[228:231], 0
    v_accvgpr_read_b32 v251, a43
    v_accvgpr_read_b32 v252, a56
    v_accvgpr_read_b32 v253, a57
    v_mfma_f32_16x16x32_bf16 v[128:131], v[212:215], v[216:219], 0
    ds_read_b64_tr_b16 v[204:205], v8 offset:9216
    v_accvgpr_read_b32 v254, a58
    v_accvgpr_read_b32 v255, a59
    v_mul_f32 v248, v248, v34
    v_mfma_f32_16x16x32_bf16 v[132:135], v[212:215], v[220:223], 0
    ds_read_b64_tr_b16 v[206:207], v8 offset:13824
    s_waitcnt lgkmcnt(6)
    v_mul_f32 v249, v249, v34
    v_mfma_f32_16x16x32_bf16 v[136:139], v[212:215], v[224:227], 0
    v_mul_f32 v250, v250, v34
    v_mul_f32 v251, v251, v34
    v_mul_f32 v252, v252, v34
    v_mfma_f32_16x16x32_bf16 v[140:143], v[212:215], v[228:231], 0
    v_mul_f32 v253, v253, v34
    v_mul_f32 v254, v254, v34
    v_mfma_f32_16x16x32_bf16 v[144:147], v[192:195], v[216:219], 0
    ds_read_b64_tr_b16 v[208:209], v8 offset:9248
    v_mul_f32 v255, v255, v34
    v_cvt_pk_bf16_f32 v240, v248, v249
    v_cvt_pk_bf16_f32 v241, v250, v251
    v_mfma_f32_16x16x32_bf16 v[148:151], v[192:195], v[220:223], 0
    ds_read_b64_tr_b16 v[210:211], v8 offset:13856
    s_waitcnt lgkmcnt(6)
    v_cvt_pk_bf16_f32 v242, v252, v253
    v_cvt_pk_bf16_f32 v243, v254, v255
    v_mfma_f32_16x16x32_bf16 v[152:155], v[192:195], v[224:227], 0
    buffer_store_dwordx4 v[240:243], v12, s[16:19], s83 offen offset:1024 sc1
    v_accvgpr_read_b32 v248, a44
    v_mfma_f32_16x16x32_bf16 v[156:159], v[192:195], v[228:231], 0
    v_accvgpr_read_b32 v249, a45
    v_accvgpr_read_b32 v250, a46
    v_accvgpr_read_b32 v251, a47
    v_mfma_f32_16x16x32_bf16 v[160:163], v[196:199], v[216:219], 0
    ds_read_b64_tr_b16 v[212:213], v8 offset:9280
    v_accvgpr_read_b32 v252, a60
    v_accvgpr_read_b32 v253, a61
    v_accvgpr_read_b32 v254, a62
    v_mfma_f32_16x16x32_bf16 v[164:167], v[196:199], v[220:223], 0
    ds_read_b64_tr_b16 v[214:215], v8 offset:13888
    s_waitcnt lgkmcnt(6)
    v_accvgpr_read_b32 v255, a63
    v_mul_f32 v248, v248, v35
    v_mfma_f32_16x16x32_bf16 v[168:171], v[196:199], v[224:227], 0
    v_mul_f32 v249, v249, v35
    v_mul_f32 v250, v250, v35
    v_mfma_f32_16x16x32_bf16 v[172:175], v[196:199], v[228:231], 0
    v_mul_f32 v251, v251, v35
    v_mul_f32 v252, v252, v35
    v_mfma_f32_16x16x32_bf16 v[176:179], v[200:203], v[216:219], 0
    ds_read_b64_tr_b16 v[192:193], v8 offset:9312
    v_mul_f32 v253, v253, v35
    v_mul_f32 v254, v254, v35
    v_mul_f32 v255, v255, v35
    v_cvt_pk_bf16_f32 v244, v248, v249
    v_mfma_f32_16x16x32_bf16 v[180:183], v[200:203], v[220:223], 0
    ds_read_b64_tr_b16 v[194:195], v8 offset:13920
    s_waitcnt lgkmcnt(6)
    v_cvt_pk_bf16_f32 v245, v250, v251
    v_mfma_f32_16x16x32_bf16 v[184:187], v[200:203], v[224:227], 0
    v_cvt_pk_bf16_f32 v246, v252, v253
    v_cvt_pk_bf16_f32 v247, v254, v255
    buffer_store_dwordx4 v[244:247], v13, s[16:19], s83 offen offset:1024 sc1
    v_mfma_f32_16x16x32_bf16 v[188:191], v[200:203], v[228:231], 0
    v_mfma_f32_16x16x32_bf16 v[48:51], v[204:207], v[232:235], v[48:51]
    ds_read_b64_tr_b16 v[196:197], v8 offset:9344
    v_accvgpr_read_b32 v248, a64
    v_accvgpr_read_b32 v249, a65
    v_accvgpr_read_b32 v250, a66
    v_mfma_f32_16x16x32_bf16 v[52:55], v[204:207], v[236:239], v[52:55]
    ds_read_b64_tr_b16 v[198:199], v8 offset:13952
    s_waitcnt lgkmcnt(6)
    v_accvgpr_read_b32 v251, a67
    v_mfma_f32_16x16x32_bf16 v[56:59], v[204:207], v[240:243], v[56:59]
    v_accvgpr_read_b32 v252, a80
    v_accvgpr_read_b32 v253, a81
    v_accvgpr_read_b32 v254, a82
    v_mfma_f32_16x16x32_bf16 v[60:63], v[204:207], v[244:247], v[60:63]
    v_accvgpr_read_b32 v255, a83
    v_mul_f32 v248, v248, v32
    v_mfma_f32_16x16x32_bf16 v[64:67], v[208:211], v[232:235], v[64:67]
    ds_read_b64_tr_b16 v[200:201], v8 offset:9376
    v_mul_f32 v249, v249, v32
    v_mul_f32 v250, v250, v32
    v_mul_f32 v251, v251, v32
    v_mfma_f32_16x16x32_bf16 v[68:71], v[208:211], v[236:239], v[68:71]
    ds_read_b64_tr_b16 v[202:203], v8 offset:13984
    s_waitcnt lgkmcnt(6)
    v_mul_f32 v252, v252, v32
    v_mul_f32 v253, v253, v32
    v_mfma_f32_16x16x32_bf16 v[72:75], v[208:211], v[240:243], v[72:75]
    v_mul_f32 v254, v254, v32
    v_mul_f32 v255, v255, v32
    v_mfma_f32_16x16x32_bf16 v[76:79], v[208:211], v[244:247], v[76:79]
    v_cvt_pk_bf16_f32 v216, v248, v249
    v_cvt_pk_bf16_f32 v217, v250, v251
    v_cvt_pk_bf16_f32 v218, v252, v253
    v_mfma_f32_16x16x32_bf16 v[80:83], v[212:215], v[232:235], v[80:83]
    ds_read_b64_tr_b16 v[204:205], v8 offset:9408
    v_cvt_pk_bf16_f32 v219, v254, v255
    buffer_store_dwordx4 v[216:219], v10, s[16:19], s83 offen offset:2048 sc1
    v_accvgpr_read_b32 v248, a68
    v_mfma_f32_16x16x32_bf16 v[84:87], v[212:215], v[236:239], v[84:87]
    ds_read_b64_tr_b16 v[206:207], v8 offset:14016
    s_waitcnt lgkmcnt(6)
    v_accvgpr_read_b32 v249, a69
    v_accvgpr_read_b32 v250, a70
    v_mfma_f32_16x16x32_bf16 v[88:91], v[212:215], v[240:243], v[88:91]
    v_accvgpr_read_b32 v251, a71
    v_accvgpr_read_b32 v252, a84
    v_mfma_f32_16x16x32_bf16 v[92:95], v[212:215], v[244:247], v[92:95]
    v_accvgpr_read_b32 v253, a85
    v_accvgpr_read_b32 v254, a86
    v_mfma_f32_16x16x32_bf16 v[96:99], v[192:195], v[232:235], v[96:99]
    ds_read_b64_tr_b16 v[208:209], v8 offset:9440
    v_accvgpr_read_b32 v255, a87
    v_mul_f32 v248, v248, v33
    v_mul_f32 v249, v249, v33
    v_mul_f32 v250, v250, v33
    v_mfma_f32_16x16x32_bf16 v[100:103], v[192:195], v[236:239], v[100:103]
    ds_read_b64_tr_b16 v[210:211], v8 offset:14048
    s_waitcnt lgkmcnt(6)
    v_mul_f32 v251, v251, v33
    v_mfma_f32_16x16x32_bf16 v[104:107], v[192:195], v[240:243], v[104:107]
    v_mul_f32 v252, v252, v33
    v_mul_f32 v253, v253, v33
    v_mul_f32 v254, v254, v33
    v_mfma_f32_16x16x32_bf16 v[108:111], v[192:195], v[244:247], v[108:111]
    v_mul_f32 v255, v255, v33
    v_cvt_pk_bf16_f32 v220, v248, v249
    v_mfma_f32_16x16x32_bf16 v[112:115], v[196:199], v[232:235], v[112:115]
    ds_read_b64_tr_b16 v[212:213], v8 offset:9472
    v_cvt_pk_bf16_f32 v221, v250, v251
    v_cvt_pk_bf16_f32 v222, v252, v253
    v_cvt_pk_bf16_f32 v223, v254, v255
    v_mfma_f32_16x16x32_bf16 v[116:119], v[196:199], v[236:239], v[116:119]
    ds_read_b64_tr_b16 v[214:215], v8 offset:14080
    s_waitcnt lgkmcnt(6)
    buffer_store_dwordx4 v[220:223], v11, s[16:19], s83 offen offset:2048 sc1
    v_accvgpr_read_b32 v248, a72
    v_mfma_f32_16x16x32_bf16 v[120:123], v[196:199], v[240:243], v[120:123]
    v_accvgpr_read_b32 v249, a73
    v_accvgpr_read_b32 v250, a74
    v_mfma_f32_16x16x32_bf16 v[124:127], v[196:199], v[244:247], v[124:127]
    v_accvgpr_read_b32 v251, a75
    v_accvgpr_read_b32 v252, a88
    v_accvgpr_read_b32 v253, a89
    v_mfma_f32_16x16x32_bf16 v[128:131], v[200:203], v[232:235], v[128:131]
    ds_read_b64_tr_b16 v[192:193], v8 offset:18432
    v_accvgpr_read_b32 v254, a90
    v_accvgpr_read_b32 v255, a91
    v_mul_f32 v248, v248, v34
    v_mfma_f32_16x16x32_bf16 v[132:135], v[200:203], v[236:239], v[132:135]
    ds_read_b64_tr_b16 v[194:195], v8 offset:23040
    s_waitcnt lgkmcnt(6)
    v_mul_f32 v249, v249, v34
    v_mfma_f32_16x16x32_bf16 v[136:139], v[200:203], v[240:243], v[136:139]
    v_mul_f32 v250, v250, v34
    v_mul_f32 v251, v251, v34
    v_mul_f32 v252, v252, v34
    v_mfma_f32_16x16x32_bf16 v[140:143], v[200:203], v[244:247], v[140:143]
    v_mul_f32 v253, v253, v34
    v_mul_f32 v254, v254, v34
    v_mfma_f32_16x16x32_bf16 v[144:147], v[204:207], v[232:235], v[144:147]
    ds_read_b64_tr_b16 v[196:197], v8 offset:18464
    v_mul_f32 v255, v255, v34
    v_cvt_pk_bf16_f32 v224, v248, v249
    v_cvt_pk_bf16_f32 v225, v250, v251
    v_mfma_f32_16x16x32_bf16 v[148:151], v[204:207], v[236:239], v[148:151]
    ds_read_b64_tr_b16 v[198:199], v8 offset:23072
    s_waitcnt lgkmcnt(6)
    v_cvt_pk_bf16_f32 v226, v252, v253
    v_cvt_pk_bf16_f32 v227, v254, v255
    v_mfma_f32_16x16x32_bf16 v[152:155], v[204:207], v[240:243], v[152:155]
    buffer_store_dwordx4 v[224:227], v12, s[16:19], s83 offen offset:2048 sc1
    v_accvgpr_read_b32 v248, a76
    v_mfma_f32_16x16x32_bf16 v[156:159], v[204:207], v[244:247], v[156:159]
    v_accvgpr_read_b32 v249, a77
    v_accvgpr_read_b32 v250, a78
    v_accvgpr_read_b32 v251, a79
    v_mfma_f32_16x16x32_bf16 v[160:163], v[208:211], v[232:235], v[160:163]
    ds_read_b64_tr_b16 v[200:201], v8 offset:18496
    v_accvgpr_read_b32 v252, a92
    v_accvgpr_read_b32 v253, a93
    v_accvgpr_read_b32 v254, a94
    v_mfma_f32_16x16x32_bf16 v[164:167], v[208:211], v[236:239], v[164:167]
    ds_read_b64_tr_b16 v[202:203], v8 offset:23104
    s_waitcnt lgkmcnt(6)
    v_accvgpr_read_b32 v255, a95
    v_mul_f32 v248, v248, v35
    v_mfma_f32_16x16x32_bf16 v[168:171], v[208:211], v[240:243], v[168:171]
    v_mul_f32 v249, v249, v35
    v_mul_f32 v250, v250, v35
    v_mfma_f32_16x16x32_bf16 v[172:175], v[208:211], v[244:247], v[172:175]
    v_mul_f32 v251, v251, v35
    v_mul_f32 v252, v252, v35
    v_mfma_f32_16x16x32_bf16 v[176:179], v[212:215], v[232:235], v[176:179]
    ds_read_b64_tr_b16 v[204:205], v8 offset:18528
    v_mul_f32 v253, v253, v35
    v_mul_f32 v254, v254, v35
    v_mul_f32 v255, v255, v35
    v_cvt_pk_bf16_f32 v228, v248, v249
    v_mfma_f32_16x16x32_bf16 v[180:183], v[212:215], v[236:239], v[180:183]
    ds_read_b64_tr_b16 v[206:207], v8 offset:23136
    s_waitcnt lgkmcnt(6)
    v_cvt_pk_bf16_f32 v229, v250, v251
    v_mfma_f32_16x16x32_bf16 v[184:187], v[212:215], v[240:243], v[184:187]
    v_cvt_pk_bf16_f32 v230, v252, v253
    v_cvt_pk_bf16_f32 v231, v254, v255
    buffer_store_dwordx4 v[228:231], v13, s[16:19], s83 offen offset:2048 sc1
    v_mfma_f32_16x16x32_bf16 v[188:191], v[212:215], v[244:247], v[188:191]
    v_mfma_f32_16x16x32_bf16 v[48:51], v[192:195], v[216:219], v[48:51]
    ds_read_b64_tr_b16 v[208:209], v8 offset:18560
    v_accvgpr_read_b32 v248, a96
    v_accvgpr_read_b32 v249, a97
    v_accvgpr_read_b32 v250, a98
    v_mfma_f32_16x16x32_bf16 v[52:55], v[192:195], v[220:223], v[52:55]
    ds_read_b64_tr_b16 v[210:211], v8 offset:23168
    s_waitcnt lgkmcnt(6)
    v_accvgpr_read_b32 v251, a99
    v_mfma_f32_16x16x32_bf16 v[56:59], v[192:195], v[224:227], v[56:59]
    v_accvgpr_read_b32 v252, a112
    v_accvgpr_read_b32 v253, a113
    v_accvgpr_read_b32 v254, a114
    v_mfma_f32_16x16x32_bf16 v[60:63], v[192:195], v[228:231], v[60:63]
    v_accvgpr_read_b32 v255, a115
    v_mul_f32 v248, v248, v32
    v_mfma_f32_16x16x32_bf16 v[64:67], v[196:199], v[216:219], v[64:67]
    ds_read_b64_tr_b16 v[212:213], v8 offset:18592
    v_mul_f32 v249, v249, v32
    v_mul_f32 v250, v250, v32
    v_mul_f32 v251, v251, v32
    v_mfma_f32_16x16x32_bf16 v[68:71], v[196:199], v[220:223], v[68:71]
    ds_read_b64_tr_b16 v[214:215], v8 offset:23200
    s_waitcnt lgkmcnt(6)
    v_mul_f32 v252, v252, v32
    v_mul_f32 v253, v253, v32
    v_mfma_f32_16x16x32_bf16 v[72:75], v[196:199], v[224:227], v[72:75]
    v_mul_f32 v254, v254, v32
    v_mul_f32 v255, v255, v32
    v_mfma_f32_16x16x32_bf16 v[76:79], v[196:199], v[228:231], v[76:79]
    v_cvt_pk_bf16_f32 v232, v248, v249
    v_cvt_pk_bf16_f32 v233, v250, v251
    v_cvt_pk_bf16_f32 v234, v252, v253
    v_mfma_f32_16x16x32_bf16 v[80:83], v[200:203], v[216:219], v[80:83]
    ds_read_b64_tr_b16 v[192:193], v8 offset:18624
    v_cvt_pk_bf16_f32 v235, v254, v255
    buffer_store_dwordx4 v[232:235], v10, s[16:19], s83 offen offset:3072 sc1
    v_accvgpr_read_b32 v248, a100
    v_mfma_f32_16x16x32_bf16 v[84:87], v[200:203], v[220:223], v[84:87]
    ds_read_b64_tr_b16 v[194:195], v8 offset:23232
    s_waitcnt lgkmcnt(6)
    v_accvgpr_read_b32 v249, a101
    v_accvgpr_read_b32 v250, a102
    v_mfma_f32_16x16x32_bf16 v[88:91], v[200:203], v[224:227], v[88:91]
    v_accvgpr_read_b32 v251, a103
    v_accvgpr_read_b32 v252, a116
    v_mfma_f32_16x16x32_bf16 v[92:95], v[200:203], v[228:231], v[92:95]
    v_accvgpr_read_b32 v253, a117
    v_accvgpr_read_b32 v254, a118
    v_mfma_f32_16x16x32_bf16 v[96:99], v[204:207], v[216:219], v[96:99]
    ds_read_b64_tr_b16 v[196:197], v8 offset:18656
    v_accvgpr_read_b32 v255, a119
    v_mul_f32 v248, v248, v33
    v_mul_f32 v249, v249, v33
    v_mul_f32 v250, v250, v33
    v_mfma_f32_16x16x32_bf16 v[100:103], v[204:207], v[220:223], v[100:103]
    ds_read_b64_tr_b16 v[198:199], v8 offset:23264
    s_waitcnt lgkmcnt(6)
    v_mul_f32 v251, v251, v33
    v_mfma_f32_16x16x32_bf16 v[104:107], v[204:207], v[224:227], v[104:107]
    v_mul_f32 v252, v252, v33
    v_mul_f32 v253, v253, v33
    v_mul_f32 v254, v254, v33
    v_mfma_f32_16x16x32_bf16 v[108:111], v[204:207], v[228:231], v[108:111]
    v_mul_f32 v255, v255, v33
    v_cvt_pk_bf16_f32 v236, v248, v249
    v_mfma_f32_16x16x32_bf16 v[112:115], v[208:211], v[216:219], v[112:115]
    ds_read_b64_tr_b16 v[200:201], v8 offset:18688
    v_cvt_pk_bf16_f32 v237, v250, v251
    v_cvt_pk_bf16_f32 v238, v252, v253
    v_cvt_pk_bf16_f32 v239, v254, v255
    v_mfma_f32_16x16x32_bf16 v[116:119], v[208:211], v[220:223], v[116:119]
    ds_read_b64_tr_b16 v[202:203], v8 offset:23296
    s_waitcnt lgkmcnt(6)
    buffer_store_dwordx4 v[236:239], v11, s[16:19], s83 offen offset:3072 sc1
    v_accvgpr_read_b32 v248, a104
    v_mfma_f32_16x16x32_bf16 v[120:123], v[208:211], v[224:227], v[120:123]
    v_accvgpr_read_b32 v249, a105
    v_accvgpr_read_b32 v250, a106
    v_mfma_f32_16x16x32_bf16 v[124:127], v[208:211], v[228:231], v[124:127]
    v_accvgpr_read_b32 v251, a107
    v_accvgpr_read_b32 v252, a120
    v_accvgpr_read_b32 v253, a121
    v_mfma_f32_16x16x32_bf16 v[128:131], v[212:215], v[216:219], v[128:131]
    ds_read_b64_tr_b16 v[204:205], v8 offset:27648
    v_accvgpr_read_b32 v254, a122
    v_accvgpr_read_b32 v255, a123
    v_mul_f32 v248, v248, v34
    v_mfma_f32_16x16x32_bf16 v[132:135], v[212:215], v[220:223], v[132:135]
    ds_read_b64_tr_b16 v[206:207], v8 offset:32256
    s_waitcnt lgkmcnt(6)
    v_mul_f32 v249, v249, v34
    v_mfma_f32_16x16x32_bf16 v[136:139], v[212:215], v[224:227], v[136:139]
    v_mul_f32 v250, v250, v34
    v_mul_f32 v251, v251, v34
    v_mul_f32 v252, v252, v34
    v_mfma_f32_16x16x32_bf16 v[140:143], v[212:215], v[228:231], v[140:143]
    v_mul_f32 v253, v253, v34
    v_mul_f32 v254, v254, v34
    v_mfma_f32_16x16x32_bf16 v[144:147], v[192:195], v[216:219], v[144:147]
    ds_read_b64_tr_b16 v[208:209], v8 offset:27680
    v_mul_f32 v255, v255, v34
    v_cvt_pk_bf16_f32 v240, v248, v249
    v_cvt_pk_bf16_f32 v241, v250, v251
    v_mfma_f32_16x16x32_bf16 v[148:151], v[192:195], v[220:223], v[148:151]
    ds_read_b64_tr_b16 v[210:211], v8 offset:32288
    s_waitcnt lgkmcnt(6)
    v_cvt_pk_bf16_f32 v242, v252, v253
    v_cvt_pk_bf16_f32 v243, v254, v255
    v_mfma_f32_16x16x32_bf16 v[152:155], v[192:195], v[224:227], v[152:155]
    buffer_store_dwordx4 v[240:243], v12, s[16:19], s83 offen offset:3072 sc1
    v_accvgpr_read_b32 v248, a108
    v_mfma_f32_16x16x32_bf16 v[156:159], v[192:195], v[228:231], v[156:159]
    v_accvgpr_read_b32 v249, a109
    v_accvgpr_read_b32 v250, a110
    v_accvgpr_read_b32 v251, a111
    v_mfma_f32_16x16x32_bf16 v[160:163], v[196:199], v[216:219], v[160:163]
    ds_read_b64_tr_b16 v[212:213], v8 offset:27712
    v_accvgpr_read_b32 v252, a124
    v_accvgpr_read_b32 v253, a125
    v_accvgpr_read_b32 v254, a126
    v_mfma_f32_16x16x32_bf16 v[164:167], v[196:199], v[220:223], v[164:167]
    ds_read_b64_tr_b16 v[214:215], v8 offset:32320
    s_waitcnt lgkmcnt(6)
    v_accvgpr_read_b32 v255, a127
    v_mul_f32 v248, v248, v35
    v_mfma_f32_16x16x32_bf16 v[168:171], v[196:199], v[224:227], v[168:171]
    v_mul_f32 v249, v249, v35
    v_mul_f32 v250, v250, v35
    v_mfma_f32_16x16x32_bf16 v[172:175], v[196:199], v[228:231], v[172:175]
    v_mul_f32 v251, v251, v35
    v_mul_f32 v252, v252, v35
    v_mfma_f32_16x16x32_bf16 v[176:179], v[200:203], v[216:219], v[176:179]
    ds_read_b64_tr_b16 v[192:193], v8 offset:27744
    v_mul_f32 v253, v253, v35
    v_mul_f32 v254, v254, v35
    v_mul_f32 v255, v255, v35
    v_cvt_pk_bf16_f32 v244, v248, v249
    v_mfma_f32_16x16x32_bf16 v[180:183], v[200:203], v[220:223], v[180:183]
    ds_read_b64_tr_b16 v[194:195], v8 offset:32352
    s_waitcnt lgkmcnt(6)
    v_cvt_pk_bf16_f32 v245, v250, v251
    v_mfma_f32_16x16x32_bf16 v[184:187], v[200:203], v[224:227], v[184:187]
    v_cvt_pk_bf16_f32 v246, v252, v253
    v_cvt_pk_bf16_f32 v247, v254, v255
    buffer_store_dwordx4 v[244:247], v13, s[16:19], s83 offen offset:3072 sc1
    v_mfma_f32_16x16x32_bf16 v[188:191], v[200:203], v[228:231], v[188:191]
    v_mfma_f32_16x16x32_bf16 v[48:51], v[204:207], v[232:235], v[48:51]
    ds_read_b64_tr_b16 v[196:197], v8 offset:27776
    s_xor_b32 s92, s88, s85
    v_mfma_f32_16x16x32_bf16 v[52:55], v[204:207], v[236:239], v[52:55]
    ds_read_b64_tr_b16 v[198:199], v8 offset:32384
    s_waitcnt lgkmcnt(6)
    v_mfma_f32_16x16x32_bf16 v[56:59], v[204:207], v[240:243], v[56:59]
    s_mul_i32 s92, s92, s97
    v_mfma_f32_16x16x32_bf16 v[60:63], v[204:207], v[244:247], v[60:63]
    s_add_u32 s92, s92, s93
    v_mfma_f32_16x16x32_bf16 v[64:67], v[208:211], v[232:235], v[64:67]
    ds_read_b64_tr_b16 v[200:201], v8 offset:27808
    v_mfma_f32_16x16x32_bf16 v[68:71], v[208:211], v[236:239], v[68:71]
    ds_read_b64_tr_b16 v[202:203], v8 offset:32416
    s_waitcnt lgkmcnt(6)
    v_mfma_f32_16x16x32_bf16 v[72:75], v[208:211], v[240:243], v[72:75]
    s_add_u32 m0, s94, 0
    v_mfma_f32_16x16x32_bf16 v[76:79], v[208:211], v[244:247], v[76:79]
    buffer_load_dwordx4 v16, s[20:23], s92 offen offset:0 sc1 lds
    v_mfma_f32_16x16x32_bf16 v[80:83], v[212:215], v[232:235], v[80:83]
    ds_read_b64_tr_b16 v[204:205], v8 offset:27840
    v_mfma_f32_16x16x32_bf16 v[84:87], v[212:215], v[236:239], v[84:87]
    ds_read_b64_tr_b16 v[206:207], v8 offset:32448
    s_waitcnt lgkmcnt(6)
    v_mfma_f32_16x16x32_bf16 v[88:91], v[212:215], v[240:243], v[88:91]
    buffer_load_dwordx4 v17, s[20:23], s92 offen offset:1024 sc1 lds
    v_mfma_f32_16x16x32_bf16 v[92:95], v[212:215], v[244:247], v[92:95]
    buffer_load_dwordx4 v18, s[20:23], s92 offen offset:2048 sc1 lds
    v_mfma_f32_16x16x32_bf16 v[96:99], v[192:195], v[232:235], v[96:99]
    ds_read_b64_tr_b16 v[208:209], v8 offset:27872
    v_mfma_f32_16x16x32_bf16 v[100:103], v[192:195], v[236:239], v[100:103]
    ds_read_b64_tr_b16 v[210:211], v8 offset:32480
    s_waitcnt lgkmcnt(6)
    v_mfma_f32_16x16x32_bf16 v[104:107], v[192:195], v[240:243], v[104:107]
    buffer_load_dwordx4 v19, s[20:23], s92 offen offset:3072 sc1 lds
    v_mfma_f32_16x16x32_bf16 v[108:111], v[192:195], v[244:247], v[108:111]
    s_add_u32 m0, s94, 4096
    v_mfma_f32_16x16x32_bf16 v[112:115], v[196:199], v[232:235], v[112:115]
    ds_read_b64_tr_b16 v[212:213], v8 offset:27904
    v_mfma_f32_16x16x32_bf16 v[116:119], v[196:199], v[236:239], v[116:119]
    ds_read_b64_tr_b16 v[214:215], v8 offset:32512
    s_waitcnt lgkmcnt(6)
    v_mfma_f32_16x16x32_bf16 v[120:123], v[196:199], v[240:243], v[120:123]
    buffer_load_dwordx4 v20, s[20:23], s92 offen offset:0 sc1 lds
    v_mfma_f32_16x16x32_bf16 v[124:127], v[196:199], v[244:247], v[124:127]
    v_add_u32 v8, s96, v5
    v_mfma_f32_16x16x32_bf16 v[128:131], v[200:203], v[232:235], v[128:131]
    buffer_load_dwordx4 v21, s[20:23], s92 offen offset:1024 sc1 lds
    v_mfma_f32_16x16x32_bf16 v[132:135], v[200:203], v[236:239], v[132:135]
    s_waitcnt lgkmcnt(4)
    v_mfma_f32_16x16x32_bf16 v[136:139], v[200:203], v[240:243], v[136:139]
    buffer_load_dwordx4 v22, s[20:23], s92 offen offset:2048 sc1 lds
    v_mfma_f32_16x16x32_bf16 v[140:143], v[200:203], v[244:247], v[140:143]
    buffer_load_dwordx4 v23, s[20:23], s92 offen offset:3072 sc1 lds
    v_mfma_f32_16x16x32_bf16 v[144:147], v[204:207], v[232:235], v[144:147]
    v_mfma_f32_16x16x32_bf16 v[148:151], v[204:207], v[236:239], v[148:151]
    s_waitcnt lgkmcnt(2)
    s_add_u32 m0, s94, 8192
    v_mfma_f32_16x16x32_bf16 v[152:155], v[204:207], v[240:243], v[152:155]
    v_mfma_f32_16x16x32_bf16 v[156:159], v[204:207], v[244:247], v[156:159]
    buffer_load_dwordx4 v24, s[20:23], s92 offen offset:0 sc1 lds
    v_mfma_f32_16x16x32_bf16 v[160:163], v[208:211], v[232:235], v[160:163]
    v_mfma_f32_16x16x32_bf16 v[164:167], v[208:211], v[236:239], v[164:167]
    s_waitcnt lgkmcnt(0)
    s_add_u32 s88, s88, 1
    v_mfma_f32_16x16x32_bf16 v[168:171], v[208:211], v[240:243], v[168:171]
    v_mfma_f32_16x16x32_bf16 v[172:175], v[208:211], v[244:247], v[172:175]
    s_add_u32 s94, s94, 36864
    v_mfma_f32_16x16x32_bf16 v[176:179], v[212:215], v[232:235], v[176:179]
    v_mfma_f32_16x16x32_bf16 v[180:183], v[212:215], v[236:239], v[180:183]
    s_cmp_ge_u32 s94, 147456
    s_cselect_b32 s94, s81, s94
    v_mfma_f32_16x16x32_bf16 v[184:187], v[212:215], v[240:243], v[184:187]
    v_mfma_f32_16x16x32_bf16 v[188:191], v[212:215], v[244:247], v[188:191]
    s_waitcnt vmcnt(9)
    s_mov_b64 exec, 0xf
    buffer_store_dword v7, v14, s[16:19], s90 offen sc1
    s_mov_b64 exec, -1
    s_mov_b32 s30, s18
    s_xor_b32 s79, s87, s85
    s_lshl_b32 s79, s79, 12
    s_add_u32 s79, s79, s80
    s_add_u32 s87, s87, 1
    s_mov_b32 s73, 0
KF_sp16:
    buffer_load_dword v40, v9, s[16:19], s84 offen sc1
    s_waitcnt vmcnt(0)
    v_cmp_ne_u32 vcc, v40, v7
    s_add_u32 s73, s73, 1
    s_cmp_ge_u32 s73, 100000
    s_cbranch_scc1 KF_sd17
    s_cbranch_vccz KF_sd17
    s_sleep 2
    s_branch KF_sp16
KF_sd17:
    buffer_load_dwordx4 a[128:131], v10, s[28:31], s79 offen offset:0 sc1
    buffer_load_dwordx4 a[132:135], v11, s[28:31], s79 offen offset:0 sc1
    buffer_load_dwordx4 a[136:139], v12, s[28:31], s79 offen offset:0 sc1
    buffer_load_dwordx4 a[140:143], v13, s[28:31], s79 offen offset:0 sc1
    buffer_load_dwordx4 a[144:147], v10, s[28:31], s79 offen offset:1024 sc1
    buffer_load_dwordx4 a[148:151], v11, s[28:31], s79 offen offset:1024 sc1
    buffer_load_dwordx4 a[152:155], v12, s[28:31], s79 offen offset:1024 sc1
    buffer_load_dwordx4 a[156:159], v13, s[28:31], s79 offen offset:1024 sc1
    buffer_load_dwordx4 a[160:163], v10, s[28:31], s79 offen offset:2048 sc1
    buffer_load_dwordx4 a[164:167], v11, s[28:31], s79 offen offset:2048 sc1
    buffer_load_dwordx4 a[168:171], v12, s[28:31], s79 offen offset:2048 sc1
    buffer_load_dwordx4 a[172:175], v13, s[28:31], s79 offen offset:2048 sc1
    buffer_load_dwordx4 a[176:179], v10, s[28:31], s79 offen offset:3072 sc1
    buffer_load_dwordx4 a[180:183], v11, s[28:31], s79 offen offset:3072 sc1
    buffer_load_dwordx4 a[184:187], v12, s[28:31], s79 offen offset:3072 sc1
    buffer_load_dwordx4 a[188:191], v13, s[28:31], s79 offen offset:3072 sc1
    s_xor_b32 s79, s87, s85
    s_lshl_b32 s79, s79, 12
    s_add_u32 s79, s79, s80
    s_add_u32 s87, s87, 1
    buffer_load_dwordx4 a[192:195], v10, s[28:31], s79 offen offset:0 sc1
    buffer_load_dwordx4 a[196:199], v11, s[28:31], s79 offen offset:0 sc1
    buffer_load_dwordx4 a[200:203], v12, s[28:31], s79 offen offset:0 sc1
    buffer_load_dwordx4 a[204:207], v13, s[28:31], s79 offen offset:0 sc1
    buffer_load_dwordx4 a[208:211], v10, s[28:31], s79 offen offset:1024 sc1
    buffer_load_dwordx4 a[212:215], v11, s[28:31], s79 offen offset:1024 sc1
    buffer_load_dwordx4 a[216:219], v12, s[28:31], s79 offen offset:1024 sc1
    buffer_load_dwordx4 a[220:223], v13, s[28:31], s79 offen offset:1024 sc1
    ds_read_b64_tr_b16 v[192:193], v8 offset:0
    ds_read_b64_tr_b16 v[194:195], v8 offset:4608
    ds_read_b64_tr_b16 v[196:197], v8 offset:9216
    ds_read_b64_tr_b16 v[198:199], v8 offset:13824
    ds_read_b64_tr_b16 v[200:201], v8 offset:32
    ds_read_b64_tr_b16 v[202:203], v8 offset:4640
    ds_read_b64_tr_b16 v[204:205], v8 offset:9248
    ds_read_b64_tr_b16 v[206:207], v8 offset:13856
    s_waitcnt vmcnt(16)
    s_mov_b32 s4, 0
.p2align 3
KF_loop2:
    s_waitcnt lgkmcnt(6)
    v_mfma_f32_16x16x32_bf16 v[48:51], v[192:195], a[128:131], v[48:51]
    ds_read_b64_tr_b16 v[208:209], v8 offset:64
    s_waitcnt lgkmcnt(5)
    v_mfma_f32_16x16x32_bf16 v[48:51], v[196:199], a[144:147], v[48:51]
    ds_read_b64_tr_b16 v[210:211], v8 offset:4672
    v_mfma_f32_16x16x32_bf16 v[52:55], v[196:199], a[148:151], v[52:55]
    buffer_load_dwordx4 a[224:227], v10, s[28:31], s79 offen offset:2048 sc1
    v_mfma_f32_16x16x32_bf16 v[52:55], v[192:195], a[132:135], v[52:55]
    v_mfma_f32_16x16x32_bf16 v[56:59], v[192:195], a[136:139], v[56:59]
    ds_read_b64_tr_b16 v[212:213], v8 offset:9280
    v_mfma_f32_16x16x32_bf16 v[56:59], v[196:199], a[152:155], v[56:59]
    ds_read_b64_tr_b16 v[214:215], v8 offset:13888
    s_waitcnt lgkmcnt(4)
    v_mfma_f32_16x16x32_bf16 v[60:63], v[196:199], a[156:159], v[60:63]
    s_barrier
    v_mfma_f32_16x16x32_bf16 v[60:63], v[192:195], a[140:143], v[60:63]
    s_add_u32 s96, s96, 36864
    s_cmp_eq_u32 s96, 147456
    s_cselect_b32 s96, 0, s96
    v_mfma_f32_16x16x32_bf16 v[64:67], v[200:203], a[128:131], v[64:67]
    ds_read_b64_tr_b16 v[192:193], v8 offset:96
    v_mfma_f32_16x16x32_bf16 v[64:67], v[204:207], a[144:147], v[64:67]
    ds_read_b64_tr_b16 v[194:195], v8 offset:4704
    v_mfma_f32_16x16x32_bf16 v[68:71], v[204:207], a[148:151], v[68:71]
    buffer_load_dwordx4 a[228:231], v11, s[28:31], s79 offen offset:2048 sc1
    v_mfma_f32_16x16x32_bf16 v[68:71], v[200:203], a[132:135], v[68:71]
    v_mfma_f32_16x16x32_bf16 v[72:75], v[200:203], a[136:139], v[72:75]
    ds_read_b64_tr_b16 v[196:197], v8 offset:9312
    s_xor_b32 s92, s88, s85
    v_mfma_f32_16x16x32_bf16 v[72:75], v[204:207], a[152:155], v[72:75]
    ds_read_b64_tr_b16 v[198:199], v8 offset:13920
    s_waitcnt lgkmcnt(4)
    v_mfma_f32_16x16x32_bf16 v[76:79], v[204:207], a[156:159], v[76:79]
    buffer_load_dwordx4 a[232:235], v12, s[28:31], s79 offen offset:2048 sc1
    v_mfma_f32_16x16x32_bf16 v[76:79], v[200:203], a[140:143], v[76:79]
    v_mfma_f32_16x16x32_bf16 v[80:83], v[208:211], a[128:131], v[80:83]
    ds_read_b64_tr_b16 v[200:201], v8 offset:128
    v_mfma_f32_16x16x32_bf16 v[80:83], v[212:215], a[144:147], v[80:83]
    ds_read_b64_tr_b16 v[202:203], v8 offset:4736
    v_mfma_f32_16x16x32_bf16 v[84:87], v[212:215], a[148:151], v[84:87]
    v_mfma_f32_16x16x32_bf16 v[84:87], v[208:211], a[132:135], v[84:87]
    s_mul_i32 s92, s92, s97
    v_mfma_f32_16x16x32_bf16 v[88:91], v[208:211], a[136:139], v[88:91]
    ds_read_b64_tr_b16 v[204:205], v8 offset:9344
    v_mfma_f32_16x16x32_bf16 v[88:91], v[212:215], a[152:155], v[88:91]
    ds_read_b64_tr_b16 v[206:207], v8 offset:13952
    s_waitcnt lgkmcnt(4)
    v_mfma_f32_16x16x32_bf16 v[92:95], v[212:215], a[156:159], v[92:95]
    buffer_load_dwordx4 a[236:239], v13, s[28:31], s79 offen offset:2048 sc1
    v_mfma_f32_16x16x32_bf16 v[92:95], v[208:211], a[140:143], v[92:95]
    v_mfma_f32_16x16x32_bf16 v[96:99], v[192:195], a[128:131], v[96:99]
    ds_read_b64_tr_b16 v[208:209], v8 offset:160
    v_mfma_f32_16x16x32_bf16 v[96:99], v[196:199], a[144:147], v[96:99]
    ds_read_b64_tr_b16 v[210:211], v8 offset:4768
    v_mfma_f32_16x16x32_bf16 v[100:103], v[196:199], a[148:151], v[100:103]
    buffer_load_dwordx4 a[240:243], v10, s[28:31], s79 offen offset:3072 sc1
    v_mfma_f32_16x16x32_bf16 v[100:103], v[192:195], a[132:135], v[100:103]
    s_add_u32 s92, s92, s93
    v_mfma_f32_16x16x32_bf16 v[104:107], v[192:195], a[136:139], v[104:107]
    ds_read_b64_tr_b16 v[212:213], v8 offset:9376
    v_mfma_f32_16x16x32_bf16 v[104:107], v[196:199], a[152:155], v[104:107]
    ds_read_b64_tr_b16 v[214:215], v8 offset:13984
    s_waitcnt lgkmcnt(4)
    v_mfma_f32_16x16x32_bf16 v[108:111], v[196:199], a[156:159], v[108:111]
    v_mfma_f32_16x16x32_bf16 v[108:111], v[192:195], a[140:143], v[108:111]
    v_mfma_f32_16x16x32_bf16 v[112:115], v[200:203], a[128:131], v[112:115]
    ds_read_b64_tr_b16 v[192:193], v8 offset:192
    v_mfma_f32_16x16x32_bf16 v[112:115], v[204:207], a[144:147], v[112:115]
    ds_read_b64_tr_b16 v[194:195], v8 offset:4800
    s_add_u32 m0, s94, 0
    v_mfma_f32_16x16x32_bf16 v[116:119], v[204:207], a[148:151], v[116:119]
    buffer_load_dwordx4 a[244:247], v11, s[28:31], s79 offen offset:3072 sc1
    v_mfma_f32_16x16x32_bf16 v[116:119], v[200:203], a[132:135], v[116:119]
    v_mfma_f32_16x16x32_bf16 v[120:123], v[200:203], a[136:139], v[120:123]
    ds_read_b64_tr_b16 v[196:197], v8 offset:9408
    v_mfma_f32_16x16x32_bf16 v[120:123], v[204:207], a[152:155], v[120:123]
    ds_read_b64_tr_b16 v[198:199], v8 offset:14016
    s_waitcnt lgkmcnt(4)
    v_mfma_f32_16x16x32_bf16 v[124:127], v[204:207], a[156:159], v[124:127]
    buffer_load_dwordx4 a[248:251], v12, s[28:31], s79 offen offset:3072 sc1
    v_mfma_f32_16x16x32_bf16 v[124:127], v[200:203], a[140:143], v[124:127]
    v_mfma_f32_16x16x32_bf16 v[128:131], v[208:211], a[128:131], v[128:131]
    ds_read_b64_tr_b16 v[200:201], v8 offset:224
    v_mfma_f32_16x16x32_bf16 v[128:131], v[212:215], a[144:147], v[128:131]
    ds_read_b64_tr_b16 v[202:203], v8 offset:4832
    v_mfma_f32_16x16x32_bf16 v[132:135], v[212:215], a[148:151], v[132:135]
    buffer_load_dwordx4 v16, s[20:23], s92 offen offset:0 sc1 lds
    v_mfma_f32_16x16x32_bf16 v[132:135], v[208:211], a[132:135], v[132:135]
    v_mfma_f32_16x16x32_bf16 v[136:139], v[208:211], a[136:139], v[136:139]
    ds_read_b64_tr_b16 v[204:205], v8 offset:9440
    v_mfma_f32_16x16x32_bf16 v[136:139], v[212:215], a[152:155], v[136:139]
    ds_read_b64_tr_b16 v[206:207], v8 offset:14048
    s_waitcnt lgkmcnt(4)
    v_mfma_f32_16x16x32_bf16 v[140:143], v[212:215], a[156:159], v[140:143]
    buffer_load_dwordx4 a[252:255], v13, s[28:31], s79 offen offset:3072 sc1
    v_mfma_f32_16x16x32_bf16 v[140:143], v[208:211], a[140:143], v[140:143]
    buffer_load_dwordx4 v17, s[20:23], s92 offen offset:1024 sc1 lds
    v_mfma_f32_16x16x32_bf16 v[144:147], v[192:195], a[128:131], v[144:147]
    ds_read_b64_tr_b16 v[208:209], v8 offset:256
    v_mfma_f32_16x16x32_bf16 v[144:147], v[196:199], a[144:147], v[144:147]
    ds_read_b64_tr_b16 v[210:211], v8 offset:4864
    v_mfma_f32_16x16x32_bf16 v[148:151], v[196:199], a[148:151], v[148:151]
    s_xor_b32 s79, s87, s85
    s_lshl_b32 s79, s79, 12
    v_mfma_f32_16x16x32_bf16 v[148:151], v[192:195], a[132:135], v[148:151]
    v_mfma_f32_16x16x32_bf16 v[152:155], v[192:195], a[136:139], v[152:155]
    ds_read_b64_tr_b16 v[212:213], v8 offset:9472
    v_mfma_f32_16x16x32_bf16 v[152:155], v[196:199], a[152:155], v[152:155]
    ds_read_b64_tr_b16 v[214:215], v8 offset:14080
    s_waitcnt lgkmcnt(4)
    v_mfma_f32_16x16x32_bf16 v[156:159], v[196:199], a[156:159], v[156:159]
    buffer_load_dwordx4 v18, s[20:23], s92 offen offset:2048 sc1 lds
    v_mfma_f32_16x16x32_bf16 v[156:159], v[192:195], a[140:143], v[156:159]
    v_mfma_f32_16x16x32_bf16 v[160:163], v[200:203], a[128:131], v[160:163]
    ds_read_b64_tr_b16 v[192:193], v8 offset:18432
    v_mfma_f32_16x16x32_bf16 v[160:163], v[204:207], a[144:147], v[160:163]
    ds_read_b64_tr_b16 v[194:195], v8 offset:23040
    v_mfma_f32_16x16x32_bf16 v[164:167], v[204:207], a[148:151], v[164:167]
    s_add_u32 s79, s79, s80
    s_add_u32 s87, s87, 1
    v_mfma_f32_16x16x32_bf16 v[164:167], v[200:203], a[132:135], v[164:167]
    v_mfma_f32_16x16x32_bf16 v[168:171], v[200:203], a[136:139], v[168:171]
    ds_read_b64_tr_b16 v[196:197], v8 offset:27648
    v_mfma_f32_16x16x32_bf16 v[168:171], v[204:207], a[152:155], v[168:171]
    ds_read_b64_tr_b16 v[198:199], v8 offset:32256
    s_waitcnt lgkmcnt(4)
    v_mfma_f32_16x16x32_bf16 v[172:175], v[204:207], a[156:159], v[172:175]
    buffer_load_dwordx4 v19, s[20:23], s92 offen offset:3072 sc1 lds
    v_mfma_f32_16x16x32_bf16 v[172:175], v[200:203], a[140:143], v[172:175]
    v_mfma_f32_16x16x32_bf16 v[176:179], v[208:211], a[128:131], v[176:179]
    ds_read_b64_tr_b16 v[200:201], v8 offset:18464
    v_mfma_f32_16x16x32_bf16 v[176:179], v[212:215], a[144:147], v[176:179]
    ds_read_b64_tr_b16 v[202:203], v8 offset:23072
    v_mfma_f32_16x16x32_bf16 v[180:183], v[212:215], a[148:151], v[180:183]
    v_mfma_f32_16x16x32_bf16 v[180:183], v[208:211], a[132:135], v[180:183]
    v_mfma_f32_16x16x32_bf16 v[184:187], v[208:211], a[136:139], v[184:187]
    ds_read_b64_tr_b16 v[204:205], v8 offset:27680
    s_waitcnt vmcnt(12)
    v_mfma_f32_16x16x32_bf16 v[184:187], v[212:215], a[152:155], v[184:187]
    ds_read_b64_tr_b16 v[206:207], v8 offset:32288
    s_waitcnt lgkmcnt(4)
    v_mfma_f32_16x16x32_bf16 v[188:191], v[212:215], a[156:159], v[188:191]
    s_add_u32 m0, s94, 4096
    v_mfma_f32_16x16x32_bf16 v[188:191], v[208:211], a[140:143], v[188:191]
    v_mfma_f32_16x16x32_bf16 v[48:51], v[192:195], a[160:163], v[48:51]
    ds_read_b64_tr_b16 v[208:209], v8 offset:18496
    v_mfma_f32_16x16x32_bf16 v[48:51], v[196:199], a[176:179], v[48:51]
    ds_read_b64_tr_b16 v[210:211], v8 offset:23104
    v_mfma_f32_16x16x32_bf16 v[52:55], v[196:199], a[180:183], v[52:55]
    buffer_load_dwordx4 a[128:131], v10, s[28:31], s79 offen offset:0 sc1
    v_mfma_f32_16x16x32_bf16 v[52:55], v[192:195], a[164:167], v[52:55]
    v_mfma_f32_16x16x32_bf16 v[56:59], v[192:195], a[168:171], v[56:59]
    ds_read_b64_tr_b16 v[212:213], v8 offset:27712
    v_mfma_f32_16x16x32_bf16 v[56:59], v[196:199], a[184:187], v[56:59]
    ds_read_b64_tr_b16 v[214:215], v8 offset:32320
    s_waitcnt lgkmcnt(4)
    v_mfma_f32_16x16x32_bf16 v[60:63], v[196:199], a[188:191], v[60:63]
    buffer_load_dwordx4 v20, s[20:23], s92 offen offset:0 sc1 lds
    v_mfma_f32_16x16x32_bf16 v[60:63], v[192:195], a[172:175], v[60:63]
    v_mfma_f32_16x16x32_bf16 v[64:67], v[200:203], a[160:163], v[64:67]
    ds_read_b64_tr_b16 v[192:193], v8 offset:18528
    v_mfma_f32_16x16x32_bf16 v[64:67], v[204:207], a[176:179], v[64:67]
    ds_read_b64_tr_b16 v[194:195], v8 offset:23136
    v_mfma_f32_16x16x32_bf16 v[68:71], v[204:207], a[180:183], v[68:71]
    buffer_load_dwordx4 a[132:135], v11, s[28:31], s79 offen offset:0 sc1
    v_mfma_f32_16x16x32_bf16 v[68:71], v[200:203], a[164:167], v[68:71]
    buffer_load_dwordx4 v21, s[20:23], s92 offen offset:1024 sc1 lds
    v_mfma_f32_16x16x32_bf16 v[72:75], v[200:203], a[168:171], v[72:75]
    ds_read_b64_tr_b16 v[196:197], v8 offset:27744
    v_mfma_f32_16x16x32_bf16 v[72:75], v[204:207], a[184:187], v[72:75]
    ds_read_b64_tr_b16 v[198:199], v8 offset:32352
    s_waitcnt lgkmcnt(4)
    v_mfma_f32_16x16x32_bf16 v[76:79], v[204:207], a[188:191], v[76:79]
    v_mfma_f32_16x16x32_bf16 v[76:79], v[200:203], a[172:175], v[76:79]
    v_mfma_f32_16x16x32_bf16 v[80:83], v[208:211], a[160:163], v[80:83]
    ds_read_b64_tr_b16 v[200:201], v8 offset:18560
    v_mfma_f32_16x16x32_bf16 v[80:83], v[212:215], a[176:179], v[80:83]
    ds_read_b64_tr_b16 v[202:203], v8 offset:23168
    v_mfma_f32_16x16x32_bf16 v[84:87], v[212:215], a[180:183], v[84:87]
    buffer_load_dwordx4 a[136:139], v12, s[28:31], s79 offen offset:0 sc1
    v_mfma_f32_16x16x32_bf16 v[84:87], v[208:211], a[164:167], v[84:87]
    buffer_load_dwordx4 v22, s[20:23], s92 offen offset:2048 sc1 lds
    v_mfma_f32_16x16x32_bf16 v[88:91], v[208:211], a[168:171], v[88:91]
    ds_read_b64_tr_b16 v[204:205], v8 offset:27776
    v_mfma_f32_16x16x32_bf16 v[88:91], v[212:215], a[184:187], v[88:91]
    ds_read_b64_tr_b16 v[206:207], v8 offset:32384
    s_waitcnt lgkmcnt(4)
    v_mfma_f32_16x16x32_bf16 v[92:95], v[212:215], a[188:191], v[92:95]
    v_mfma_f32_16x16x32_bf16 v[92:95], v[208:211], a[172:175], v[92:95]
    v_mfma_f32_16x16x32_bf16 v[96:99], v[192:195], a[160:163], v[96:99]
    ds_read_b64_tr_b16 v[208:209], v8 offset:18592
    v_mfma_f32_16x16x32_bf16 v[96:99], v[196:199], a[176:179], v[96:99]
    ds_read_b64_tr_b16 v[210:211], v8 offset:23200
    v_mfma_f32_16x16x32_bf16 v[100:103], v[196:199], a[180:183], v[100:103]
    buffer_load_dwordx4 a[140:143], v13, s[28:31], s79 offen offset:0 sc1
    v_mfma_f32_16x16x32_bf16 v[100:103], v[192:195], a[164:167], v[100:103]
    buffer_load_dwordx4 v23, s[20:23], s92 offen offset:3072 sc1 lds
    v_mfma_f32_16x16x32_bf16 v[104:107], v[192:195], a[168:171], v[104:107]
    ds_read_b64_tr_b16 v[212:213], v8 offset:27808
    v_mfma_f32_16x16x32_bf16 v[104:107], v[196:199], a[184:187], v[104:107]
    ds_read_b64_tr_b16 v[214:215], v8 offset:32416
    s_waitcnt lgkmcnt(4)
    v_mfma_f32_16x16x32_bf16 v[108:111], v[196:199], a[188:191], v[108:111]
    v_mfma_f32_16x16x32_bf16 v[108:111], v[192:195], a[172:175], v[108:111]
    v_mfma_f32_16x16x32_bf16 v[112:115], v[200:203], a[160:163], v[112:115]
    ds_read_b64_tr_b16 v[192:193], v8 offset:18624
    s_add_u32 m0, s94, 8192
    v_mfma_f32_16x16x32_bf16 v[112:115], v[204:207], a[176:179], v[112:115]
    ds_read_b64_tr_b16 v[194:195], v8 offset:23232
    v_mfma_f32_16x16x32_bf16 v[116:119], v[204:207], a[180:183], v[116:119]
    buffer_load_dwordx4 a[144:147], v10, s[28:31], s79 offen offset:1024 sc1
    v_mfma_f32_16x16x32_bf16 v[116:119], v[200:203], a[164:167], v[116:119]
    v_mfma_f32_16x16x32_bf16 v[120:123], v[200:203], a[168:171], v[120:123]
    ds_read_b64_tr_b16 v[196:197], v8 offset:27840
    v_mfma_f32_16x16x32_bf16 v[120:123], v[204:207], a[184:187], v[120:123]
    ds_read_b64_tr_b16 v[198:199], v8 offset:32448
    s_waitcnt lgkmcnt(4)
    v_mfma_f32_16x16x32_bf16 v[124:127], v[204:207], a[188:191], v[124:127]
    v_mfma_f32_16x16x32_bf16 v[124:127], v[200:203], a[172:175], v[124:127]
    buffer_load_dwordx4 v24, s[20:23], s92 offen offset:0 sc1 lds
    v_mfma_f32_16x16x32_bf16 v[128:131], v[208:211], a[160:163], v[128:131]
    ds_read_b64_tr_b16 v[200:201], v8 offset:18656
    v_mfma_f32_16x16x32_bf16 v[128:131], v[212:215], a[176:179], v[128:131]
    ds_read_b64_tr_b16 v[202:203], v8 offset:23264
    v_mfma_f32_16x16x32_bf16 v[132:135], v[212:215], a[180:183], v[132:135]
    buffer_load_dwordx4 a[148:151], v11, s[28:31], s79 offen offset:1024 sc1
    v_mfma_f32_16x16x32_bf16 v[132:135], v[208:211], a[164:167], v[132:135]
    v_mfma_f32_16x16x32_bf16 v[136:139], v[208:211], a[168:171], v[136:139]
    ds_read_b64_tr_b16 v[204:205], v8 offset:27872
    v_mfma_f32_16x16x32_bf16 v[136:139], v[212:215], a[184:187], v[136:139]
    ds_read_b64_tr_b16 v[206:207], v8 offset:32480
    s_waitcnt lgkmcnt(4)
    v_mfma_f32_16x16x32_bf16 v[140:143], v[212:215], a[188:191], v[140:143]
    s_add_u32 s88, s88, 1
    v_mfma_f32_16x16x32_bf16 v[140:143], v[208:211], a[172:175], v[140:143]
    v_mfma_f32_16x16x32_bf16 v[144:147], v[192:195], a[160:163], v[144:147]
    ds_read_b64_tr_b16 v[208:209], v8 offset:18688
    v_mfma_f32_16x16x32_bf16 v[144:147], v[196:199], a[176:179], v[144:147]
    ds_read_b64_tr_b16 v[210:211], v8 offset:23296
    v_mfma_f32_16x16x32_bf16 v[148:151], v[196:199], a[180:183], v[148:151]
    buffer_load_dwordx4 a[152:155], v12, s[28:31], s79 offen offset:1024 sc1
    v_mfma_f32_16x16x32_bf16 v[148:151], v[192:195], a[164:167], v[148:151]
    v_mfma_f32_16x16x32_bf16 v[152:155], v[192:195], a[168:171], v[152:155]
    ds_read_b64_tr_b16 v[212:213], v8 offset:27904
    v_mfma_f32_16x16x32_bf16 v[152:155], v[196:199], a[184:187], v[152:155]
    ds_read_b64_tr_b16 v[214:215], v8 offset:32512
    s_waitcnt lgkmcnt(4)
    v_mfma_f32_16x16x32_bf16 v[156:159], v[196:199], a[188:191], v[156:159]
    s_add_u32 s94, s94, 36864
    v_mfma_f32_16x16x32_bf16 v[156:159], v[192:195], a[172:175], v[156:159]
    v_add_u32 v8, s96, v5
    v_mfma_f32_16x16x32_bf16 v[160:163], v[200:203], a[160:163], v[160:163]
    ds_read_b64_tr_b16 v[192:193], v8 offset:0
    v_mfma_f32_16x16x32_bf16 v[160:163], v[204:207], a[176:179], v[160:163]
    ds_read_b64_tr_b16 v[194:195], v8 offset:4608
    v_mfma_f32_16x16x32_bf16 v[164:167], v[204:207], a[180:183], v[164:167]
    buffer_load_dwordx4 a[156:159], v13, s[28:31], s79 offen offset:1024 sc1
    v_mfma_f32_16x16x32_bf16 v[164:167], v[200:203], a[164:167], v[164:167]
    s_cmp_eq_u32 s101, 0
    s_cbranch_scc1 KF_hk0
KF_hk0r:
    v_mfma_f32_16x16x32_bf16 v[168:171], v[200:203], a[168:171], v[168:171]
    ds_read_b64_tr_b16 v[196:197], v8 offset:9216
    v_mfma_f32_16x16x32_bf16 v[168:171], v[204:207], a[184:187], v[168:171]
    ds_read_b64_tr_b16 v[198:199], v8 offset:13824
    s_waitcnt lgkmcnt(4)
    v_mfma_f32_16x16x32_bf16 v[172:175], v[204:207], a[188:191], v[172:175]
    s_cmp_ge_u32 s94, 147456
    s_cselect_b32 s94, s81, s94
    v_mfma_f32_16x16x32_bf16 v[172:175], v[200:203], a[172:175], v[172:175]
    v_mfma_f32_16x16x32_bf16 v[176:179], v[208:211], a[160:163], v[176:179]
    ds_read_b64_tr_b16 v[200:201], v8 offset:32
    v_mfma_f32_16x16x32_bf16 v[176:179], v[212:215], a[176:179], v[176:179]
    ds_read_b64_tr_b16 v[202:203], v8 offset:4640
    v_mfma_f32_16x16x32_bf16 v[180:183], v[212:215], a[180:183], v[180:183]
    v_mfma_f32_16x16x32_bf16 v[180:183], v[208:211], a[164:167], v[180:183]
    v_mfma_f32_16x16x32_bf16 v[184:187], v[208:211], a[168:171], v[184:187]
    ds_read_b64_tr_b16 v[204:205], v8 offset:9248
    v_mfma_f32_16x16x32_bf16 v[184:187], v[212:215], a[184:187], v[184:187]
    ds_read_b64_tr_b16 v[206:207], v8 offset:13856
    s_waitcnt lgkmcnt(4)
    v_mfma_f32_16x16x32_bf16 v[188:191], v[212:215], a[188:191], v[188:191]
    v_mfma_f32_16x16x32_bf16 v[188:191], v[208:211], a[172:175], v[188:191]
    v_mfma_f32_16x16x32_bf16 v[48:51], v[192:195], a[192:195], v[48:51]
    ds_read_b64_tr_b16 v[208:209], v8 offset:64
    v_mfma_f32_16x16x32_bf16 v[48:51], v[196:199], a[208:211], v[48:51]
    ds_read_b64_tr_b16 v[210:211], v8 offset:4672
    v_mfma_f32_16x16x32_bf16 v[52:55], v[196:199], a[212:215], v[52:55]
    buffer_load_dwordx4 a[160:163], v10, s[28:31], s79 offen offset:2048 sc1
    v_mfma_f32_16x16x32_bf16 v[52:55], v[192:195], a[196:199], v[52:55]
    v_mfma_f32_16x16x32_bf16 v[56:59], v[192:195], a[200:203], v[56:59]
    ds_read_b64_tr_b16 v[212:213], v8 offset:9280
    v_mfma_f32_16x16x32_bf16 v[56:59], v[196:199], a[216:219], v[56:59]
    ds_read_b64_tr_b16 v[214:215], v8 offset:13888
    s_waitcnt lgkmcnt(4)
    v_mfma_f32_16x16x32_bf16 v[60:63], v[196:199], a[220:223], v[60:63]
    s_barrier
    v_mfma_f32_16x16x32_bf16 v[60:63], v[192:195], a[204:207], v[60:63]
    s_add_u32 s96, s96, 36864
    s_cmp_eq_u32 s96, 147456
    s_cselect_b32 s96, 0, s96
    v_mfma_f32_16x16x32_bf16 v[64:67], v[200:203], a[192:195], v[64:67]
    ds_read_b64_tr_b16 v[192:193], v8 offset:96
    v_mfma_f32_16x16x32_bf16 v[64:67], v[204:207], a[208:211], v[64:67]
    ds_read_b64_tr_b16 v[194:195], v8 offset:4704
    v_mfma_f32_16x16x32_bf16 v[68:71], v[204:207], a[212:215], v[68:71]
    buffer_load_dwordx4 a[164:167], v11, s[28:31], s79 offen offset:2048 sc1
    v_mfma_f32_16x16x32_bf16 v[68:71], v[200:203], a[196:199], v[68:71]
    v_mfma_f32_16x16x32_bf16 v[72:75], v[200:203], a[200:203], v[72:75]
    ds_read_b64_tr_b16 v[196:197], v8 offset:9312
    s_xor_b32 s92, s88, s85
    v_mfma_f32_16x16x32_bf16 v[72:75], v[204:207], a[216:219], v[72:75]
    ds_read_b64_tr_b16 v[198:199], v8 offset:13920
    s_waitcnt lgkmcnt(4)
    v_mfma_f32_16x16x32_bf16 v[76:79], v[204:207], a[220:223], v[76:79]
    buffer_load_dwordx4 a[168:171], v12, s[28:31], s79 offen offset:2048 sc1
    v_mfma_f32_16x16x32_bf16 v[76:79], v[200:203], a[204:207], v[76:79]
    v_mfma_f32_16x16x32_bf16 v[80:83], v[208:211], a[192:195], v[80:83]
    ds_read_b64_tr_b16 v[200:201], v8 offset:128
    v_mfma_f32_16x16x32_bf16 v[80:83], v[212:215], a[208:211], v[80:83]
    ds_read_b64_tr_b16 v[202:203], v8 offset:4736
    v_mfma_f32_16x16x32_bf16 v[84:87], v[212:215], a[212:215], v[84:87]
    v_mfma_f32_16x16x32_bf16 v[84:87], v[208:211], a[196:199], v[84:87]
    s_mul_i32 s92, s92, s97
    v_mfma_f32_16x16x32_bf16 v[88:91], v[208:211], a[200:203], v[88:91]
    ds_read_b64_tr_b16 v[204:205], v8 offset:9344
    v_mfma_f32_16x16x32_bf16 v[88:91], v[212:215], a[216:219], v[88:91]
    ds_read_b64_tr_b16 v[206:207], v8 offset:13952
    s_waitcnt lgkmcnt(4)
    v_mfma_f32_16x16x32_bf16 v[92:95], v[212:215], a[220:223], v[92:95]
    buffer_load_dwordx4 a[172:175], v13, s[28:31], s79 offen offset:2048 sc1
    v_mfma_f32_16x16x32_bf16 v[92:95], v[208:211], a[204:207], v[92:95]
    v_mfma_f32_16x16x32_bf16 v[96:99], v[192:195], a[192:195], v[96:99]
    ds_read_b64_tr_b16 v[208:209], v8 offset:160
    v_mfma_f32_16x16x32_bf16 v[96:99], v[196:199], a[208:211], v[96:99]
    ds_read_b64_tr_b16 v[210:211], v8 offset:4768
    v_mfma_f32_16x16x32_bf16 v[100:103], v[196:199], a[212:215], v[100:103]
    buffer_load_dwordx4 a[176:179], v10, s[28:31], s79 offen offset:3072 sc1
    v_mfma_f32_16x16x32_bf16 v[100:103], v[192:195], a[196:199], v[100:103]
    s_add_u32 s92, s92, s93
    v_mfma_f32_16x16x32_bf16 v[104:107], v[192:195], a[200:203], v[104:107]
    ds_read_b64_tr_b16 v[212:213], v8 offset:9376
    v_mfma_f32_16x16x32_bf16 v[104:107], v[196:199], a[216:219], v[104:107]
    ds_read_b64_tr_b16 v[214:215], v8 offset:13984
    s_waitcnt lgkmcnt(4)
    v_mfma_f32_16x16x32_bf16 v[108:111], v[196:199], a[220:223], v[108:111]
    v_mfma_f32_16x16x32_bf16 v[108:111], v[192:195], a[204:207], v[108:111]
    v_mfma_f32_16x16x32_bf16 v[112:115], v[200:203], a[192:195], v[112:115]
    ds_read_b64_tr_b16 v[192:193], v8 offset:192
    v_mfma_f32_16x16x32_bf16 v[112:115], v[204:207], a[208:211], v[112:115]
    ds_read_b64_tr_b16 v[194:195], v8 offset:4800
    s_add_u32 m0, s94, 0
    v_mfma_f32_16x16x32_bf16 v[116:119], v[204:207], a[212:215], v[116:119]
    buffer_load_dwordx4 a[180:183], v11, s[28:31], s79 offen offset:3072 sc1
    v_mfma_f32_16x16x32_bf16 v[116:119], v[200:203], a[196:199], v[116:119]
    v_mfma_f32_16x16x32_bf16 v[120:123], v[200:203], a[200:203], v[120:123]
    ds_read_b64_tr_b16 v[196:197], v8 offset:9408
    v_mfma_f32_16x16x32_bf16 v[120:123], v[204:207], a[216:219], v[120:123]
    ds_read_b64_tr_b16 v[198:199], v8 offset:14016
    s_waitcnt lgkmcnt(4)
    v_mfma_f32_16x16x32_bf16 v[124:127], v[204:207], a[220:223], v[124:127]
    buffer_load_dwordx4 a[184:187], v12, s[28:31], s79 offen offset:3072 sc1
    v_mfma_f32_16x16x32_bf16 v[124:127], v[200:203], a[204:207], v[124:127]
    v_mfma_f32_16x16x32_bf16 v[128:131], v[208:211], a[192:195], v[128:131]
    ds_read_b64_tr_b16 v[200:201], v8 offset:224
    v_mfma_f32_16x16x32_bf16 v[128:131], v[212:215], a[208:211], v[128:131]
    ds_read_b64_tr_b16 v[202:203], v8 offset:4832
    v_mfma_f32_16x16x32_bf16 v[132:135], v[212:215], a[212:215], v[132:135]
    buffer_load_dwordx4 v16, s[20:23], s92 offen offset:0 sc1 lds
    v_mfma_f32_16x16x32_bf16 v[132:135], v[208:211], a[196:199], v[132:135]
    v_mfma_f32_16x16x32_bf16 v[136:139], v[208:211], a[200:203], v[136:139]
    ds_read_b64_tr_b16 v[204:205], v8 offset:9440
    v_mfma_f32_16x16x32_bf16 v[136:139], v[212:215], a[216:219], v[136:139]
    ds_read_b64_tr_b16 v[206:207], v8 offset:14048
    s_waitcnt lgkmcnt(4)
    v_mfma_f32_16x16x32_bf16 v[140:143], v[212:215], a[220:223], v[140:143]
    buffer_load_dwordx4 a[188:191], v13, s[28:31], s79 offen offset:3072 sc1
    v_mfma_f32_16x16x32_bf16 v[140:143], v[208:211], a[204:207], v[140:143]
    buffer_load_dwordx4 v17, s[20:23], s92 offen offset:1024 sc1 lds
    v_mfma_f32_16x16x32_bf16 v[144:147], v[192:195], a[192:195], v[144:147]
    ds_read_b64_tr_b16 v[208:209], v8 offset:256
    v_mfma_f32_16x16x32_bf16 v[144:147], v[196:199], a[208:211], v[144:147]
    ds_read_b64_tr_b16 v[210:211], v8 offset:4864
    v_mfma_f32_16x16x32_bf16 v[148:151], v[196:199], a[212:215], v[148:151]
    s_xor_b32 s79, s87, s85
    s_lshl_b32 s79, s79, 12
    v_mfma_f32_16x16x32_bf16 v[148:151], v[192:195], a[196:199], v[148:151]
    v_mfma_f32_16x16x32_bf16 v[152:155], v[192:195], a[200:203], v[152:155]
    ds_read_b64_tr_b16 v[212:213], v8 offset:9472
    v_mfma_f32_16x16x32_bf16 v[152:155], v[196:199], a[216:219], v[152:155]
    ds_read_b64_tr_b16 v[214:215], v8 offset:14080
    s_waitcnt lgkmcnt(4)
    v_mfma_f32_16x16x32_bf16 v[156:159], v[196:199], a[220:223], v[156:159]
    buffer_load_dwordx4 v18, s[20:23], s92 offen offset:2048 sc1 lds
    v_mfma_f32_16x16x32_bf16 v[156:159], v[192:195], a[204:207], v[156:159]
    v_mfma_f32_16x16x32_bf16 v[160:163], v[200:203], a[192:195], v[160:163]
    ds_read_b64_tr_b16 v[192:193], v8 offset:18432
    v_mfma_f32_16x16x32_bf16 v[160:163], v[204:207], a[208:211], v[160:163]
    ds_read_b64_tr_b16 v[194:195], v8 offset:23040
    v_mfma_f32_16x16x32_bf16 v[164:167], v[204:207], a[212:215], v[164:167]
    s_add_u32 s79, s79, s80
    s_add_u32 s87, s87, 1
    v_mfma_f32_16x16x32_bf16 v[164:167], v[200:203], a[196:199], v[164:167]
    v_mfma_f32_16x16x32_bf16 v[168:171], v[200:203], a[200:203], v[168:171]
    ds_read_b64_tr_b16 v[196:197], v8 offset:27648
    v_mfma_f32_16x16x32_bf16 v[168:171], v[204:207], a[216:219], v[168:171]
    ds_read_b64_tr_b16 v[198:199], v8 offset:32256
    s_waitcnt lgkmcnt(4)
    v_mfma_f32_16x16x32_bf16 v[172:175], v[204:207], a[220:223], v[172:175]
    buffer_load_dwordx4 v19, s[20:23], s92 offen offset:3072 sc1 lds
    v_mfma_f32_16x16x32_bf16 v[172:175], v[200:203], a[204:207], v[172:175]
    v_mfma_f32_16x16x32_bf16 v[176:179], v[208:211], a[192:195], v[176:179]
    ds_read_b64_tr_b16 v[200:201], v8 offset:18464
    v_mfma_f32_16x16x32_bf16 v[176:179], v[212:215], a[208:211], v[176:179]
    ds_read_b64_tr_b16 v[202:203], v8 offset:23072
    v_mfma_f32_16x16x32_bf16 v[180:183], v[212:215], a[212:215], v[180:183]
    s_cmp_eq_u32 s101, 0
    s_cbranch_scc1 KF_hk1
KF_hk1r:
    v_mfma_f32_16x16x32_bf16 v[180:183], v[208:211], a[196:199], v[180:183]
    v_mfma_f32_16x16x32_bf16 v[184:187], v[208:211], a[200:203], v[184:187]
    ds_read_b64_tr_b16 v[204:205], v8 offset:27680
    s_waitcnt vmcnt(28)
    v_mfma_f32_16x16x32_bf16 v[184:187], v[212:215], a[216:219], v[184:187]
    ds_read_b64_tr_b16 v[206:207], v8 offset:32288
    s_waitcnt lgkmcnt(4)
    v_mfma_f32_16x16x32_bf16 v[188:191], v[212:215], a[220:223], v[188:191]
    s_add_u32 m0, s94, 4096
    v_mfma_f32_16x16x32_bf16 v[188:191], v[208:211], a[204:207], v[188:191]
    v_mfma_f32_16x16x32_bf16 v[48:51], v[192:195], a[224:227], v[48:51]
    ds_read_b64_tr_b16 v[208:209], v8 offset:18496
    v_mfma_f32_16x16x32_bf16 v[48:51], v[196:199], a[240:243], v[48:51]
    ds_read_b64_tr_b16 v[210:211], v8 offset:23104
    v_mfma_f32_16x16x32_bf16 v[52:55], v[196:199], a[244:247], v[52:55]
    buffer_load_dwordx4 a[192:195], v10, s[28:31], s79 offen offset:0 sc1
    v_mfma_f32_16x16x32_bf16 v[52:55], v[192:195], a[228:231], v[52:55]
    v_mfma_f32_16x16x32_bf16 v[56:59], v[192:195], a[232:235], v[56:59]
    ds_read_b64_tr_b16 v[212:213], v8 offset:27712
    v_mfma_f32_16x16x32_bf16 v[56:59], v[196:199], a[248:251], v[56:59]
    ds_read_b64_tr_b16 v[214:215], v8 offset:32320
    s_waitcnt lgkmcnt(4)
    v_mfma_f32_16x16x32_bf16 v[60:63], v[196:199], a[252:255], v[60:63]
    buffer_load_dwordx4 v20, s[20:23], s92 offen offset:0 sc1 lds
    v_mfma_f32_16x16x32_bf16 v[60:63], v[192:195], a[236:239], v[60:63]
    v_mfma_f32_16x16x32_bf16 v[64:67], v[200:203], a[224:227], v[64:67]
    ds_read_b64_tr_b16 v[192:193], v8 offset:18528
    v_mfma_f32_16x16x32_bf16 v[64:67], v[204:207], a[240:243], v[64:67]
    ds_read_b64_tr_b16 v[194:195], v8 offset:23136
    v_mfma_f32_16x16x32_bf16 v[68:71], v[204:207], a[244:247], v[68:71]
    buffer_load_dwordx4 a[196:199], v11, s[28:31], s79 offen offset:0 sc1
    v_mfma_f32_16x16x32_bf16 v[68:71], v[200:203], a[228:231], v[68:71]
    buffer_load_dwordx4 v21, s[20:23], s92 offen offset:1024 sc1 lds
    v_mfma_f32_16x16x32_bf16 v[72:75], v[200:203], a[232:235], v[72:75]
    ds_read_b64_tr_b16 v[196:197], v8 offset:27744
    v_mfma_f32_16x16x32_bf16 v[72:75], v[204:207], a[248:251], v[72:75]
    ds_read_b64_tr_b16 v[198:199], v8 offset:32352
    s_waitcnt lgkmcnt(4)
    v_mfma_f32_16x16x32_bf16 v[76:79], v[204:207], a[252:255], v[76:79]
    v_mfma_f32_16x16x32_bf16 v[76:79], v[200:203], a[236:239], v[76:79]
    v_mfma_f32_16x16x32_bf16 v[80:83], v[208:211], a[224:227], v[80:83]
    ds_read_b64_tr_b16 v[200:201], v8 offset:18560
    v_mfma_f32_16x16x32_bf16 v[80:83], v[212:215], a[240:243], v[80:83]
    ds_read_b64_tr_b16 v[202:203], v8 offset:23168
    v_mfma_f32_16x16x32_bf16 v[84:87], v[212:215], a[244:247], v[84:87]
    buffer_load_dwordx4 a[200:203], v12, s[28:31], s79 offen offset:0 sc1
    v_mfma_f32_16x16x32_bf16 v[84:87], v[208:211], a[228:231], v[84:87]
    buffer_load_dwordx4 v22, s[20:23], s92 offen offset:2048 sc1 lds
    v_mfma_f32_16x16x32_bf16 v[88:91], v[208:211], a[232:235], v[88:91]
    ds_read_b64_tr_b16 v[204:205], v8 offset:27776
    v_mfma_f32_16x16x32_bf16 v[88:91], v[212:215], a[248:251], v[88:91]
    ds_read_b64_tr_b16 v[206:207], v8 offset:32384
    s_waitcnt lgkmcnt(4)
    v_mfma_f32_16x16x32_bf16 v[92:95], v[212:215], a[252:255], v[92:95]
    v_mfma_f32_16x16x32_bf16 v[92:95], v[208:211], a[236:239], v[92:95]
    v_mfma_f32_16x16x32_bf16 v[96:99], v[192:195], a[224:227], v[96:99]
    ds_read_b64_tr_b16 v[208:209], v8 offset:18592
    v_mfma_f32_16x16x32_bf16 v[96:99], v[196:199], a[240:243], v[96:99]
    ds_read_b64_tr_b16 v[210:211], v8 offset:23200
    v_mfma_f32_16x16x32_bf16 v[100:103], v[196:199], a[244:247], v[100:103]
    buffer_load_dwordx4 a[204:207], v13, s[28:31], s79 offen offset:0 sc1
    v_mfma_f32_16x16x32_bf16 v[100:103], v[192:195], a[228:231], v[100:103]
    buffer_load_dwordx4 v23, s[20:23], s92 offen offset:3072 sc1 lds
    v_mfma_f32_16x16x32_bf16 v[104:107], v[192:195], a[232:235], v[104:107]
    ds_read_b64_tr_b16 v[212:213], v8 offset:27808
    v_mfma_f32_16x16x32_bf16 v[104:107], v[196:199], a[248:251], v[104:107]
    ds_read_b64_tr_b16 v[214:215], v8 offset:32416
    s_waitcnt lgkmcnt(4)
    v_mfma_f32_16x16x32_bf16 v[108:111], v[196:199], a[252:255], v[108:111]
    v_mfma_f32_16x16x32_bf16 v[108:111], v[192:195], a[236:239], v[108:111]
    v_mfma_f32_16x16x32_bf16 v[112:115], v[200:203], a[224:227], v[112:115]
    ds_read_b64_tr_b16 v[192:193], v8 offset:18624
    s_add_u32 m0, s94, 8192
    v_mfma_f32_16x16x32_bf16 v[112:115], v[204:207], a[240:243], v[112:115]
    ds_read_b64_tr_b16 v[194:195], v8 offset:23232
    v_mfma_f32_16x16x32_bf16 v[116:119], v[204:207], a[244:247], v[116:119]
    buffer_load_dwordx4 a[208:211], v10, s[28:31], s79 offen offset:1024 sc1
    v_mfma_f32_16x16x32_bf16 v[116:119], v[200:203], a[228:231], v[116:119]
    v_mfma_f32_16x16x32_bf16 v[120:123], v[200:203], a[232:235], v[120:123]
    ds_read_b64_tr_b16 v[196:197], v8 offset:27840
    v_mfma_f32_16x16x32_bf16 v[120:123], v[204:207], a[248:251], v[120:123]
    ds_read_b64_tr_b16 v[198:199], v8 offset:32448
    s_waitcnt lgkmcnt(4)
    v_mfma_f32_16x16x32_bf16 v[124:127], v[204:207], a[252:255], v[124:127]
    v_mfma_f32_16x16x32_bf16 v[124:127], v[200:203], a[236:239], v[124:127]
    buffer_load_dwordx4 v24, s[20:23], s92 offen offset:0 sc1 lds
    v_mfma_f32_16x16x32_bf16 v[128:131], v[208:211], a[224:227], v[128:131]
    ds_read_b64_tr_b16 v[200:201], v8 offset:18656
    v_mfma_f32_16x16x32_bf16 v[128:131], v[212:215], a[240:243], v[128:131]
    ds_read_b64_tr_b16 v[202:203], v8 offset:23264
    v_mfma_f32_16x16x32_bf16 v[132:135], v[212:215], a[244:247], v[132:135]
    buffer_load_dwordx4 a[212:215], v11, s[28:31], s79 offen offset:1024 sc1
    v_mfma_f32_16x16x32_bf16 v[132:135], v[208:211], a[228:231], v[132:135]
    v_mfma_f32_16x16x32_bf16 v[136:139], v[208:211], a[232:235], v[136:139]
    ds_read_b64_tr_b16 v[204:205], v8 offset:27872
    v_mfma_f32_16x16x32_bf16 v[136:139], v[212:215], a[248:251], v[136:139]
    ds_read_b64_tr_b16 v[206:207], v8 offset:32480
    s_waitcnt lgkmcnt(4)
    v_mfma_f32_16x16x32_bf16 v[140:143], v[212:215], a[252:255], v[140:143]
    s_add_u32 s88, s88, 1
    v_mfma_f32_16x16x32_bf16 v[140:143], v[208:211], a[236:239], v[140:143]
    v_mfma_f32_16x16x32_bf16 v[144:147], v[192:195], a[224:227], v[144:147]
    ds_read_b64_tr_b16 v[208:209], v8 offset:18688
    v_mfma_f32_16x16x32_bf16 v[144:147], v[196:199], a[240:243], v[144:147]
    ds_read_b64_tr_b16 v[210:211], v8 offset:23296
    v_mfma_f32_16x16x32_bf16 v[148:151], v[196:199], a[244:247], v[148:151]
    buffer_load_dwordx4 a[216:219], v12, s[28:31], s79 offen offset:1024 sc1
    v_mfma_f32_16x16x32_bf16 v[148:151], v[192:195], a[228:231], v[148:151]
    v_mfma_f32_16x16x32_bf16 v[152:155], v[192:195], a[232:235], v[152:155]
    ds_read_b64_tr_b16 v[212:213], v8 offset:27904
    v_mfma_f32_16x16x32_bf16 v[152:155], v[196:199], a[248:251], v[152:155]
    ds_read_b64_tr_b16 v[214:215], v8 offset:32512
    s_waitcnt lgkmcnt(4)
    v_mfma_f32_16x16x32_bf16 v[156:159], v[196:199], a[252:255], v[156:159]
    s_add_u32 s94, s94, 36864
    v_mfma_f32_16x16x32_bf16 v[156:159], v[192:195], a[236:239], v[156:159]
    v_add_u32 v8, s96, v5
    v_mfma_f32_16x16x32_bf16 v[160:163], v[200:203], a[224:227], v[160:163]
    ds_read_b64_tr_b16 v[192:193], v8 offset:0
    v_mfma_f32_16x16x32_bf16 v[160:163], v[204:207], a[240:243], v[160:163]
    ds_read_b64_tr_b16 v[194:195], v8 offset:4608
    v_mfma_f32_16x16x32_bf16 v[164:167], v[204:207], a[244:247], v[164:167]
    buffer_load_dwordx4 a[220:223], v13, s[28:31], s79 offen offset:1024 sc1
    v_mfma_f32_16x16x32_bf16 v[164:167], v[200:203], a[228:231], v[164:167]
    v_mfma_f32_16x16x32_bf16 v[168:171], v[200:203], a[232:235], v[168:171]
    ds_read_b64_tr_b16 v[196:197], v8 offset:9216
    v_mfma_f32_16x16x32_bf16 v[168:171], v[204:207], a[248:251], v[168:171]
    ds_read_b64_tr_b16 v[198:199], v8 offset:13824
    s_waitcnt lgkmcnt(4)
    v_mfma_f32_16x16x32_bf16 v[172:175], v[204:207], a[252:255], v[172:175]
    s_cmp_ge_u32 s94, 147456
    s_cselect_b32 s94, s81, s94
    v_mfma_f32_16x16x32_bf16 v[172:175], v[200:203], a[236:239], v[172:175]
    v_mfma_f32_16x16x32_bf16 v[176:179], v[208:211], a[224:227], v[176:179]
    ds_read_b64_tr_b16 v[200:201], v8 offset:32
    v_mfma_f32_16x16x32_bf16 v[176:179], v[212:215], a[240:243], v[176:179]
    ds_read_b64_tr_b16 v[202:203], v8 offset:4640
    v_mfma_f32_16x16x32_bf16 v[180:183], v[212:215], a[244:247], v[180:183]
    v_mfma_f32_16x16x32_bf16 v[180:183], v[208:211], a[228:231], v[180:183]
    v_mfma_f32_16x16x32_bf16 v[184:187], v[208:211], a[232:235], v[184:187]
    ds_read_b64_tr_b16 v[204:205], v8 offset:9248
    s_waitcnt vmcnt(25)
    v_mfma_f32_16x16x32_bf16 v[184:187], v[212:215], a[248:251], v[184:187]
    ds_read_b64_tr_b16 v[206:207], v8 offset:13856
    s_waitcnt lgkmcnt(4)
    v_mfma_f32_16x16x32_bf16 v[188:191], v[212:215], a[252:255], v[188:191]
    v_mfma_f32_16x16x32_bf16 v[188:191], v[208:211], a[236:239], v[188:191]
    s_add_u32 s4, s4, 1
    s_cmp_lt_u32 s4, 2
    s_cbranch_scc1 KF_loop2
    v_mfma_f32_16x16x32_bf16 v[48:51], v[192:195], a[128:131], v[48:51]
    ds_read_b64_tr_b16 v[208:209], v8 offset:64
    v_mfma_f32_16x16x32_bf16 v[48:51], v[196:199], a[144:147], v[48:51]
    ds_read_b64_tr_b16 v[210:211], v8 offset:4672
    v_mfma_f32_16x16x32_bf16 v[52:55], v[196:199], a[148:151], v[52:55]
    buffer_load_dwordx4 a[224:227], v10, s[28:31], s79 offen offset:2048 sc1
    v_mfma_f32_16x16x32_bf16 v[52:55], v[192:195], a[132:135], v[52:55]
    v_mfma_f32_16x16x32_bf16 v[56:59], v[192:195], a[136:139], v[56:59]
    ds_read_b64_tr_b16 v[212:213], v8 offset:9280
    v_mfma_f32_16x16x32_bf16 v[56:59], v[196:199], a[152:155], v[56:59]
    ds_read_b64_tr_b16 v[214:215], v8 offset:13888
    s_waitcnt lgkmcnt(4)
    v_mfma_f32_16x16x32_bf16 v[60:63], v[196:199], a[156:159], v[60:63]
    buffer_load_dwordx4 a[228:231], v11, s[28:31], s79 offen offset:2048 sc1
    v_mfma_f32_16x16x32_bf16 v[60:63], v[192:195], a[140:143], v[60:63]
    buffer_load_dwordx4 a[232:235], v12, s[28:31], s79 offen offset:2048 sc1
    v_mfma_f32_16x16x32_bf16 v[64:67], v[200:203], a[128:131], v[64:67]
    ds_read_b64_tr_b16 v[192:193], v8 offset:96
    s_add_u32 s96, s96, 36864
    v_bfe_u32 v25, v1, 4, 4
    v_mfma_f32_16x16x32_bf16 v[64:67], v[204:207], a[144:147], v[64:67]
    ds_read_b64_tr_b16 v[194:195], v8 offset:4704
    s_cmp_eq_u32 s96, 147456
    s_cselect_b32 s96, 0, s96
    v_mfma_f32_16x16x32_bf16 v[68:71], v[204:207], a[148:151], v[68:71]
    buffer_load_dwordx4 a[236:239], v13, s[28:31], s79 offen offset:2048 sc1
    v_mfma_f32_16x16x32_bf16 v[68:71], v[200:203], a[132:135], v[68:71]
    buffer_load_dwordx4 a[240:243], v10, s[28:31], s79 offen offset:3072 sc1
    v_mfma_f32_16x16x32_bf16 v[72:75], v[200:203], a[136:139], v[72:75]
    ds_read_b64_tr_b16 v[196:197], v8 offset:9312
    v_add_u32 v9, s96, v5
    v_lshrrev_b32 v14, 8, v1
    v_mfma_f32_16x16x32_bf16 v[72:75], v[204:207], a[152:155], v[72:75]
    ds_read_b64_tr_b16 v[198:199], v8 offset:13920
    s_waitcnt lgkmcnt(4)
    v_mfma_f32_16x16x32_bf16 v[76:79], v[204:207], a[156:159], v[76:79]
    buffer_load_dwordx4 a[244:247], v11, s[28:31], s79 offen offset:3072 sc1
    v_mfma_f32_16x16x32_bf16 v[76:79], v[200:203], a[140:143], v[76:79]
    buffer_load_dwordx4 a[248:251], v12, s[28:31], s79 offen offset:3072 sc1
    v_mfma_f32_16x16x32_bf16 v[80:83], v[208:211], a[128:131], v[80:83]
    ds_read_b64_tr_b16 v[200:201], v8 offset:128
    s_add_u32 s96, s96, 36864
    v_mfma_f32_16x16x32_bf16 v[80:83], v[212:215], a[144:147], v[80:83]
    ds_read_b64_tr_b16 v[202:203], v8 offset:4736
    s_cmp_eq_u32 s96, 147456
    s_cselect_b32 s96, 0, s96
    v_bfe_u32 v46, v1, 6, 2
    v_mfma_f32_16x16x32_bf16 v[84:87], v[212:215], a[148:151], v[84:87]
    buffer_load_dwordx4 a[252:255], v13, s[28:31], s79 offen offset:3072 sc1
    v_mfma_f32_16x16x32_bf16 v[84:87], v[208:211], a[132:135], v[84:87]
    s_add_u32 s72, s5, 7
    s_xor_b32 s72, s72, s85
    s_lshl_b32 s72, s72, 12
    s_add_u32 s86, s72, s80
    v_mfma_f32_16x16x32_bf16 v[88:91], v[208:211], a[136:139], v[88:91]
    ds_read_b64_tr_b16 v[204:205], v8 offset:9344
    v_add_u32 v250, s96, v5
    v_mfma_f32_16x16x32_bf16 v[88:91], v[212:215], a[152:155], v[88:91]
    ds_read_b64_tr_b16 v[206:207], v8 offset:13952
    s_waitcnt lgkmcnt(4)
    v_mfma_f32_16x16x32_bf16 v[92:95], v[212:215], a[156:159], v[92:95]
    buffer_load_dwordx4 a[0:3], v10, s[28:31], s86 offen offset:0 sc1
    v_mfma_f32_16x16x32_bf16 v[92:95], v[208:211], a[140:143], v[92:95]
    buffer_load_dwordx4 a[4:7], v11, s[28:31], s86 offen offset:0 sc1
    v_mfma_f32_16x16x32_bf16 v[96:99], v[192:195], a[128:131], v[96:99]
    ds_read_b64_tr_b16 v[208:209], v8 offset:160
    v_cmp_eq_u32 vcc, v46, v14
    v_mov_b32 v26, 0x3f80
    v_and_b32 v46, 16, v1
    v_lshlrev_b32 v26, v46, v26
    v_cndmask_b32 v26, 0, v26, vcc
    v_mfma_f32_16x16x32_bf16 v[96:99], v[196:199], a[144:147], v[96:99]
    ds_read_b64_tr_b16 v[210:211], v8 offset:4768
    v_mfma_f32_16x16x32_bf16 v[100:103], v[196:199], a[148:151], v[100:103]
    buffer_load_dwordx4 a[8:11], v12, s[28:31], s86 offen offset:0 sc1
    v_mfma_f32_16x16x32_bf16 v[100:103], v[192:195], a[132:135], v[100:103]
    buffer_load_dwordx4 a[12:15], v13, s[28:31], s86 offen offset:0 sc1
    v_mfma_f32_16x16x32_bf16 v[104:107], v[192:195], a[136:139], v[104:107]
    ds_read_b64_tr_b16 v[212:213], v8 offset:9376
    v_mfma_f32_16x16x32_bf16 v[104:107], v[196:199], a[152:155], v[104:107]
    ds_read_b64_tr_b16 v[214:215], v8 offset:13984
    s_waitcnt lgkmcnt(4)
    v_mfma_f32_16x16x32_bf16 v[108:111], v[196:199], a[156:159], v[108:111]
    buffer_load_dwordx4 a[16:19], v10, s[28:31], s86 offen offset:1024 sc1
    v_mfma_f32_16x16x32_bf16 v[108:111], v[192:195], a[140:143], v[108:111]
    v_and_b32 v46, 32, v1
    v_cmp_eq_u32 vcc, 0, v46
    s_nop 1
    v_cndmask_b32 v28, 0, v26, vcc
    v_cndmask_b32 v29, v26, 0, vcc
    v_mfma_f32_16x16x32_bf16 v[112:115], v[200:203], a[128:131], v[112:115]
    ds_read_b64_tr_b16 v[192:193], v8 offset:192
    v_mov_b32 v26, 0
    v_mfma_f32_16x16x32_bf16 v[112:115], v[204:207], a[144:147], v[112:115]
    ds_read_b64_tr_b16 v[194:195], v8 offset:4800
    v_mfma_f32_16x16x32_bf16 v[116:119], v[204:207], a[148:151], v[116:119]
    buffer_load_dwordx4 a[20:23], v11, s[28:31], s86 offen offset:1024 sc1
    v_mfma_f32_16x16x32_bf16 v[116:119], v[200:203], a[132:135], v[116:119]
    buffer_load_dwordx4 a[24:27], v12, s[28:31], s86 offen offset:1024 sc1
    v_mfma_f32_16x16x32_bf16 v[120:123], v[200:203], a[136:139], v[120:123]
    ds_read_b64_tr_b16 v[196:197], v8 offset:9408
    v_mov_b32 v27, 0
    v_mfma_f32_16x16x32_bf16 v[120:123], v[204:207], a[152:155], v[120:123]
    ds_read_b64_tr_b16 v[198:199], v8 offset:14016
    s_waitcnt lgkmcnt(4)
    v_mfma_f32_16x16x32_bf16 v[124:127], v[204:207], a[156:159], v[124:127]
    buffer_load_dwordx4 a[28:31], v13, s[28:31], s86 offen offset:1024 sc1
    v_mfma_f32_16x16x32_bf16 v[124:127], v[200:203], a[140:143], v[124:127]
    buffer_load_dwordx4 a[32:35], v10, s[28:31], s86 offen offset:2048 sc1
    v_mfma_f32_16x16x32_bf16 v[128:131], v[208:211], a[128:131], v[128:131]
    ds_read_b64_tr_b16 v[200:201], v8 offset:224
    v_mov_b32 v30, 0
    v_mfma_f32_16x16x32_bf16 v[128:131], v[212:215], a[144:147], v[128:131]
    ds_read_b64_tr_b16 v[202:203], v8 offset:4832
    v_mfma_f32_16x16x32_bf16 v[132:135], v[212:215], a[148:151], v[132:135]
    buffer_load_dwordx4 a[36:39], v11, s[28:31], s86 offen offset:2048 sc1
    v_mfma_f32_16x16x32_bf16 v[132:135], v[208:211], a[132:135], v[132:135]
    buffer_load_dwordx4 a[40:43], v12, s[28:31], s86 offen offset:2048 sc1
    v_mfma_f32_16x16x32_bf16 v[136:139], v[208:211], a[136:139], v[136:139]
    ds_read_b64_tr_b16 v[204:205], v8 offset:9440
    v_mfma_f32_16x16x32_bf16 v[136:139], v[212:215], a[152:155], v[136:139]
    ds_read_b64_tr_b16 v[206:207], v8 offset:14048
    s_waitcnt lgkmcnt(4)
    v_mfma_f32_16x16x32_bf16 v[140:143], v[212:215], a[156:159], v[140:143]
    s_waitcnt vmcnt(22)
    s_barrier
    v_mfma_f32_16x16x32_bf16 v[140:143], v[208:211], a[140:143], v[140:143]
    buffer_load_dwordx4 a[44:47], v13, s[28:31], s86 offen offset:2048 sc1
    v_mfma_f32_16x16x32_bf16 v[144:147], v[192:195], a[128:131], v[144:147]
    ds_read_b64_tr_b16 v[208:209], v8 offset:256
    buffer_load_dwordx4 a[48:51], v10, s[28:31], s86 offen offset:3072 sc1
    v_mfma_f32_16x16x32_bf16 v[144:147], v[196:199], a[144:147], v[144:147]
    ds_read_b64_tr_b16 v[210:211], v8 offset:4864
    v_mov_b32 v31, 0
    v_mfma_f32_16x16x32_bf16 v[148:151], v[196:199], a[148:151], v[148:151]
    buffer_load_dwordx4 a[52:55], v11, s[28:31], s86 offen offset:3072 sc1
    v_mfma_f32_16x16x32_bf16 v[148:151], v[192:195], a[132:135], v[148:151]
    buffer_load_dwordx4 a[56:59], v12, s[28:31], s86 offen offset:3072 sc1
    v_mfma_f32_16x16x32_bf16 v[152:155], v[192:195], a[136:139], v[152:155]
    ds_read_b64_tr_b16 v[212:213], v8 offset:9472
    v_mov_b32 v32, v28
    v_mfma_f32_16x16x32_bf16 v[152:155], v[196:199], a[152:155], v[152:155]
    ds_read_b64_tr_b16 v[214:215], v8 offset:14080
    s_waitcnt lgkmcnt(4)
    v_mfma_f32_16x16x32_bf16 v[156:159], v[196:199], a[156:159], v[156:159]
    buffer_load_dwordx4 a[60:63], v13, s[28:31], s86 offen offset:3072 sc1
    v_mfma_f32_16x16x32_bf16 v[156:159], v[192:195], a[140:143], v[156:159]
    v_mov_b32 v33, v29
    v_mfma_f32_16x16x32_bf16 v[160:163], v[200:203], a[128:131], v[160:163]
    ds_read_b64_tr_b16 v[192:193], v8 offset:18688
    v_mfma_f32_16x16x32_bf16 v[160:163], v[204:207], a[144:147], v[160:163]
    ds_read_b64_tr_b16 v[194:195], v8 offset:23296
    v_mfma_f32_16x16x32_bf16 v[164:167], v[204:207], a[148:151], v[164:167]
    s_and_b32 s82, s64, 3
    s_mul_i32 s73, s82, 5120
    v_mfma_f32_16x16x32_bf16 v[164:167], v[200:203], a[132:135], v[164:167]
    v_mov_b32 v34, v28
    v_mfma_f32_16x16x32_bf16 v[168:171], v[200:203], a[136:139], v[168:171]
    ds_read_b64_tr_b16 v[196:197], v8 offset:27904
    v_mfma_f32_16x16x32_bf16 v[168:171], v[204:207], a[152:155], v[168:171]
    ds_read_b64_tr_b16 v[198:199], v8 offset:32512
    s_waitcnt lgkmcnt(4)
    v_mfma_f32_16x16x32_bf16 v[172:175], v[204:207], a[156:159], v[172:175]
    s_add_u32 s78, s78, s73
    s_lshl_b32 s73, s5, 10
    v_mfma_f32_16x16x32_bf16 v[172:175], v[200:203], a[140:143], v[172:175]
    v_mfma_f32_16x16x32_bf16 v[176:179], v[208:211], a[128:131], v[176:179]
    ds_read_b64_tr_b16 v[200:201], v9 offset:256
    v_mov_b32 v35, v29
    v_mfma_f32_16x16x32_bf16 v[176:179], v[212:215], a[144:147], v[176:179]
    ds_read_b64_tr_b16 v[202:203], v9 offset:4864
    v_mfma_f32_16x16x32_bf16 v[180:183], v[212:215], a[148:151], v[180:183]
    s_add_u32 s85, s78, s73
    v_mfma_f32_16x16x32_bf16 v[180:183], v[208:211], a[132:135], v[180:183]
    v_mfma_f32_16x16x32_bf16 v[184:187], v[208:211], a[136:139], v[184:187]
    ds_read_b64_tr_b16 v[204:205], v9 offset:9472
    s_waitcnt vmcnt(24)
    v_mfma_f32_16x16x32_bf16 v[184:187], v[212:215], a[152:155], v[184:187]
    ds_read_b64_tr_b16 v[206:207], v9 offset:14080
    s_waitcnt lgkmcnt(4)
    v_mfma_f32_16x16x32_bf16 v[188:191], v[212:215], a[156:159], v[188:191]
    v_mul_u32_u24 v25, 1152, v25
    v_mfma_f32_16x16x32_bf16 v[188:191], v[208:211], a[140:143], v[188:191]
    s_lshl_b32 s73, s71, 1
    s_xor_b32 s82, s82, s73
    v_mfma_f32_16x16x32_bf16 v[188:191], v[192:195], a[172:175], v[188:191]
    ds_read_b64_tr_b16 v[208:209], v9 offset:18688
    v_mfma_f32_16x16x32_bf16 v[188:191], v[196:199], a[188:191], v[188:191]
    ds_read_b64_tr_b16 v[210:211], v9 offset:23296
    v_lshl_add_u32 v25, v14, 3, v25
    v_mfma_f32_16x16x32_bf16 v[184:187], v[196:199], a[184:187], v[184:187]
    v_mfma_f32_16x16x32_bf16 v[184:187], v[192:195], a[168:171], v[184:187]
    v_mfma_f32_16x16x32_bf16 v[180:183], v[192:195], a[164:167], v[180:183]
    ds_read_b64_tr_b16 v[212:213], v9 offset:27904
    v_mfma_f32_16x16x32_bf16 v[180:183], v[196:199], a[180:183], v[180:183]
    ds_read_b64_tr_b16 v[214:215], v9 offset:32512
    s_waitcnt lgkmcnt(4)
    v_mfma_f32_16x16x32_bf16 v[176:179], v[196:199], a[176:179], v[176:179]
    s_add_u32 s82, s82, s69
    s_mul_i32 s83, s82, 18432
    v_lshrrev_b32 v46, 1, v1
    v_mfma_f32_16x16x32_bf16 v[176:179], v[192:195], a[160:163], v[176:179]
    v_mfma_f32_16x16x32_bf16 v[176:179], v[200:203], a[192:195], v[176:179]
    ds_read_b64_tr_b16 v[192:193], v250 offset:256
    v_mfma_f32_16x16x32_bf16 v[176:179], v[204:207], a[208:211], v[176:179]
    ds_read_b64_tr_b16 v[194:195], v250 offset:4864
    v_mfma_f32_16x16x32_bf16 v[180:183], v[204:207], a[212:215], v[180:183]
    s_mul_i32 s73, s65, 288
    s_add_u32 s87, s83, s73
    v_mfma_f32_16x16x32_bf16 v[180:183], v[200:203], a[196:199], v[180:183]
    v_add_u32 v46, 4096, v46
    v_mfma_f32_16x16x32_bf16 v[184:187], v[200:203], a[200:203], v[184:187]
    ds_read_b64_tr_b16 v[196:197], v250 offset:9472
    s_waitcnt vmcnt(16)
    v_mfma_f32_16x16x32_bf16 v[184:187], v[204:207], a[216:219], v[184:187]
    ds_read_b64_tr_b16 v[198:199], v250 offset:14080
    s_waitcnt lgkmcnt(4)
    v_mfma_f32_16x16x32_bf16 v[188:191], v[204:207], a[220:223], v[188:191]
    v_mfma_f32_16x16x32_bf16 v[188:191], v[200:203], a[204:207], v[188:191]
    s_lshl_b32 s73, s5, 6
    s_add_u32 s83, s87, s73
    v_lshlrev_b32 v14, 7, v1
    v_mfma_f32_16x16x32_bf16 v[188:191], v[208:211], a[236:239], v[188:191]
    ds_read_b64_tr_b16 v[200:201], v250 offset:18688
    v_mfma_f32_16x16x32_bf16 v[188:191], v[212:215], a[252:255], v[188:191]
    ds_read_b64_tr_b16 v[202:203], v250 offset:23296
    v_mfma_f32_16x16x32_bf16 v[184:187], v[212:215], a[248:251], v[184:187]
    v_mfma_f32_16x16x32_bf16 v[184:187], v[208:211], a[232:235], v[184:187]
    v_mfma_f32_16x16x32_bf16 v[180:183], v[208:211], a[228:231], v[180:183]
    ds_read_b64_tr_b16 v[204:205], v250 offset:27904
    s_waitcnt vmcnt(0)
    v_mfma_f32_16x16x32_bf16 v[180:183], v[212:215], a[244:247], v[180:183]
    ds_read_b64_tr_b16 v[206:207], v250 offset:32512
    s_waitcnt lgkmcnt(4)
    v_mfma_f32_16x16x32_bf16 v[176:179], v[212:215], a[240:243], v[176:179]
    s_mov_b32 s12, s56
    s_mov_b32 s13, s57
    v_bfe_u32 v248, v1, 4, 3
    v_mfma_f32_16x16x32_bf16 v[176:179], v[208:211], a[224:227], v[176:179]
    v_mfma_f32_16x16x32_bf16 v[176:179], v[192:195], a[0:3], v[176:179]
    ds_read_b64_tr_b16 v[208:209], v8 offset:18432
    v_mfma_f32_16x16x32_bf16 v[176:179], v[196:199], a[16:19], v[176:179]
    ds_read_b64_tr_b16 v[210:211], v8 offset:23040
    s_mov_b32 s14, 2359296
    v_mfma_f32_16x16x32_bf16 v[180:183], v[196:199], a[20:23], v[180:183]
    v_lshlrev_b32 v248, 2, v248
    v_mfma_f32_16x16x32_bf16 v[180:183], v[192:195], a[4:7], v[180:183]
    v_mfma_f32_16x16x32_bf16 v[184:187], v[192:195], a[8:11], v[184:187]
    ds_read_b64_tr_b16 v[212:213], v8 offset:27648
    v_mfma_f32_16x16x32_bf16 v[184:187], v[196:199], a[24:27], v[184:187]
    ds_read_b64_tr_b16 v[214:215], v8 offset:32256
    s_waitcnt lgkmcnt(4)
    v_mfma_f32_16x16x32_bf16 v[188:191], v[196:199], a[28:31], v[188:191]
    s_mov_b32 s88, 0xbfb8aa3b
    s_mov_b32 s89, 0xffff0000
    v_mfma_f32_16x16x32_bf16 v[188:191], v[192:195], a[12:15], v[188:191]
    v_mfma_f32_16x16x32_bf16 v[188:191], v[200:203], a[44:47], v[188:191]
    ds_read_b64_tr_b16 v[192:193], v9 offset:0
    v_mfma_f32_16x16x32_bf16 v[188:191], v[204:207], a[60:63], v[188:191]
    ds_read_b64_tr_b16 v[194:195], v9 offset:4608
    v_mfma_f32_16x16x32_bf16 v[184:187], v[204:207], a[56:59], v[184:187]
    v_mfma_f32_16x16x32_bf16 v[184:187], v[200:203], a[40:43], v[184:187]
    v_mfma_f32_16x16x32_bf16 v[180:183], v[200:203], a[36:39], v[180:183]
    ds_read_b64_tr_b16 v[196:197], v9 offset:9216
    v_mfma_f32_16x16x32_bf16 v[180:183], v[204:207], a[52:55], v[180:183]
    ds_read_b64_tr_b16 v[198:199], v9 offset:13824
    s_waitcnt lgkmcnt(4)
    v_mfma_f32_16x16x32_bf16 v[176:179], v[204:207], a[48:51], v[176:179]
    buffer_load_dwordx2 v[36:37], v25, s[32:35], s83 offen offset:0
    v_mfma_f32_16x16x32_bf16 v[176:179], v[200:203], a[32:35], v[176:179]
    v_mfma_f32_16x16x32_bf16 v[48:51], v[208:211], a[160:163], v[48:51]
    ds_read_b64_tr_b16 v[200:201], v9 offset:18432
    v_mfma_f32_16x16x32_bf16 v[48:51], v[212:215], a[176:179], v[48:51]
    ds_read_b64_tr_b16 v[202:203], v9 offset:23040
    v_mfma_f32_16x16x32_bf16 v[52:55], v[212:215], a[180:183], v[52:55]
    v_mfma_f32_16x16x32_bf16 v[52:55], v[208:211], a[164:167], v[52:55]
    v_mfma_f32_16x16x32_bf16 v[56:59], v[208:211], a[168:171], v[56:59]
    ds_read_b64_tr_b16 v[204:205], v9 offset:27648
    v_cvt_pk_bf16_f32 v176, v176, v177
    v_mfma_f32_16x16x32_bf16 v[56:59], v[212:215], a[184:187], v[56:59]
    ds_read_b64_tr_b16 v[206:207], v9 offset:32256
    s_waitcnt lgkmcnt(4)
    v_mfma_f32_16x16x32_bf16 v[60:63], v[212:215], a[188:191], v[60:63]
    buffer_load_dwordx2 v[38:39], v25, s[32:35], s83 offen offset:32
    v_mfma_f32_16x16x32_bf16 v[60:63], v[208:211], a[172:175], v[60:63]
    v_mfma_f32_16x16x32_bf16 v[60:63], v[192:195], a[204:207], v[60:63]
    ds_read_b64_tr_b16 v[208:209], v250 offset:0
    v_mfma_f32_16x16x32_bf16 v[60:63], v[196:199], a[220:223], v[60:63]
    ds_read_b64_tr_b16 v[210:211], v250 offset:4608
    v_mfma_f32_16x16x32_bf16 v[56:59], v[196:199], a[216:219], v[56:59]
    buffer_load_dwordx2 v[40:41], v25, s[32:35], s83 offen offset:128
    v_mfma_f32_16x16x32_bf16 v[56:59], v[192:195], a[200:203], v[56:59]
    v_cvt_pk_bf16_f32 v177, v178, v179
    v_mfma_f32_16x16x32_bf16 v[52:55], v[192:195], a[196:199], v[52:55]
    ds_read_b64_tr_b16 v[212:213], v250 offset:9216
    v_mfma_f32_16x16x32_bf16 v[52:55], v[196:199], a[212:215], v[52:55]
    ds_read_b64_tr_b16 v[214:215], v250 offset:13824
    s_waitcnt lgkmcnt(4)
    v_mfma_f32_16x16x32_bf16 v[48:51], v[196:199], a[208:211], v[48:51]
    v_mfma_f32_16x16x32_bf16 v[48:51], v[192:195], a[192:195], v[48:51]
    v_mfma_f32_16x16x32_bf16 v[48:51], v[200:203], a[224:227], v[48:51]
    ds_read_b64_tr_b16 v[192:193], v250 offset:18432
    v_mfma_f32_16x16x32_bf16 v[48:51], v[204:207], a[240:243], v[48:51]
    ds_read_b64_tr_b16 v[194:195], v250 offset:23040
    v_mfma_f32_16x16x32_bf16 v[52:55], v[204:207], a[244:247], v[52:55]
    buffer_load_dwordx2 v[42:43], v25, s[32:35], s83 offen offset:160
    v_mfma_f32_16x16x32_bf16 v[52:55], v[200:203], a[228:231], v[52:55]
    buffer_store_dwordx2 v[176:177], v46, s[16:19], s74 offen sc1
    v_mfma_f32_16x16x32_bf16 v[56:59], v[200:203], a[232:235], v[56:59]
    ds_read_b64_tr_b16 v[196:197], v250 offset:27648
    v_mfma_f32_16x16x32_bf16 v[56:59], v[204:207], a[248:251], v[56:59]
    ds_read_b64_tr_b16 v[198:199], v250 offset:32256
    s_waitcnt lgkmcnt(4)
    v_mfma_f32_16x16x32_bf16 v[60:63], v[204:207], a[252:255], v[60:63]
    v_cvt_pk_bf16_f32 v180, v180, v181
    v_mfma_f32_16x16x32_bf16 v[60:63], v[200:203], a[236:239], v[60:63]
    buffer_load_dwordx2 v[44:45], v25, s[32:35], s87 offen offset:256
    v_mfma_f32_16x16x32_bf16 v[60:63], v[208:211], a[12:15], v[60:63]
    ds_read_b64_tr_b16 v[200:201], v8 offset:18464
    v_mfma_f32_16x16x32_bf16 v[60:63], v[212:215], a[28:31], v[60:63]
    ds_read_b64_tr_b16 v[202:203], v8 offset:23072
    v_mfma_f32_16x16x32_bf16 v[56:59], v[212:215], a[24:27], v[56:59]
    v_mfma_f32_16x16x32_bf16 v[56:59], v[208:211], a[8:11], v[56:59]
    v_mfma_f32_16x16x32_bf16 v[52:55], v[208:211], a[4:7], v[52:55]
    ds_read_b64_tr_b16 v[204:205], v8 offset:27680
    v_cvt_pk_bf16_f32 v181, v182, v183
    v_mfma_f32_16x16x32_bf16 v[52:55], v[212:215], a[20:23], v[52:55]
    ds_read_b64_tr_b16 v[206:207], v8 offset:32288
    s_waitcnt lgkmcnt(4)
    v_mfma_f32_16x16x32_bf16 v[48:51], v[212:215], a[16:19], v[48:51]
    buffer_load_dword v249, v248, s[16:19], s37 offen sc1
    v_mfma_f32_16x16x32_bf16 v[48:51], v[208:211], a[0:3], v[48:51]
    v_mfma_f32_16x16x32_bf16 v[48:51], v[192:195], a[32:35], v[48:51]
    ds_read_b64_tr_b16 v[208:209], v9 offset:32
    v_mfma_f32_16x16x32_bf16 v[48:51], v[196:199], a[48:51], v[48:51]
    ds_read_b64_tr_b16 v[210:211], v9 offset:4640
    v_mfma_f32_16x16x32_bf16 v[52:55], v[196:199], a[52:55], v[52:55]
    buffer_store_dwordx2 v[180:181], v46, s[16:19], s75 offen sc1
    v_mfma_f32_16x16x32_bf16 v[52:55], v[192:195], a[36:39], v[52:55]
    v_mfma_f32_16x16x32_bf16 v[56:59], v[192:195], a[40:43], v[56:59]
    ds_read_b64_tr_b16 v[212:213], v9 offset:9248
    v_mfma_f32_16x16x32_bf16 v[56:59], v[196:199], a[56:59], v[56:59]
    ds_read_b64_tr_b16 v[214:215], v9 offset:13856
    s_waitcnt lgkmcnt(4)
    v_mfma_f32_16x16x32_bf16 v[60:63], v[196:199], a[60:63], v[60:63]
    v_mfma_f32_16x16x32_bf16 v[60:63], v[192:195], a[44:47], v[60:63]
    v_mfma_f32_16x16x32_bf16 v[64:67], v[200:203], a[160:163], v[64:67]
    ds_read_b64_tr_b16 v[192:193], v9 offset:18464
    v_cvt_pk_bf16_f32 v184, v184, v185
    v_mfma_f32_16x16x32_bf16 v[64:67], v[204:207], a[176:179], v[64:67]
    ds_read_b64_tr_b16 v[194:195], v9 offset:23072
    v_mfma_f32_16x16x32_bf16 v[68:71], v[204:207], a[180:183], v[68:71]
    v_mfma_f32_16x16x32_bf16 v[68:71], v[200:203], a[164:167], v[68:71]
    v_mfma_f32_16x16x32_bf16 v[72:75], v[200:203], a[168:171], v[72:75]
    ds_read_b64_tr_b16 v[196:197], v9 offset:27680
    v_mfma_f32_16x16x32_bf16 v[72:75], v[204:207], a[184:187], v[72:75]
    ds_read_b64_tr_b16 v[198:199], v9 offset:32288
    s_waitcnt lgkmcnt(4)
    v_mfma_f32_16x16x32_bf16 v[76:79], v[204:207], a[188:191], v[76:79]
    v_cvt_pk_bf16_f32 v185, v186, v187
    v_mfma_f32_16x16x32_bf16 v[76:79], v[200:203], a[172:175], v[76:79]
    v_mfma_f32_16x16x32_bf16 v[76:79], v[208:211], a[204:207], v[76:79]
    ds_read_b64_tr_b16 v[200:201], v250 offset:32
    v_mfma_f32_16x16x32_bf16 v[76:79], v[212:215], a[220:223], v[76:79]
    ds_read_b64_tr_b16 v[202:203], v250 offset:4640
    v_mfma_f32_16x16x32_bf16 v[72:75], v[212:215], a[216:219], v[72:75]
    v_mfma_f32_16x16x32_bf16 v[72:75], v[208:211], a[200:203], v[72:75]
    v_mfma_f32_16x16x32_bf16 v[68:71], v[208:211], a[196:199], v[68:71]
    ds_read_b64_tr_b16 v[204:205], v250 offset:9248
    v_mfma_f32_16x16x32_bf16 v[68:71], v[212:215], a[212:215], v[68:71]
    ds_read_b64_tr_b16 v[206:207], v250 offset:13856
    s_waitcnt lgkmcnt(4)
    v_mfma_f32_16x16x32_bf16 v[64:67], v[212:215], a[208:211], v[64:67]
    buffer_store_dwordx2 v[184:185], v46, s[16:19], s76 offen sc1
    v_mfma_f32_16x16x32_bf16 v[64:67], v[208:211], a[192:195], v[64:67]
    v_mfma_f32_16x16x32_bf16 v[64:67], v[192:195], a[224:227], v[64:67]
    ds_read_b64_tr_b16 v[208:209], v250 offset:18464
    v_mfma_f32_16x16x32_bf16 v[64:67], v[196:199], a[240:243], v[64:67]
    ds_read_b64_tr_b16 v[210:211], v250 offset:23072
    v_mfma_f32_16x16x32_bf16 v[68:71], v[196:199], a[244:247], v[68:71]
    v_cvt_pk_bf16_f32 v188, v188, v189
    v_mfma_f32_16x16x32_bf16 v[68:71], v[192:195], a[228:231], v[68:71]
    v_mfma_f32_16x16x32_bf16 v[72:75], v[192:195], a[232:235], v[72:75]
    ds_read_b64_tr_b16 v[212:213], v250 offset:27680
    v_mfma_f32_16x16x32_bf16 v[72:75], v[196:199], a[248:251], v[72:75]
    ds_read_b64_tr_b16 v[214:215], v250 offset:32288
    s_waitcnt lgkmcnt(4)
    v_mfma_f32_16x16x32_bf16 v[76:79], v[196:199], a[252:255], v[76:79]
    v_mfma_f32_16x16x32_bf16 v[76:79], v[192:195], a[236:239], v[76:79]
    v_mfma_f32_16x16x32_bf16 v[76:79], v[200:203], a[12:15], v[76:79]
    ds_read_b64_tr_b16 v[192:193], v8 offset:18496
    v_cvt_pk_bf16_f32 v189, v190, v191
    v_mfma_f32_16x16x32_bf16 v[76:79], v[204:207], a[28:31], v[76:79]
    ds_read_b64_tr_b16 v[194:195], v8 offset:23104
    v_mfma_f32_16x16x32_bf16 v[72:75], v[204:207], a[24:27], v[72:75]
    v_mfma_f32_16x16x32_bf16 v[72:75], v[200:203], a[8:11], v[72:75]
    v_mfma_f32_16x16x32_bf16 v[68:71], v[200:203], a[4:7], v[68:71]
    ds_read_b64_tr_b16 v[196:197], v8 offset:27712
    v_mfma_f32_16x16x32_bf16 v[68:71], v[204:207], a[20:23], v[68:71]
    ds_read_b64_tr_b16 v[198:199], v8 offset:32320
    s_waitcnt lgkmcnt(4)
    v_mfma_f32_16x16x32_bf16 v[64:67], v[204:207], a[16:19], v[64:67]
    buffer_store_dwordx2 v[188:189], v46, s[16:19], s77 offen sc1
    v_mfma_f32_16x16x32_bf16 v[64:67], v[200:203], a[0:3], v[64:67]
    v_mfma_f32_16x16x32_bf16 v[64:67], v[208:211], a[32:35], v[64:67]
    ds_read_b64_tr_b16 v[200:201], v9 offset:64
    v_mfma_f32_16x16x32_bf16 v[64:67], v[212:215], a[48:51], v[64:67]
    ds_read_b64_tr_b16 v[202:203], v9 offset:4672
    v_mfma_f32_16x16x32_bf16 v[68:71], v[212:215], a[52:55], v[68:71]
    v_mfma_f32_16x16x32_bf16 v[68:71], v[208:211], a[36:39], v[68:71]
    v_mfma_f32_16x16x32_bf16 v[72:75], v[208:211], a[40:43], v[72:75]
    ds_read_b64_tr_b16 v[204:205], v9 offset:9280
    v_mfma_f32_16x16x32_bf16 v[72:75], v[212:215], a[56:59], v[72:75]
    ds_read_b64_tr_b16 v[206:207], v9 offset:13888
    s_waitcnt lgkmcnt(4)
    v_mfma_f32_16x16x32_bf16 v[76:79], v[212:215], a[60:63], v[76:79]
    v_mfma_f32_16x16x32_bf16 v[76:79], v[208:211], a[44:47], v[76:79]
    v_mfma_f32_16x16x32_bf16 v[80:83], v[192:195], a[160:163], v[80:83]
    ds_read_b64_tr_b16 v[208:209], v9 offset:18496
    v_mfma_f32_16x16x32_bf16 v[80:83], v[196:199], a[176:179], v[80:83]
    ds_read_b64_tr_b16 v[210:211], v9 offset:23104
    v_mfma_f32_16x16x32_bf16 v[84:87], v[196:199], a[180:183], v[84:87]
    v_mfma_f32_16x16x32_bf16 v[84:87], v[192:195], a[164:167], v[84:87]
    v_mfma_f32_16x16x32_bf16 v[88:91], v[192:195], a[168:171], v[88:91]
    ds_read_b64_tr_b16 v[212:213], v9 offset:27712
    v_cvt_pk_bf16_f32 v48, v48, v49
    v_mfma_f32_16x16x32_bf16 v[88:91], v[196:199], a[184:187], v[88:91]
    ds_read_b64_tr_b16 v[214:215], v9 offset:32320
    s_waitcnt lgkmcnt(4)
    v_mfma_f32_16x16x32_bf16 v[92:95], v[196:199], a[188:191], v[92:95]
    v_mfma_f32_16x16x32_bf16 v[92:95], v[192:195], a[172:175], v[92:95]
    v_cvt_pk_bf16_f32 v49, v50, v51
    v_mfma_f32_16x16x32_bf16 v[92:95], v[200:203], a[204:207], v[92:95]
    ds_read_b64_tr_b16 v[192:193], v250 offset:64
    v_mfma_f32_16x16x32_bf16 v[92:95], v[204:207], a[220:223], v[92:95]
    ds_read_b64_tr_b16 v[194:195], v250 offset:4672
    v_mfma_f32_16x16x32_bf16 v[88:91], v[204:207], a[216:219], v[88:91]
    v_mfma_f32_16x16x32_bf16 v[88:91], v[200:203], a[200:203], v[88:91]
    v_cvt_pk_bf16_f32 v50, v64, v65
    v_mfma_f32_16x16x32_bf16 v[84:87], v[200:203], a[196:199], v[84:87]
    ds_read_b64_tr_b16 v[196:197], v250 offset:9280
    v_mfma_f32_16x16x32_bf16 v[84:87], v[204:207], a[212:215], v[84:87]
    ds_read_b64_tr_b16 v[198:199], v250 offset:13888
    s_waitcnt lgkmcnt(4)
    v_mfma_f32_16x16x32_bf16 v[80:83], v[204:207], a[208:211], v[80:83]
    v_cvt_pk_bf16_f32 v51, v66, v67
    v_mfma_f32_16x16x32_bf16 v[80:83], v[200:203], a[192:195], v[80:83]
    v_mfma_f32_16x16x32_bf16 v[80:83], v[208:211], a[224:227], v[80:83]
    ds_read_b64_tr_b16 v[200:201], v250 offset:18496
    v_mfma_f32_16x16x32_bf16 v[80:83], v[212:215], a[240:243], v[80:83]
    ds_read_b64_tr_b16 v[202:203], v250 offset:23104
    v_mfma_f32_16x16x32_bf16 v[84:87], v[212:215], a[244:247], v[84:87]
    buffer_store_dwordx4 v[48:51], v1, s[16:19], s74 offen offset:0 sc1
    v_mfma_f32_16x16x32_bf16 v[84:87], v[208:211], a[228:231], v[84:87]
    v_mfma_f32_16x16x32_bf16 v[88:91], v[208:211], a[232:235], v[88:91]
    ds_read_b64_tr_b16 v[204:205], v250 offset:27712
    v_mfma_f32_16x16x32_bf16 v[88:91], v[212:215], a[248:251], v[88:91]
    ds_read_b64_tr_b16 v[206:207], v250 offset:32320
    s_waitcnt lgkmcnt(4)
    v_mfma_f32_16x16x32_bf16 v[92:95], v[212:215], a[252:255], v[92:95]
    v_cvt_pk_bf16_f32 v52, v52, v53
    v_mfma_f32_16x16x32_bf16 v[92:95], v[208:211], a[236:239], v[92:95]
    v_mfma_f32_16x16x32_bf16 v[92:95], v[192:195], a[12:15], v[92:95]
    ds_read_b64_tr_b16 v[208:209], v8 offset:18528
    v_mfma_f32_16x16x32_bf16 v[92:95], v[196:199], a[28:31], v[92:95]
    ds_read_b64_tr_b16 v[210:211], v8 offset:23136
    v_cvt_pk_bf16_f32 v53, v54, v55
    v_mfma_f32_16x16x32_bf16 v[88:91], v[196:199], a[24:27], v[88:91]
    v_mfma_f32_16x16x32_bf16 v[88:91], v[192:195], a[8:11], v[88:91]
    v_mfma_f32_16x16x32_bf16 v[84:87], v[192:195], a[4:7], v[84:87]
    ds_read_b64_tr_b16 v[212:213], v8 offset:27744
    v_mfma_f32_16x16x32_bf16 v[84:87], v[196:199], a[20:23], v[84:87]
    ds_read_b64_tr_b16 v[214:215], v8 offset:32352
    s_waitcnt lgkmcnt(4)
    v_mfma_f32_16x16x32_bf16 v[80:83], v[196:199], a[16:19], v[80:83]
    v_cvt_pk_bf16_f32 v54, v68, v69
    v_mfma_f32_16x16x32_bf16 v[80:83], v[192:195], a[0:3], v[80:83]
    v_mfma_f32_16x16x32_bf16 v[80:83], v[200:203], a[32:35], v[80:83]
    ds_read_b64_tr_b16 v[192:193], v9 offset:96
    v_cvt_pk_bf16_f32 v55, v70, v71
    v_mfma_f32_16x16x32_bf16 v[80:83], v[204:207], a[48:51], v[80:83]
    ds_read_b64_tr_b16 v[194:195], v9 offset:4704
    v_mfma_f32_16x16x32_bf16 v[84:87], v[204:207], a[52:55], v[84:87]
    v_mfma_f32_16x16x32_bf16 v[84:87], v[200:203], a[36:39], v[84:87]
    v_mfma_f32_16x16x32_bf16 v[88:91], v[200:203], a[40:43], v[88:91]
    ds_read_b64_tr_b16 v[196:197], v9 offset:9312
    v_mfma_f32_16x16x32_bf16 v[88:91], v[204:207], a[56:59], v[88:91]
    ds_read_b64_tr_b16 v[198:199], v9 offset:13920
    s_waitcnt lgkmcnt(4)
    v_mfma_f32_16x16x32_bf16 v[92:95], v[204:207], a[60:63], v[92:95]
    buffer_store_dwordx4 v[52:55], v1, s[16:19], s75 offen offset:0 sc1
    v_mfma_f32_16x16x32_bf16 v[92:95], v[200:203], a[44:47], v[92:95]
    v_mfma_f32_16x16x32_bf16 v[96:99], v[208:211], a[160:163], v[96:99]
    ds_read_b64_tr_b16 v[200:201], v9 offset:18528
    v_cvt_pk_bf16_f32 v56, v56, v57
    v_mfma_f32_16x16x32_bf16 v[96:99], v[212:215], a[176:179], v[96:99]
    ds_read_b64_tr_b16 v[202:203], v9 offset:23136
    v_mfma_f32_16x16x32_bf16 v[100:103], v[212:215], a[180:183], v[100:103]
    v_mfma_f32_16x16x32_bf16 v[100:103], v[208:211], a[164:167], v[100:103]
    v_cvt_pk_bf16_f32 v57, v58, v59
    v_mfma_f32_16x16x32_bf16 v[104:107], v[208:211], a[168:171], v[104:107]
    ds_read_b64_tr_b16 v[204:205], v9 offset:27744
    v_mfma_f32_16x16x32_bf16 v[104:107], v[212:215], a[184:187], v[104:107]
    ds_read_b64_tr_b16 v[206:207], v9 offset:32352
    s_waitcnt lgkmcnt(4)
    v_mfma_f32_16x16x32_bf16 v[108:111], v[212:215], a[188:191], v[108:111]
    v_mfma_f32_16x16x32_bf16 v[108:111], v[208:211], a[172:175], v[108:111]
    v_cvt_pk_bf16_f32 v58, v72, v73
    v_mfma_f32_16x16x32_bf16 v[108:111], v[192:195], a[204:207], v[108:111]
    ds_read_b64_tr_b16 v[208:209], v250 offset:96
    v_mfma_f32_16x16x32_bf16 v[108:111], v[196:199], a[220:223], v[108:111]
    ds_read_b64_tr_b16 v[210:211], v250 offset:4704
    v_mfma_f32_16x16x32_bf16 v[104:107], v[196:199], a[216:219], v[104:107]
    v_cvt_pk_bf16_f32 v59, v74, v75
    v_mfma_f32_16x16x32_bf16 v[104:107], v[192:195], a[200:203], v[104:107]
    v_mfma_f32_16x16x32_bf16 v[100:103], v[192:195], a[196:199], v[100:103]
    ds_read_b64_tr_b16 v[212:213], v250 offset:9312
    v_mfma_f32_16x16x32_bf16 v[100:103], v[196:199], a[212:215], v[100:103]
    ds_read_b64_tr_b16 v[214:215], v250 offset:13920
    s_waitcnt lgkmcnt(4)
    v_mfma_f32_16x16x32_bf16 v[96:99], v[196:199], a[208:211], v[96:99]
    buffer_store_dwordx4 v[56:59], v1, s[16:19], s76 offen offset:0 sc1
    v_mfma_f32_16x16x32_bf16 v[96:99], v[192:195], a[192:195], v[96:99]
    v_mfma_f32_16x16x32_bf16 v[96:99], v[200:203], a[224:227], v[96:99]
    ds_read_b64_tr_b16 v[192:193], v250 offset:18528
    v_mfma_f32_16x16x32_bf16 v[96:99], v[204:207], a[240:243], v[96:99]
    ds_read_b64_tr_b16 v[194:195], v250 offset:23136
    v_mfma_f32_16x16x32_bf16 v[100:103], v[204:207], a[244:247], v[100:103]
    v_cvt_pk_bf16_f32 v60, v60, v61
    v_mfma_f32_16x16x32_bf16 v[100:103], v[200:203], a[228:231], v[100:103]
    v_mfma_f32_16x16x32_bf16 v[104:107], v[200:203], a[232:235], v[104:107]
    ds_read_b64_tr_b16 v[196:197], v250 offset:27744
    v_mfma_f32_16x16x32_bf16 v[104:107], v[204:207], a[248:251], v[104:107]
    ds_read_b64_tr_b16 v[198:199], v250 offset:32352
    s_waitcnt lgkmcnt(4)
    v_mfma_f32_16x16x32_bf16 v[108:111], v[204:207], a[252:255], v[108:111]
    v_cvt_pk_bf16_f32 v61, v62, v63
    v_mfma_f32_16x16x32_bf16 v[108:111], v[200:203], a[236:239], v[108:111]
    v_mfma_f32_16x16x32_bf16 v[108:111], v[208:211], a[12:15], v[108:111]
    ds_read_b64_tr_b16 v[200:201], v8 offset:18560
    v_mfma_f32_16x16x32_bf16 v[108:111], v[212:215], a[28:31], v[108:111]
    ds_read_b64_tr_b16 v[202:203], v8 offset:23168
    v_cvt_pk_bf16_f32 v62, v76, v77
    v_mfma_f32_16x16x32_bf16 v[104:107], v[212:215], a[24:27], v[104:107]
    v_mfma_f32_16x16x32_bf16 v[104:107], v[208:211], a[8:11], v[104:107]
    v_mfma_f32_16x16x32_bf16 v[100:103], v[208:211], a[4:7], v[100:103]
    ds_read_b64_tr_b16 v[204:205], v8 offset:27776
    v_cvt_pk_bf16_f32 v63, v78, v79
    v_mfma_f32_16x16x32_bf16 v[100:103], v[212:215], a[20:23], v[100:103]
    ds_read_b64_tr_b16 v[206:207], v8 offset:32384
    s_waitcnt lgkmcnt(4)
    v_mfma_f32_16x16x32_bf16 v[96:99], v[212:215], a[16:19], v[96:99]
    v_mfma_f32_16x16x32_bf16 v[96:99], v[208:211], a[0:3], v[96:99]
    v_mfma_f32_16x16x32_bf16 v[96:99], v[192:195], a[32:35], v[96:99]
    ds_read_b64_tr_b16 v[208:209], v9 offset:128
    v_mfma_f32_16x16x32_bf16 v[96:99], v[196:199], a[48:51], v[96:99]
    ds_read_b64_tr_b16 v[210:211], v9 offset:4736
    v_mfma_f32_16x16x32_bf16 v[100:103], v[196:199], a[52:55], v[100:103]
    buffer_store_dwordx4 v[60:63], v1, s[16:19], s77 offen offset:0 sc1
    v_mfma_f32_16x16x32_bf16 v[100:103], v[192:195], a[36:39], v[100:103]
    v_mfma_f32_16x16x32_bf16 v[104:107], v[192:195], a[40:43], v[104:107]
    ds_read_b64_tr_b16 v[212:213], v9 offset:9344
    v_mfma_f32_16x16x32_bf16 v[104:107], v[196:199], a[56:59], v[104:107]
    ds_read_b64_tr_b16 v[214:215], v9 offset:13952
    s_waitcnt lgkmcnt(4)
    v_mfma_f32_16x16x32_bf16 v[108:111], v[196:199], a[60:63], v[108:111]
    v_mfma_f32_16x16x32_bf16 v[108:111], v[192:195], a[44:47], v[108:111]
    v_mfma_f32_16x16x32_bf16 v[112:115], v[200:203], a[160:163], v[112:115]
    ds_read_b64_tr_b16 v[192:193], v9 offset:18560
    v_mfma_f32_16x16x32_bf16 v[112:115], v[204:207], a[176:179], v[112:115]
    ds_read_b64_tr_b16 v[194:195], v9 offset:23168
    v_mfma_f32_16x16x32_bf16 v[116:119], v[204:207], a[180:183], v[116:119]
    s_waitcnt vmcnt(7)
    v_cmp_ne_u32 vcc, v249, v7
    s_nop 0
    s_cbranch_vccnz KF_ck19
KF_cr20:
    v_mfma_f32_16x16x32_bf16 v[116:119], v[200:203], a[164:167], v[116:119]
    v_mfma_f32_16x16x32_bf16 v[120:123], v[200:203], a[168:171], v[120:123]
    ds_read_b64_tr_b16 v[196:197], v9 offset:27776
    v_cvt_pk_bf16_f32 v80, v80, v81
    v_mfma_f32_16x16x32_bf16 v[120:123], v[204:207], a[184:187], v[120:123]
    ds_read_b64_tr_b16 v[198:199], v9 offset:32384
    s_waitcnt lgkmcnt(4)
    v_mfma_f32_16x16x32_bf16 v[124:127], v[204:207], a[188:191], v[124:127]
    v_cvt_pk_bf16_f32 v81, v82, v83
    v_mfma_f32_16x16x32_bf16 v[124:127], v[200:203], a[172:175], v[124:127]
    v_mfma_f32_16x16x32_bf16 v[124:127], v[208:211], a[204:207], v[124:127]
    ds_read_b64_tr_b16 v[200:201], v250 offset:128
    v_cvt_pk_bf16_f32 v82, v96, v97
    v_mfma_f32_16x16x32_bf16 v[124:127], v[212:215], a[220:223], v[124:127]
    ds_read_b64_tr_b16 v[202:203], v250 offset:4736
    v_mfma_f32_16x16x32_bf16 v[120:123], v[212:215], a[216:219], v[120:123]
    v_cvt_pk_bf16_f32 v83, v98, v99
    v_mfma_f32_16x16x32_bf16 v[120:123], v[208:211], a[200:203], v[120:123]
    v_mfma_f32_16x16x32_bf16 v[116:119], v[208:211], a[196:199], v[116:119]
    ds_read_b64_tr_b16 v[204:205], v250 offset:9344
    buffer_store_dwordx4 v[80:83], v1, s[16:19], s74 offen offset:1024 sc1
    v_mfma_f32_16x16x32_bf16 v[116:119], v[212:215], a[212:215], v[116:119]
    ds_read_b64_tr_b16 v[206:207], v250 offset:13952
    s_waitcnt lgkmcnt(4)
    v_mfma_f32_16x16x32_bf16 v[112:115], v[212:215], a[208:211], v[112:115]
    v_cvt_pk_bf16_f32 v84, v84, v85
    v_mfma_f32_16x16x32_bf16 v[112:115], v[208:211], a[192:195], v[112:115]
    v_mfma_f32_16x16x32_bf16 v[112:115], v[192:195], a[224:227], v[112:115]
    ds_read_b64_tr_b16 v[208:209], v250 offset:18560
    v_cvt_pk_bf16_f32 v85, v86, v87
    v_mfma_f32_16x16x32_bf16 v[112:115], v[196:199], a[240:243], v[112:115]
    ds_read_b64_tr_b16 v[210:211], v250 offset:23168
    v_mfma_f32_16x16x32_bf16 v[116:119], v[196:199], a[244:247], v[116:119]
    v_cvt_pk_bf16_f32 v86, v100, v101
    v_mfma_f32_16x16x32_bf16 v[116:119], v[192:195], a[228:231], v[116:119]
    v_mfma_f32_16x16x32_bf16 v[120:123], v[192:195], a[232:235], v[120:123]
    ds_read_b64_tr_b16 v[212:213], v250 offset:27776
    v_cvt_pk_bf16_f32 v87, v102, v103
    v_mfma_f32_16x16x32_bf16 v[120:123], v[196:199], a[248:251], v[120:123]
    ds_read_b64_tr_b16 v[214:215], v250 offset:32384
    s_waitcnt lgkmcnt(4)
    v_mfma_f32_16x16x32_bf16 v[124:127], v[196:199], a[252:255], v[124:127]
    buffer_store_dwordx4 v[84:87], v1, s[16:19], s75 offen offset:1024 sc1
    v_mfma_f32_16x16x32_bf16 v[124:127], v[192:195], a[236:239], v[124:127]
    v_mfma_f32_16x16x32_bf16 v[124:127], v[200:203], a[12:15], v[124:127]
    ds_read_b64_tr_b16 v[192:193], v8 offset:18592
    v_cvt_pk_bf16_f32 v88, v88, v89
    v_mfma_f32_16x16x32_bf16 v[124:127], v[204:207], a[28:31], v[124:127]
    ds_read_b64_tr_b16 v[194:195], v8 offset:23200
    v_mfma_f32_16x16x32_bf16 v[120:123], v[204:207], a[24:27], v[120:123]
    v_cvt_pk_bf16_f32 v89, v90, v91
    v_mfma_f32_16x16x32_bf16 v[120:123], v[200:203], a[8:11], v[120:123]
    v_mfma_f32_16x16x32_bf16 v[116:119], v[200:203], a[4:7], v[116:119]
    ds_read_b64_tr_b16 v[196:197], v8 offset:27808
    v_cvt_pk_bf16_f32 v90, v104, v105
    v_mfma_f32_16x16x32_bf16 v[116:119], v[204:207], a[20:23], v[116:119]
    ds_read_b64_tr_b16 v[198:199], v8 offset:32416
    s_waitcnt lgkmcnt(4)
    v_mfma_f32_16x16x32_bf16 v[112:115], v[204:207], a[16:19], v[112:115]
    v_cvt_pk_bf16_f32 v91, v106, v107
    v_mfma_f32_16x16x32_bf16 v[112:115], v[200:203], a[0:3], v[112:115]
    v_mfma_f32_16x16x32_bf16 v[112:115], v[208:211], a[32:35], v[112:115]
    ds_read_b64_tr_b16 v[200:201], v9 offset:160
    buffer_store_dwordx4 v[88:91], v1, s[16:19], s76 offen offset:1024 sc1
    v_mfma_f32_16x16x32_bf16 v[112:115], v[212:215], a[48:51], v[112:115]
    ds_read_b64_tr_b16 v[202:203], v9 offset:4768
    v_mfma_f32_16x16x32_bf16 v[116:119], v[212:215], a[52:55], v[116:119]
    v_cvt_pk_bf16_f32 v92, v92, v93
    v_mfma_f32_16x16x32_bf16 v[116:119], v[208:211], a[36:39], v[116:119]
    v_mfma_f32_16x16x32_bf16 v[120:123], v[208:211], a[40:43], v[120:123]
    ds_read_b64_tr_b16 v[204:205], v9 offset:9376
    v_cvt_pk_bf16_f32 v93, v94, v95
    v_mfma_f32_16x16x32_bf16 v[120:123], v[212:215], a[56:59], v[120:123]
    ds_read_b64_tr_b16 v[206:207], v9 offset:13984
    s_waitcnt lgkmcnt(4)
    v_mfma_f32_16x16x32_bf16 v[124:127], v[212:215], a[60:63], v[124:127]
    v_cvt_pk_bf16_f32 v94, v108, v109
    v_mfma_f32_16x16x32_bf16 v[124:127], v[208:211], a[44:47], v[124:127]
    v_mfma_f32_16x16x32_bf16 v[128:131], v[192:195], a[160:163], v[128:131]
    ds_read_b64_tr_b16 v[208:209], v9 offset:18592
    v_cvt_pk_bf16_f32 v95, v110, v111
    v_mfma_f32_16x16x32_bf16 v[128:131], v[196:199], a[176:179], v[128:131]
    ds_read_b64_tr_b16 v[210:211], v9 offset:23200
    v_mfma_f32_16x16x32_bf16 v[132:135], v[196:199], a[180:183], v[132:135]
    buffer_store_dwordx4 v[92:95], v1, s[16:19], s77 offen offset:1024 sc1
    v_mfma_f32_16x16x32_bf16 v[132:135], v[192:195], a[164:167], v[132:135]
    v_mfma_f32_16x16x32_bf16 v[136:139], v[192:195], a[168:171], v[136:139]
    ds_read_b64_tr_b16 v[212:213], v9 offset:27808
    v_mfma_f32_16x16x32_bf16 v[136:139], v[196:199], a[184:187], v[136:139]
    ds_read_b64_tr_b16 v[214:215], v9 offset:32416
    s_waitcnt lgkmcnt(4)
    v_mfma_f32_16x16x32_bf16 v[140:143], v[196:199], a[188:191], v[140:143]
    v_mfma_f32_16x16x32_bf16 v[140:143], v[192:195], a[172:175], v[140:143]
    v_mfma_f32_16x16x32_bf16 v[140:143], v[200:203], a[204:207], v[140:143]
    ds_read_b64_tr_b16 v[192:193], v250 offset:160
    v_mfma_f32_16x16x32_bf16 v[140:143], v[204:207], a[220:223], v[140:143]
    ds_read_b64_tr_b16 v[194:195], v250 offset:4768
    v_mfma_f32_16x16x32_bf16 v[136:139], v[204:207], a[216:219], v[136:139]
    v_mfma_f32_16x16x32_bf16 v[136:139], v[200:203], a[200:203], v[136:139]
    v_mfma_f32_16x16x32_bf16 v[132:135], v[200:203], a[196:199], v[132:135]
    ds_read_b64_tr_b16 v[196:197], v250 offset:9376
    v_mfma_f32_16x16x32_bf16 v[132:135], v[204:207], a[212:215], v[132:135]
    ds_read_b64_tr_b16 v[198:199], v250 offset:13984
    s_waitcnt lgkmcnt(4)
    v_mfma_f32_16x16x32_bf16 v[128:131], v[204:207], a[208:211], v[128:131]
    v_mfma_f32_16x16x32_bf16 v[128:131], v[200:203], a[192:195], v[128:131]
    v_mfma_f32_16x16x32_bf16 v[128:131], v[208:211], a[224:227], v[128:131]
    ds_read_b64_tr_b16 v[200:201], v250 offset:18592
    v_mfma_f32_16x16x32_bf16 v[128:131], v[212:215], a[240:243], v[128:131]
    ds_read_b64_tr_b16 v[202:203], v250 offset:23200
    v_mfma_f32_16x16x32_bf16 v[132:135], v[212:215], a[244:247], v[132:135]
    v_mfma_f32_16x16x32_bf16 v[132:135], v[208:211], a[228:231], v[132:135]
    v_mfma_f32_16x16x32_bf16 v[136:139], v[208:211], a[232:235], v[136:139]
    ds_read_b64_tr_b16 v[204:205], v250 offset:27808
    v_mfma_f32_16x16x32_bf16 v[136:139], v[212:215], a[248:251], v[136:139]
    ds_read_b64_tr_b16 v[206:207], v250 offset:32416
    s_waitcnt lgkmcnt(4)
    v_mfma_f32_16x16x32_bf16 v[140:143], v[212:215], a[252:255], v[140:143]
    v_mfma_f32_16x16x32_bf16 v[140:143], v[208:211], a[236:239], v[140:143]
    v_mfma_f32_16x16x32_bf16 v[140:143], v[192:195], a[12:15], v[140:143]
    ds_read_b64_tr_b16 v[208:209], v8 offset:18624
    v_mfma_f32_16x16x32_bf16 v[140:143], v[196:199], a[28:31], v[140:143]
    ds_read_b64_tr_b16 v[210:211], v8 offset:23232
    v_mfma_f32_16x16x32_bf16 v[136:139], v[196:199], a[24:27], v[136:139]
    v_mfma_f32_16x16x32_bf16 v[136:139], v[192:195], a[8:11], v[136:139]
    v_mfma_f32_16x16x32_bf16 v[132:135], v[192:195], a[4:7], v[132:135]
    ds_read_b64_tr_b16 v[212:213], v8 offset:27840
    v_mfma_f32_16x16x32_bf16 v[132:135], v[196:199], a[20:23], v[132:135]
    ds_read_b64_tr_b16 v[214:215], v8 offset:32448
    s_waitcnt lgkmcnt(4)
    v_mfma_f32_16x16x32_bf16 v[128:131], v[196:199], a[16:19], v[128:131]
    v_mfma_f32_16x16x32_bf16 v[128:131], v[192:195], a[0:3], v[128:131]
    v_mfma_f32_16x16x32_bf16 v[128:131], v[200:203], a[32:35], v[128:131]
    ds_read_b64_tr_b16 v[192:193], v9 offset:192
    v_mfma_f32_16x16x32_bf16 v[128:131], v[204:207], a[48:51], v[128:131]
    ds_read_b64_tr_b16 v[194:195], v9 offset:4800
    v_mfma_f32_16x16x32_bf16 v[132:135], v[204:207], a[52:55], v[132:135]
    v_mfma_f32_16x16x32_bf16 v[132:135], v[200:203], a[36:39], v[132:135]
    v_mfma_f32_16x16x32_bf16 v[136:139], v[200:203], a[40:43], v[136:139]
    ds_read_b64_tr_b16 v[196:197], v9 offset:9408
    v_mfma_f32_16x16x32_bf16 v[136:139], v[204:207], a[56:59], v[136:139]
    ds_read_b64_tr_b16 v[198:199], v9 offset:14016
    s_waitcnt lgkmcnt(4)
    v_mfma_f32_16x16x32_bf16 v[140:143], v[204:207], a[60:63], v[140:143]
    v_mfma_f32_16x16x32_bf16 v[140:143], v[200:203], a[44:47], v[140:143]
    v_mfma_f32_16x16x32_bf16 v[144:147], v[208:211], a[160:163], v[144:147]
    ds_read_b64_tr_b16 v[200:201], v9 offset:18624
    v_mfma_f32_16x16x32_bf16 v[144:147], v[212:215], a[176:179], v[144:147]
    ds_read_b64_tr_b16 v[202:203], v9 offset:23232
    v_mfma_f32_16x16x32_bf16 v[148:151], v[212:215], a[180:183], v[148:151]
    v_mfma_f32_16x16x32_bf16 v[148:151], v[208:211], a[164:167], v[148:151]
    v_mfma_f32_16x16x32_bf16 v[152:155], v[208:211], a[168:171], v[152:155]
    ds_read_b64_tr_b16 v[204:205], v9 offset:27840
    v_cvt_pk_bf16_f32 v112, v112, v113
    v_mfma_f32_16x16x32_bf16 v[152:155], v[212:215], a[184:187], v[152:155]
    ds_read_b64_tr_b16 v[206:207], v9 offset:32448
    s_waitcnt lgkmcnt(4)
    v_mfma_f32_16x16x32_bf16 v[156:159], v[212:215], a[188:191], v[156:159]
    v_mfma_f32_16x16x32_bf16 v[156:159], v[208:211], a[172:175], v[156:159]
    v_cvt_pk_bf16_f32 v113, v114, v115
    v_mfma_f32_16x16x32_bf16 v[156:159], v[192:195], a[204:207], v[156:159]
    ds_read_b64_tr_b16 v[208:209], v250 offset:192
    v_mfma_f32_16x16x32_bf16 v[156:159], v[196:199], a[220:223], v[156:159]
    ds_read_b64_tr_b16 v[210:211], v250 offset:4800
    v_mfma_f32_16x16x32_bf16 v[152:155], v[196:199], a[216:219], v[152:155]
    v_mfma_f32_16x16x32_bf16 v[152:155], v[192:195], a[200:203], v[152:155]
    v_cvt_pk_bf16_f32 v114, v128, v129
    v_mfma_f32_16x16x32_bf16 v[148:151], v[192:195], a[196:199], v[148:151]
    ds_read_b64_tr_b16 v[212:213], v250 offset:9408
    v_mfma_f32_16x16x32_bf16 v[148:151], v[196:199], a[212:215], v[148:151]
    ds_read_b64_tr_b16 v[214:215], v250 offset:14016
    s_waitcnt lgkmcnt(4)
    v_mfma_f32_16x16x32_bf16 v[144:147], v[196:199], a[208:211], v[144:147]
    v_cvt_pk_bf16_f32 v115, v130, v131
    v_mfma_f32_16x16x32_bf16 v[144:147], v[192:195], a[192:195], v[144:147]
    v_mfma_f32_16x16x32_bf16 v[144:147], v[200:203], a[224:227], v[144:147]
    ds_read_b64_tr_b16 v[192:193], v250 offset:18624
    v_mfma_f32_16x16x32_bf16 v[144:147], v[204:207], a[240:243], v[144:147]
    ds_read_b64_tr_b16 v[194:195], v250 offset:23232
    v_mfma_f32_16x16x32_bf16 v[148:151], v[204:207], a[244:247], v[148:151]
    buffer_store_dwordx4 v[112:115], v1, s[16:19], s74 offen offset:2048 sc1
    v_mfma_f32_16x16x32_bf16 v[148:151], v[200:203], a[228:231], v[148:151]
    v_mfma_f32_16x16x32_bf16 v[152:155], v[200:203], a[232:235], v[152:155]
    ds_read_b64_tr_b16 v[196:197], v250 offset:27840
    v_mfma_f32_16x16x32_bf16 v[152:155], v[204:207], a[248:251], v[152:155]
    ds_read_b64_tr_b16 v[198:199], v250 offset:32448
    s_waitcnt lgkmcnt(4)
    v_mfma_f32_16x16x32_bf16 v[156:159], v[204:207], a[252:255], v[156:159]
    v_cvt_pk_bf16_f32 v116, v116, v117
    v_mfma_f32_16x16x32_bf16 v[156:159], v[200:203], a[236:239], v[156:159]
    v_mfma_f32_16x16x32_bf16 v[156:159], v[208:211], a[12:15], v[156:159]
    ds_read_b64_tr_b16 v[200:201], v8 offset:18656
    v_mfma_f32_16x16x32_bf16 v[156:159], v[212:215], a[28:31], v[156:159]
    ds_read_b64_tr_b16 v[202:203], v8 offset:23264
    v_cvt_pk_bf16_f32 v117, v118, v119
    v_mfma_f32_16x16x32_bf16 v[152:155], v[212:215], a[24:27], v[152:155]
    v_mfma_f32_16x16x32_bf16 v[152:155], v[208:211], a[8:11], v[152:155]
    v_mfma_f32_16x16x32_bf16 v[148:151], v[208:211], a[4:7], v[148:151]
    ds_read_b64_tr_b16 v[204:205], v8 offset:27872
    v_mfma_f32_16x16x32_bf16 v[148:151], v[212:215], a[20:23], v[148:151]
    ds_read_b64_tr_b16 v[206:207], v8 offset:32480
    s_waitcnt lgkmcnt(4)
    v_mfma_f32_16x16x32_bf16 v[144:147], v[212:215], a[16:19], v[144:147]
    v_cvt_pk_bf16_f32 v118, v132, v133
    v_mfma_f32_16x16x32_bf16 v[144:147], v[208:211], a[0:3], v[144:147]
    v_mfma_f32_16x16x32_bf16 v[144:147], v[192:195], a[32:35], v[144:147]
    ds_read_b64_tr_b16 v[208:209], v9 offset:224
    v_cvt_pk_bf16_f32 v119, v134, v135
    v_mfma_f32_16x16x32_bf16 v[144:147], v[196:199], a[48:51], v[144:147]
    ds_read_b64_tr_b16 v[210:211], v9 offset:4832
    s_cmp_eq_u32 s5, 1
    s_cselect_b32 s30, 0, s18
    s_mov_b32 s4, 0
    v_mfma_f32_16x16x32_bf16 v[148:151], v[196:199], a[52:55], v[148:151]
    s_add_u32 s86, s85, 86016
    v_mfma_f32_16x16x32_bf16 v[148:151], v[192:195], a[36:39], v[148:151]
    buffer_load_dwordx4 v[64:67], v1, s[16:19], s86 offen sc1
    v_mfma_f32_16x16x32_bf16 v[152:155], v[192:195], a[40:43], v[152:155]
    ds_read_b64_tr_b16 v[212:213], v9 offset:9440
    s_add_u32 s86, s85, 107520
    v_mfma_f32_16x16x32_bf16 v[152:155], v[196:199], a[56:59], v[152:155]
    ds_read_b64_tr_b16 v[214:215], v9 offset:14048
    s_waitcnt lgkmcnt(4)
    buffer_load_dwordx4 v[68:71], v1, s[16:19], s86 offen sc1
    v_mfma_f32_16x16x32_bf16 v[156:159], v[196:199], a[60:63], v[156:159]
    buffer_store_dwordx4 v[116:119], v1, s[16:19], s75 offen offset:2048 sc1
    v_mfma_f32_16x16x32_bf16 v[156:159], v[192:195], a[44:47], v[156:159]
    s_add_u32 s86, s85, 129024
    v_mfma_f32_16x16x32_bf16 v[160:163], v[200:203], a[160:163], v[160:163]
    ds_read_b64_tr_b16 v[192:193], v9 offset:18656
    v_cvt_pk_bf16_f32 v120, v120, v121
    v_mfma_f32_16x16x32_bf16 v[160:163], v[204:207], a[176:179], v[160:163]
    ds_read_b64_tr_b16 v[194:195], v9 offset:23264
    buffer_load_dwordx4 v[72:75], v1, s[16:19], s86 offen sc1
    v_mfma_f32_16x16x32_bf16 v[164:167], v[204:207], a[180:183], v[164:167]
    s_add_u32 s86, s85, 150528
    buffer_load_dwordx4 v[76:79], v1, s[16:19], s86 offen sc1
    v_mfma_f32_16x16x32_bf16 v[164:167], v[200:203], a[164:167], v[164:167]
    v_cvt_pk_bf16_f32 v121, v122, v123
    v_mfma_f32_16x16x32_bf16 v[168:171], v[200:203], a[168:171], v[168:171]
    ds_read_b64_tr_b16 v[196:197], v9 offset:27872
    s_add_u32 s86, s85, 0
    v_mfma_f32_16x16x32_bf16 v[168:171], v[204:207], a[184:187], v[168:171]
    ds_read_b64_tr_b16 v[198:199], v9 offset:32480
    s_waitcnt lgkmcnt(4)
    v_mfma_f32_16x16x32_bf16 v[172:175], v[204:207], a[188:191], v[172:175]
    buffer_load_dwordx4 v[48:51], v1, s[16:19], s86 offen sc1
    v_mfma_f32_16x16x32_bf16 v[172:175], v[200:203], a[172:175], v[172:175]
    s_add_u32 s86, s85, 21504
    v_cvt_pk_bf16_f32 v122, v136, v137
    v_mfma_f32_16x16x32_bf16 v[172:175], v[208:211], a[204:207], v[172:175]
    ds_read_b64_tr_b16 v[200:201], v250 offset:224
    buffer_load_dwordx4 v[52:55], v1, s[16:19], s86 offen sc1
    v_mfma_f32_16x16x32_bf16 v[172:175], v[212:215], a[220:223], v[172:175]
    ds_read_b64_tr_b16 v[202:203], v250 offset:4832
    s_add_u32 s86, s85, 43008
    v_mfma_f32_16x16x32_bf16 v[168:171], v[212:215], a[216:219], v[168:171]
    v_cvt_pk_bf16_f32 v123, v138, v139
    v_mfma_f32_16x16x32_bf16 v[168:171], v[208:211], a[200:203], v[168:171]
    buffer_load_dwordx4 v[56:59], v1, s[16:19], s86 offen sc1
    v_mfma_f32_16x16x32_bf16 v[164:167], v[208:211], a[196:199], v[164:167]
    ds_read_b64_tr_b16 v[204:205], v250 offset:9440
    s_add_u32 s86, s85, 64512
    v_mfma_f32_16x16x32_bf16 v[164:167], v[212:215], a[212:215], v[164:167]
    ds_read_b64_tr_b16 v[206:207], v250 offset:14048
    s_waitcnt lgkmcnt(4)
    buffer_load_dwordx4 v[60:63], v1, s[16:19], s86 offen sc1
    v_mfma_f32_16x16x32_bf16 v[160:163], v[212:215], a[208:211], v[160:163]
    buffer_store_dwordx4 v[120:123], v1, s[16:19], s76 offen offset:2048 sc1
    v_mfma_f32_16x16x32_bf16 v[160:163], v[208:211], a[192:195], v[160:163]
    s_add_u32 s86, s78, 86016
    v_mfma_f32_16x16x32_bf16 v[160:163], v[192:195], a[224:227], v[160:163]
    ds_read_b64_tr_b16 v[208:209], v250 offset:18656
    buffer_load_dwordx2 v[88:89], v46, s[28:31], s86 offen sc1
    v_mfma_f32_16x16x32_bf16 v[160:163], v[196:199], a[240:243], v[160:163]
    ds_read_b64_tr_b16 v[210:211], v250 offset:23264
    s_add_u32 s86, s78, 107520
    v_mfma_f32_16x16x32_bf16 v[164:167], v[196:199], a[244:247], v[164:167]
    v_cvt_pk_bf16_f32 v124, v124, v125
    v_mfma_f32_16x16x32_bf16 v[164:167], v[192:195], a[228:231], v[164:167]
    buffer_load_dwordx2 v[90:91], v46, s[28:31], s86 offen sc1
    v_mfma_f32_16x16x32_bf16 v[168:171], v[192:195], a[232:235], v[168:171]
    ds_read_b64_tr_b16 v[212:213], v250 offset:27872
    s_add_u32 s86, s78, 129024
    v_mfma_f32_16x16x32_bf16 v[168:171], v[196:199], a[248:251], v[168:171]
    ds_read_b64_tr_b16 v[214:215], v250 offset:32480
    s_waitcnt lgkmcnt(4)
    v_mfma_f32_16x16x32_bf16 v[172:175], v[196:199], a[252:255], v[172:175]
    buffer_load_dwordx2 v[92:93], v46, s[28:31], s86 offen sc1
    v_cvt_pk_bf16_f32 v125, v126, v127
    v_mfma_f32_16x16x32_bf16 v[172:175], v[192:195], a[236:239], v[172:175]
    s_add_u32 s86, s78, 150528
    v_mfma_f32_16x16x32_bf16 v[172:175], v[200:203], a[12:15], v[172:175]
    buffer_load_dwordx2 v[94:95], v46, s[28:31], s86 offen sc1
    v_mfma_f32_16x16x32_bf16 v[172:175], v[204:207], a[28:31], v[172:175]
    s_add_u32 s86, s78, 0
    v_cvt_pk_bf16_f32 v126, v140, v141
    v_mfma_f32_16x16x32_bf16 v[168:171], v[204:207], a[24:27], v[168:171]
    buffer_load_dwordx2 v[80:81], v46, s[28:31], s86 offen sc1
    v_mfma_f32_16x16x32_bf16 v[168:171], v[200:203], a[8:11], v[168:171]
    v_mfma_f32_16x16x32_bf16 v[164:167], v[200:203], a[4:7], v[164:167]
    s_add_u32 s86, s78, 21504
    v_cvt_pk_bf16_f32 v127, v142, v143
    v_mfma_f32_16x16x32_bf16 v[164:167], v[204:207], a[20:23], v[164:167]
    s_waitcnt lgkmcnt(0)
    v_mfma_f32_16x16x32_bf16 v[160:163], v[204:207], a[16:19], v[160:163]
    buffer_load_dwordx2 v[82:83], v46, s[28:31], s86 offen sc1
    v_mfma_f32_16x16x32_bf16 v[160:163], v[200:203], a[0:3], v[160:163]
    s_add_u32 s86, s78, 43008
    v_mfma_f32_16x16x32_bf16 v[160:163], v[208:211], a[32:35], v[160:163]
    buffer_store_dwordx4 v[124:127], v1, s[16:19], s77 offen offset:2048 sc1
    v_mfma_f32_16x16x32_bf16 v[160:163], v[212:215], a[48:51], v[160:163]
    buffer_load_dwordx2 v[84:85], v46, s[28:31], s86 offen sc1
    v_mfma_f32_16x16x32_bf16 v[164:167], v[212:215], a[52:55], v[164:167]
    s_add_u32 s86, s78, 64512
    v_mfma_f32_16x16x32_bf16 v[164:167], v[208:211], a[36:39], v[164:167]
    buffer_load_dwordx2 v[86:87], v46, s[28:31], s86 offen sc1
    v_mfma_f32_16x16x32_bf16 v[168:171], v[208:211], a[40:43], v[168:171]
    v_mfma_f32_16x16x32_bf16 v[168:171], v[212:215], a[56:59], v[168:171]
    v_mfma_f32_16x16x32_bf16 v[172:175], v[212:215], a[60:63], v[172:175]
    v_mfma_f32_16x16x32_bf16 v[172:175], v[208:211], a[44:47], v[172:175]
    v_cvt_pk_bf16_f32 v144, v144, v145
    v_cvt_pk_bf16_f32 v145, v146, v147
    v_cvt_pk_bf16_f32 v146, v160, v161
    v_cvt_pk_bf16_f32 v147, v162, v163
    buffer_store_dwordx4 v[144:147], v1, s[16:19], s74 offen offset:3072 sc1
    v_cvt_pk_bf16_f32 v148, v148, v149
    v_cvt_pk_bf16_f32 v149, v150, v151
    v_cvt_pk_bf16_f32 v150, v164, v165
    v_cvt_pk_bf16_f32 v151, v166, v167
    buffer_store_dwordx4 v[148:151], v1, s[16:19], s75 offen offset:3072 sc1
    v_cvt_pk_bf16_f32 v152, v152, v153
    v_cvt_pk_bf16_f32 v153, v154, v155
    v_cvt_pk_bf16_f32 v154, v168, v169
    v_cvt_pk_bf16_f32 v155, v170, v171
    buffer_store_dwordx4 v[152:155], v1, s[16:19], s76 offen offset:3072 sc1
    v_cvt_pk_bf16_f32 v156, v156, v157
    v_cvt_pk_bf16_f32 v157, v158, v159
    v_cvt_pk_bf16_f32 v158, v172, v173
    v_cvt_pk_bf16_f32 v159, v174, v175
    buffer_store_dwordx4 v[156:159], v1, s[16:19], s77 offen offset:3072 sc1
KF_q1:
    s_waitcnt vmcnt(17)
    v_max3_u32 v128, v48, v49, v50
    s_waitcnt vmcnt(16)
    v_max3_u32 v129, v51, v52, v53
    v_max3_u32 v129, v129, v54, v55
    s_waitcnt vmcnt(15)
    v_max3_u32 v128, v128, v56, v57
    v_max3_u32 v129, v129, v58, v59
    s_waitcnt vmcnt(14)
    v_max3_u32 v128, v128, v60, v61
    v_max3_u32 v129, v129, v62, v63
    v_max3_u32 v128, v128, v64, v65
    v_max3_u32 v129, v129, v66, v67
    v_max3_u32 v128, v128, v68, v69
    v_max3_u32 v129, v129, v70, v71
    v_max3_u32 v128, v128, v72, v73
    v_max3_u32 v129, v129, v74, v75
    v_max3_u32 v128, v128, v76, v77
    v_max3_u32 v129, v129, v78, v79
    s_waitcnt vmcnt(8)
    v_max3_u32 v128, v128, v80, v81
    s_waitcnt vmcnt(7)
    v_max3_u32 v129, v129, v82, v83
    s_waitcnt vmcnt(5)
    v_max3_u32 v128, v128, v84, v85
    s_waitcnt vmcnt(4)
    v_max3_u32 v129, v129, v86, v87
    v_max3_u32 v128, v128, v88, v89
    v_max3_u32 v129, v129, v90, v91
    v_max3_u32 v128, v128, v92, v93
    v_max3_u32 v129, v129, v94, v95
    v_max_u32 v128, v128, v129
    v_cmp_eq_u32 vcc, -1, v128
    s_nop 0
    s_cbranch_vccnz KF_q1x
KF_q1d:
    v_mfma_f32_16x16x32_bf16 v[96:99], v[28:31], v[64:67], 0
    v_mfma_f32_16x16x32_bf16 v[100:103], v[26:29], v[64:67], 0
    v_mfma_f32_16x16x32_bf16 v[96:99], v[28:31], v[68:71], v[96:99]
    v_mfma_f32_16x16x32_bf16 v[100:103], v[26:29], v[68:71], v[100:103]
    v_mfma_f32_16x16x32_bf16 v[96:99], v[28:31], v[72:75], v[96:99]
    v_mfma_f32_16x16x32_bf16 v[100:103], v[26:29], v[72:75], v[100:103]
    v_mfma_f32_16x16x32_bf16 v[96:99], v[28:31], v[76:79], v[96:99]
    v_mfma_f32_16x16x32_bf16 v[100:103], v[26:29], v[76:79], v[100:103]
    v_mfma_f32_16x16x32_bf16 v[108:111], v[28:31], v[48:51], 0
    v_mfma_f32_16x16x32_bf16 v[112:115], v[26:29], v[48:51], 0
    v_mfma_f32_16x16x32_bf16 v[108:111], v[28:31], v[52:55], v[108:111]
    v_mfma_f32_16x16x32_bf16 v[112:115], v[26:29], v[52:55], v[112:115]
    v_mfma_f32_16x16x32_bf16 v[108:111], v[28:31], v[56:59], v[108:111]
    v_mfma_f32_16x16x32_bf16 v[112:115], v[26:29], v[56:59], v[112:115]
    v_mfma_f32_16x16x32_bf16 v[108:111], v[28:31], v[60:63], v[108:111]
    v_mfma_f32_16x16x32_bf16 v[112:115], v[26:29], v[60:63], v[112:115]
    v_mfma_f32_16x16x32_bf16 v[104:107], v[32:35], v[88:91], 0
    v_mfma_f32_16x16x32_bf16 v[104:107], v[32:35], v[92:95], v[104:107]
    v_mfma_f32_16x16x32_bf16 v[116:119], v[32:35], v[80:83], 0
    v_mfma_f32_16x16x32_bf16 v[116:119], v[32:35], v[84:87], v[116:119]
    v_mul_f32 v124, s88, v96
    v_mul_f32 v125, s88, v97
    v_mul_f32 v126, s88, v98
    v_mul_f32 v127, s88, v99
    v_exp_f32 v124, v124
    v_exp_f32 v125, v125
    v_exp_f32 v126, v126
    v_exp_f32 v127, v127
    v_add_f32 v124, 1.0, v124
    v_add_f32 v125, 1.0, v125
    v_add_f32 v126, 1.0, v126
    v_add_f32 v127, 1.0, v127
    v_rcp_f32 v124, v124
    v_rcp_f32 v125, v125
    v_rcp_f32 v126, v126
    v_rcp_f32 v127, v127
    v_pk_mul_f32 v[96:97], v[96:97], v[124:125]
    v_pk_mul_f32 v[98:99], v[98:99], v[126:127]
    s_add_u32 s86, s85, 86016
    buffer_load_dwordx4 v[232:235], v1, s[16:19], s86 offen offset:2048 sc1
    s_add_u32 s86, s85, 107520
    buffer_load_dwordx4 v[236:239], v1, s[16:19], s86 offen offset:2048 sc1
    s_add_u32 s86, s85, 129024
    buffer_load_dwordx4 v[240:243], v1, s[16:19], s86 offen offset:2048 sc1
    s_add_u32 s86, s85, 150528
    buffer_load_dwordx4 v[244:247], v1, s[16:19], s86 offen offset:2048 sc1
    s_add_u32 s86, s85, 0
    buffer_load_dwordx4 v[216:219], v1, s[16:19], s86 offen offset:2048 sc1
    s_add_u32 s86, s85, 21504
    buffer_load_dwordx4 v[220:223], v1, s[16:19], s86 offen offset:2048 sc1
    s_add_u32 s86, s85, 43008
    buffer_load_dwordx4 v[224:227], v1, s[16:19], s86 offen offset:2048 sc1
    s_add_u32 s86, s85, 64512
    buffer_load_dwordx4 v[228:231], v1, s[16:19], s86 offen offset:2048 sc1
    v_mul_f32 v124, s88, v100
    v_mul_f32 v125, s88, v101
    v_mul_f32 v126, s88, v102
    v_mul_f32 v127, s88, v103
    v_exp_f32 v124, v124
    v_exp_f32 v125, v125
    v_exp_f32 v126, v126
    v_exp_f32 v127, v127
    v_add_f32 v124, 1.0, v124
    v_add_f32 v125, 1.0, v125
    v_add_f32 v126, 1.0, v126
    v_add_f32 v127, 1.0, v127
    v_rcp_f32 v124, v124
    v_rcp_f32 v125, v125
    v_rcp_f32 v126, v126
    v_rcp_f32 v127, v127
    v_pk_mul_f32 v[100:101], v[100:101], v[124:125]
    v_pk_mul_f32 v[102:103], v[102:103], v[126:127]
    v_lshlrev_b32 v124, 16, v36
    v_and_b32 v125, s89, v36
    v_lshlrev_b32 v126, 16, v37
    v_and_b32 v127, s89, v37
    v_pk_fma_f32 v[96:97], v[96:97], v[108:109], v[124:125]
    v_pk_fma_f32 v[98:99], v[98:99], v[110:111], v[126:127]
    v_cvt_pk_bf16_f32 v108, v96, v97
    v_cvt_pk_bf16_f32 v109, v98, v99
    buffer_store_dwordx2 v[108:109], v25, s[12:15], s83 offen offset:0
    v_lshlrev_b32 v124, 16, v38
    v_and_b32 v125, s89, v38
    v_lshlrev_b32 v126, 16, v39
    v_and_b32 v127, s89, v39
    v_pk_fma_f32 v[100:101], v[100:101], v[112:113], v[124:125]
    v_pk_fma_f32 v[102:103], v[102:103], v[114:115], v[126:127]
    v_cvt_pk_bf16_f32 v112, v100, v101
    v_cvt_pk_bf16_f32 v113, v102, v103
    buffer_store_dwordx2 v[112:113], v25, s[12:15], s83 offen offset:32
    s_cmp_eq_u32 s5, 1
    s_cbranch_scc1 KF_r2
    v_mul_f32 v124, s88, v104
    v_mul_f32 v125, s88, v105
    v_mul_f32 v126, s88, v106
    v_mul_f32 v127, s88, v107
    v_exp_f32 v124, v124
    v_exp_f32 v125, v125
    v_exp_f32 v126, v126
    v_exp_f32 v127, v127
    s_nop 0
    v_add_f32 v124, 1.0, v124
    v_add_f32 v125, 1.0, v125
    v_add_f32 v126, 1.0, v126
    v_add_f32 v127, 1.0, v127
    v_rcp_f32 v124, v124
    v_rcp_f32 v125, v125
    v_rcp_f32 v126, v126
    v_rcp_f32 v127, v127
    s_nop 0
    v_pk_mul_f32 v[104:105], v[104:105], v[124:125]
    v_pk_mul_f32 v[106:107], v[106:107], v[126:127]
    v_lshlrev_b32 v124, 16, v44
    v_and_b32 v125, s89, v44
    v_lshlrev_b32 v126, 16, v45
    v_and_b32 v127, s89, v45
    v_pk_fma_f32 v[104:105], v[104:105], v[116:117], v[124:125]
    v_pk_fma_f32 v[106:107], v[106:107], v[118:119], v[126:127]
    v_cvt_pk_bf16_f32 v116, v104, v105
    v_cvt_pk_bf16_f32 v117, v106, v107
    buffer_store_dwordx2 v[116:117], v25, s[12:15], s87 offen offset:256
KF_r2:
KF_q2:
    s_waitcnt vmcnt(5)
    v_max3_u32 v128, v216, v217, v218
    s_waitcnt vmcnt(4)
    v_max3_u32 v129, v219, v220, v221
    v_max3_u32 v129, v129, v222, v223
    s_waitcnt vmcnt(3)
    v_max3_u32 v128, v128, v224, v225
    v_max3_u32 v129, v129, v226, v227
    s_waitcnt vmcnt(2)
    v_max3_u32 v128, v128, v228, v229
    v_max3_u32 v129, v129, v230, v231
    v_max3_u32 v128, v128, v232, v233
    v_max3_u32 v129, v129, v234, v235
    v_max3_u32 v128, v128, v236, v237
    v_max3_u32 v129, v129, v238, v239
    v_max3_u32 v128, v128, v240, v241
    v_max3_u32 v129, v129, v242, v243
    v_max3_u32 v128, v128, v244, v245
    v_max3_u32 v129, v129, v246, v247
    v_max_u32 v128, v128, v129
    v_cmp_eq_u32 vcc, -1, v128
    s_nop 0
    s_cbranch_vccnz KF_q2x
KF_q2d:
    v_mfma_f32_16x16x32_bf16 v[96:99], v[28:31], v[232:235], 0
    v_mfma_f32_16x16x32_bf16 v[100:103], v[26:29], v[232:235], 0
    v_mfma_f32_16x16x32_bf16 v[96:99], v[28:31], v[236:239], v[96:99]
    v_mfma_f32_16x16x32_bf16 v[100:103], v[26:29], v[236:239], v[100:103]
    v_mfma_f32_16x16x32_bf16 v[96:99], v[28:31], v[240:243], v[96:99]
    v_mfma_f32_16x16x32_bf16 v[100:103], v[26:29], v[240:243], v[100:103]
    v_mfma_f32_16x16x32_bf16 v[96:99], v[28:31], v[244:247], v[96:99]
    v_mfma_f32_16x16x32_bf16 v[100:103], v[26:29], v[244:247], v[100:103]
    v_mfma_f32_16x16x32_bf16 v[108:111], v[28:31], v[216:219], 0
    v_mfma_f32_16x16x32_bf16 v[112:115], v[26:29], v[216:219], 0
    v_mfma_f32_16x16x32_bf16 v[108:111], v[28:31], v[220:223], v[108:111]
    v_mfma_f32_16x16x32_bf16 v[112:115], v[26:29], v[220:223], v[112:115]
    v_mfma_f32_16x16x32_bf16 v[108:111], v[28:31], v[224:227], v[108:111]
    v_mfma_f32_16x16x32_bf16 v[112:115], v[26:29], v[224:227], v[112:115]
    v_mfma_f32_16x16x32_bf16 v[108:111], v[28:31], v[228:231], v[108:111]
    v_mfma_f32_16x16x32_bf16 v[112:115], v[26:29], v[228:231], v[112:115]
    v_mul_f32 v124, s88, v96
    v_mul_f32 v125, s88, v97
    v_mul_f32 v126, s88, v98
    v_mul_f32 v127, s88, v99
    v_exp_f32 v124, v124
    v_exp_f32 v125, v125
    v_exp_f32 v126, v126
    v_exp_f32 v127, v127
    v_add_f32 v124, 1.0, v124
    v_add_f32 v125, 1.0, v125
    v_add_f32 v126, 1.0, v126
    v_add_f32 v127, 1.0, v127
    v_rcp_f32 v124, v124
    v_rcp_f32 v125, v125
    v_rcp_f32 v126, v126
    v_rcp_f32 v127, v127
    v_pk_mul_f32 v[96:97], v[96:97], v[124:125]
    v_pk_mul_f32 v[98:99], v[98:99], v[126:127]
    v_mul_f32 v124, s88, v100
    v_mul_f32 v125, s88, v101
    v_mul_f32 v126, s88, v102
    v_mul_f32 v127, s88, v103
    v_exp_f32 v124, v124
    v_exp_f32 v125, v125
    v_exp_f32 v126, v126
    v_exp_f32 v127, v127
    v_add_f32 v124, 1.0, v124
    v_add_f32 v125, 1.0, v125
    v_add_f32 v126, 1.0, v126
    v_add_f32 v127, 1.0, v127
    v_rcp_f32 v124, v124
    v_rcp_f32 v125, v125
    v_rcp_f32 v126, v126
    v_rcp_f32 v127, v127
    v_pk_mul_f32 v[100:101], v[100:101], v[124:125]
    v_pk_mul_f32 v[102:103], v[102:103], v[126:127]
    v_lshlrev_b32 v124, 16, v40
    v_and_b32 v125, s89, v40
    v_lshlrev_b32 v126, 16, v41
    v_and_b32 v127, s89, v41
    v_pk_fma_f32 v[96:97], v[96:97], v[108:109], v[124:125]
    v_pk_fma_f32 v[98:99], v[98:99], v[110:111], v[126:127]
    v_cvt_pk_bf16_f32 v108, v96, v97
    v_cvt_pk_bf16_f32 v109, v98, v99
    buffer_store_dwordx2 v[108:109], v25, s[12:15], s83 offen offset:128
    v_lshlrev_b32 v124, 16, v42
    v_and_b32 v125, s89, v42
    v_lshlrev_b32 v126, 16, v43
    v_and_b32 v127, s89, v43
    v_pk_fma_f32 v[100:101], v[100:101], v[112:113], v[124:125]
    v_pk_fma_f32 v[102:103], v[102:103], v[114:115], v[126:127]
    v_cvt_pk_bf16_f32 v112, v100, v101
    v_cvt_pk_bf16_f32 v113, v102, v103
    buffer_store_dwordx2 v[112:113], v25, s[12:15], s83 offen offset:160
KF_fin:
KF_end:
    s_endpgm
KF_ck6:
    s_mov_b32 s73, 0
KF_sp8:
    buffer_load_dword v14, v9, s[16:19], s90 offen sc1
    s_waitcnt vmcnt(0)
    v_cmp_ne_u32 vcc, v14, v7
    s_add_u32 s73, s73, 1
    s_cmp_ge_u32 s73, 100000
    s_cbranch_scc1 KF_cr7
    s_cbranch_vccz KF_cr7
    s_sleep 2
    s_branch KF_sp8
    s_endpgm
KF_sw:
    s_mov_b32 s20, s24
    s_mov_b32 s21, s25
    s_mov_b32 s22, s26
    v_mov_b32 v16, v176
    v_mov_b32 v17, v177
    v_mov_b32 v18, v178
    v_mov_b32 v19, v179
    v_mov_b32 v20, v180
    v_mov_b32 v21, v181
    v_mov_b32 v22, v182
    v_mov_b32 v23, v183
    v_mov_b32 v24, v184
    s_mov_b32 s97, 147456
    s_mul_i32 s93, s3, 36864
    s_add_u32 s93, s93, s7
    s_mul_i32 s72, s65, 288
    s_add_u32 s93, s93, s72
    s_lshl_b32 s80, s6, 10
    s_add_u32 s80, s80, 16777216
    s_mov_b32 s79, s80
    s_mov_b32 s88, 0
    s_mov_b32 s87, 1
    s_cmp_eq_u32 s5, 0
    s_cselect_b32 s85, s65, 0
    s_cselect_b32 s30, 0, s18
    buffer_load_dword v40, v9, s[16:19], s84 offen sc1
    s_getpc_b64 s[72:73]
KF_pc2:
    s_sub_u32 s8, s72, KF_pc2-KF_nock
    s_subb_u32 s9, s73, 0
    s_mov_b32 s10, KF_codeend-KF_nock
    s_lshr_b32 s72, s2, 3
    s_lshl_b32 s72, s72, 2
    s_add_u32 s72, s72, s3
    s_mul_i32 s72, s72, 384
    s_mov_b64 exec, 7
    buffer_load_dword v0, v254, s[8:11], s72 offen
    s_mov_b64 exec, -1
    s_branch KF_oolr
    s_endpgm
KF_ck10:
    s_mov_b32 s73, 0
KF_sp12:
    buffer_load_dword v40, v9, s[16:19], s84 offen sc1
    s_waitcnt vmcnt(0)
    v_cmp_ne_u32 vcc, v40, v7
    s_add_u32 s73, s73, 1
    s_cmp_ge_u32 s73, 100000
    s_cbranch_scc1 KF_cr11
    s_cbranch_vccz KF_cr11
    s_sleep 2
    s_branch KF_sp12
    s_endpgm
KF_hk0:
    buffer_load_dword v40, v9, s[16:19], s84 offen offset:16 sc1
    s_branch KF_hk0r
    s_endpgm
KF_hk1:
    s_mov_b32 s101, 1
    s_waitcnt vmcnt(12)
    v_cmp_ne_u32 vcc, v40, v7
    s_nop 0
    s_cbranch_vccz KF_hk1r
    s_mov_b32 s73, 0
KF_sp18:
    buffer_load_dword v40, v9, s[16:19], s84 offen offset:16 sc1
    s_waitcnt vmcnt(0)
    v_cmp_ne_u32 vcc, v40, v7
    s_add_u32 s73, s73, 1
    s_cmp_ge_u32 s73, 100000
    s_cbranch_scc1 KF_hk1r
    s_cbranch_vccz KF_hk1r
    s_sleep 2
    s_branch KF_sp18
    s_endpgm
KF_ck19:
    s_mov_b32 s73, 0
KF_sp21:
    buffer_load_dword v249, v248, s[16:19], s37 offen sc1
    s_waitcnt vmcnt(0)
    v_cmp_ne_u32 vcc, v249, v7
    s_add_u32 s73, s73, 1
    s_cmp_ge_u32 s73, 100000
    s_cbranch_scc1 KF_cr20
    s_cbranch_vccz KF_cr20
    s_sleep 2
    s_branch KF_sp21
    s_endpgm
KF_q1x:
    s_add_u32 s4, s4, 1
    s_cmp_ge_u32 s4, 100000
    s_cbranch_scc1 KF_q1d
    s_sleep 2
    s_add_u32 s86, s85, 86016
    buffer_load_dwordx4 v[64:67], v1, s[16:19], s86 offen sc1
    s_add_u32 s86, s85, 107520
    buffer_load_dwordx4 v[68:71], v1, s[16:19], s86 offen sc1
    s_add_u32 s86, s85, 129024
    buffer_load_dwordx4 v[72:75], v1, s[16:19], s86 offen sc1
    s_add_u32 s86, s85, 150528
    buffer_load_dwordx4 v[76:79], v1, s[16:19], s86 offen sc1
    s_add_u32 s86, s85, 0
    buffer_load_dwordx4 v[48:51], v1, s[16:19], s86 offen sc1
    s_add_u32 s86, s85, 21504
    buffer_load_dwordx4 v[52:55], v1, s[16:19], s86 offen sc1
    s_add_u32 s86, s85, 43008
    buffer_load_dwordx4 v[56:59], v1, s[16:19], s86 offen sc1
    s_add_u32 s86, s85, 64512
    buffer_load_dwordx4 v[60:63], v1, s[16:19], s86 offen sc1
    s_add_u32 s86, s78, 86016
    buffer_load_dwordx2 v[88:89], v46, s[28:31], s86 offen sc1
    s_add_u32 s86, s78, 107520
    buffer_load_dwordx2 v[90:91], v46, s[28:31], s86 offen sc1
    s_add_u32 s86, s78, 129024
    buffer_load_dwordx2 v[92:93], v46, s[28:31], s86 offen sc1
    s_add_u32 s86, s78, 150528
    buffer_load_dwordx2 v[94:95], v46, s[28:31], s86 offen sc1
    s_add_u32 s86, s78, 0
    buffer_load_dwordx2 v[80:81], v46, s[28:31], s86 offen sc1
    s_add_u32 s86, s78, 21504
    buffer_load_dwordx2 v[82:83], v46, s[28:31], s86 offen sc1
    s_add_u32 s86, s78, 43008
    buffer_load_dwordx2 v[84:85], v46, s[28:31], s86 offen sc1
    s_add_u32 s86, s78, 64512
    buffer_load_dwordx2 v[86:87], v46, s[28:31], s86 offen sc1
    s_waitcnt vmcnt(0)
    s_branch KF_q1
    s_endpgm
KF_q2x:
    s_add_u32 s4, s4, 1
    s_cmp_ge_u32 s4, 100000
    s_cbranch_scc1 KF_q2d
    s_sleep 2
    s_add_u32 s86, s85, 86016
    buffer_load_dwordx4 v[232:235], v1, s[16:19], s86 offen offset:2048 sc1
    s_add_u32 s86, s85, 107520
    buffer_load_dwordx4 v[236:239], v1, s[16:19], s86 offen offset:2048 sc1
    s_add_u32 s86, s85, 129024
    buffer_load_dwordx4 v[240:243], v1, s[16:19], s86 offen offset:2048 sc1
    s_add_u32 s86, s85, 150528
    buffer_load_dwordx4 v[244:247], v1, s[16:19], s86 offen offset:2048 sc1
    s_add_u32 s86, s85, 0
    buffer_load_dwordx4 v[216:219], v1, s[16:19], s86 offen offset:2048 sc1
    s_add_u32 s86, s85, 21504
    buffer_load_dwordx4 v[220:223], v1, s[16:19], s86 offen offset:2048 sc1
    s_add_u32 s86, s85, 43008
    buffer_load_dwordx4 v[224:227], v1, s[16:19], s86 offen offset:2048 sc1
    s_add_u32 s86, s85, 64512
    buffer_load_dwordx4 v[228:231], v1, s[16:19], s86 offen offset:2048 sc1
    s_waitcnt vmcnt(0)
    s_branch KF_q2
    s_endpgm
KF_codeend:
KF_slow:
    s_waitcnt vmcnt(0) lgkmcnt(0)
    s_nop 15
    v_accvgpr_write_b32 a0, 0
    v_accvgpr_write_b32 a1, 0
    v_accvgpr_write_b32 a2, 0
    v_accvgpr_write_b32 a3, 0
    v_accvgpr_write_b32 a4, 0
    v_accvgpr_write_b32 a5, 0
    v_accvgpr_write_b32 a6, 0
    v_accvgpr_write_b32 a7, 0
    v_accvgpr_write_b32 a8, 0
    v_accvgpr_write_b32 a9, 0
    v_accvgpr_write_b32 a10, 0
    v_accvgpr_write_b32 a11, 0
    v_accvgpr_write_b32 a12, 0
    v_accvgpr_write_b32 a13, 0
    v_accvgpr_write_b32 a14, 0
    v_accvgpr_write_b32 a15, 0
    v_accvgpr_write_b32 a16, 0
    v_accvgpr_write_b32 a17, 0
    v_accvgpr_write_b32 a18, 0
    v_accvgpr_write_b32 a19, 0
    v_accvgpr_write_b32 a20, 0
    v_accvgpr_write_b32 a21, 0
    v_accvgpr_write_b32 a22, 0
    v_accvgpr_write_b32 a23, 0
    v_accvgpr_write_b32 a24, 0
    v_accvgpr_write_b32 a25, 0
    v_accvgpr_write_b32 a26, 0
    v_accvgpr_write_b32 a27, 0
    v_accvgpr_write_b32 a28, 0
    v_accvgpr_write_b32 a29, 0
    v_accvgpr_write_b32 a30, 0
    v_accvgpr_write_b32 a31, 0
    v_accvgpr_write_b32 a32, 0
    v_accvgpr_write_b32 a33, 0
    v_accvgpr_write_b32 a34, 0
    v_accvgpr_write_b32 a35, 0
    v_accvgpr_write_b32 a36, 0
    v_accvgpr_write_b32 a37, 0
    v_accvgpr_write_b32 a38, 0
    v_accvgpr_write_b32 a39, 0
    v_accvgpr_write_b32 a40, 0
    v_accvgpr_write_b32 a41, 0
    v_accvgpr_write_b32 a42, 0
    v_accvgpr_write_b32 a43, 0
    v_accvgpr_write_b32 a44, 0
    v_accvgpr_write_b32 a45, 0
    v_accvgpr_write_b32 a46, 0
    v_accvgpr_write_b32 a47, 0
    v_accvgpr_write_b32 a48, 0
    v_accvgpr_write_b32 a49, 0
    v_accvgpr_write_b32 a50, 0
    v_accvgpr_write_b32 a51, 0
    v_accvgpr_write_b32 a52, 0
    v_accvgpr_write_b32 a53, 0
    v_accvgpr_write_b32 a54, 0
    v_accvgpr_write_b32 a55, 0
    v_accvgpr_write_b32 a56, 0
    v_accvgpr_write_b32 a57, 0
    v_accvgpr_write_b32 a58, 0
    v_accvgpr_write_b32 a59, 0
    v_accvgpr_write_b32 a60, 0
    v_accvgpr_write_b32 a61, 0
    v_accvgpr_write_b32 a62, 0
    v_accvgpr_write_b32 a63, 0
    v_accvgpr_write_b32 a64, 0
    v_accvgpr_write_b32 a65, 0
    v_accvgpr_write_b32 a66, 0
    v_accvgpr_write_b32 a67, 0
    v_accvgpr_write_b32 a68, 0
    v_accvgpr_write_b32 a69, 0
    v_accvgpr_write_b32 a70, 0
    v_accvgpr_write_b32 a71, 0
    v_accvgpr_write_b32 a72, 0
    v_accvgpr_write_b32 a73, 0
    v_accvgpr_write_b32 a74, 0
    v_accvgpr_write_b32 a75, 0
    v_accvgpr_write_b32 a76, 0
    v_accvgpr_write_b32 a77, 0
    v_accvgpr_write_b32 a78, 0
    v_accvgpr_write_b32 a79, 0
    v_accvgpr_write_b32 a80, 0
    v_accvgpr_write_b32 a81, 0
    v_accvgpr_write_b32 a82, 0
    v_accvgpr_write_b32 a83, 0
    v_accvgpr_write_b32 a84, 0
    v_accvgpr_write_b32 a85, 0
    v_accvgpr_write_b32 a86, 0
    v_accvgpr_write_b32 a87, 0
    v_accvgpr_write_b32 a88, 0
    v_accvgpr_write_b32 a89, 0
    v_accvgpr_write_b32 a90, 0
    v_accvgpr_write_b32 a91, 0
    v_accvgpr_write_b32 a92, 0
    v_accvgpr_write_b32 a93, 0
    v_accvgpr_write_b32 a94, 0
    v_accvgpr_write_b32 a95, 0
    v_accvgpr_write_b32 a96, 0
    v_accvgpr_write_b32 a97, 0
    v_accvgpr_write_b32 a98, 0
    v_accvgpr_write_b32 a99, 0
    v_accvgpr_write_b32 a100, 0
    v_accvgpr_write_b32 a101, 0
    v_accvgpr_write_b32 a102, 0
    v_accvgpr_write_b32 a103, 0
    v_accvgpr_write_b32 a104, 0
    v_accvgpr_write_b32 a105, 0
    v_accvgpr_write_b32 a106, 0
    v_accvgpr_write_b32 a107, 0
    v_accvgpr_write_b32 a108, 0
    v_accvgpr_write_b32 a109, 0
    v_accvgpr_write_b32 a110, 0
    v_accvgpr_write_b32 a111, 0
    v_accvgpr_write_b32 a112, 0
    v_accvgpr_write_b32 a113, 0
    v_accvgpr_write_b32 a114, 0
    v_accvgpr_write_b32 a115, 0
    v_accvgpr_write_b32 a116, 0
    v_accvgpr_write_b32 a117, 0
    v_accvgpr_write_b32 a118, 0
    v_accvgpr_write_b32 a119, 0
    v_accvgpr_write_b32 a120, 0
    v_accvgpr_write_b32 a121, 0
    v_accvgpr_write_b32 a122, 0
    v_accvgpr_write_b32 a123, 0
    v_accvgpr_write_b32 a124, 0
    v_accvgpr_write_b32 a125, 0
    v_accvgpr_write_b32 a126, 0
    v_accvgpr_write_b32 a127, 0
    v_mov_b32 v32, 0
    v_mov_b32 v224, 0xff7fffff
    v_mov_b32 v33, 0
    v_mov_b32 v225, 0xff7fffff
    v_mov_b32 v34, 0
    v_mov_b32 v226, 0xff7fffff
    v_mov_b32 v35, 0
    v_mov_b32 v227, 0xff7fffff
    s_mov_b32 s72, 0
    s_mov_b32 s68, s82
KF_sloop:
    buffer_load_dwordx4 a[160:163], v1, s[16:19], s68 offen offset:0 sc1
    buffer_load_dwordx4 a[164:167], v1, s[16:19], s68 offen offset:1024 sc1
    buffer_load_dwordx4 a[168:171], v1, s[16:19], s68 offen offset:2048 sc1
    buffer_load_dwordx4 a[172:175], v1, s[16:19], s68 offen offset:3072 sc1
    s_add_u32 s68, s68, 4096
    buffer_load_dwordx4 a[176:179], v1, s[16:19], s68 offen offset:0 sc1
    buffer_load_dwordx4 a[180:183], v1, s[16:19], s68 offen offset:1024 sc1
    buffer_load_dwordx4 a[184:187], v1, s[16:19], s68 offen offset:2048 sc1
    buffer_load_dwordx4 a[188:191], v1, s[16:19], s68 offen offset:3072 sc1
    s_add_u32 s68, s68, 4096
    buffer_load_dwordx4 a[224:227], v1, s[16:19], s68 offen offset:0 sc1
    buffer_load_dwordx4 a[228:231], v1, s[16:19], s68 offen offset:1024 sc1
    buffer_load_dwordx4 a[232:235], v1, s[16:19], s68 offen offset:2048 sc1
    buffer_load_dwordx4 a[236:239], v1, s[16:19], s68 offen offset:3072 sc1
    s_add_u32 s68, s68, 4096
    buffer_load_dwordx4 a[240:243], v1, s[16:19], s68 offen offset:0 sc1
    buffer_load_dwordx4 a[244:247], v1, s[16:19], s68 offen offset:1024 sc1
    buffer_load_dwordx4 a[248:251], v1, s[16:19], s68 offen offset:2048 sc1
    buffer_load_dwordx4 a[252:255], v1, s[16:19], s68 offen offset:3072 sc1
    s_add_u32 s68, s68, 4096
    s_waitcnt vmcnt(15)
    v_mfma_f32_16x16x32_bf16 v[64:67], a[160:163], v[48:51], 0
    s_waitcnt vmcnt(14)
    v_mfma_f32_16x16x32_bf16 v[64:67], a[164:167], v[80:83], v[64:67]
    s_waitcnt vmcnt(13)
    v_mfma_f32_16x16x32_bf16 v[64:67], a[168:171], v[112:115], v[64:67]
    s_waitcnt vmcnt(12)
    v_mfma_f32_16x16x32_bf16 v[64:67], a[172:175], v[144:147], v[64:67]
    s_waitcnt vmcnt(11)
    v_mfma_f32_16x16x32_bf16 v[68:71], a[176:179], v[48:51], 0
    s_waitcnt vmcnt(10)
    v_mfma_f32_16x16x32_bf16 v[68:71], a[180:183], v[80:83], v[68:71]
    s_waitcnt vmcnt(9)
    v_mfma_f32_16x16x32_bf16 v[68:71], a[184:187], v[112:115], v[68:71]
    s_waitcnt vmcnt(8)
    v_mfma_f32_16x16x32_bf16 v[68:71], a[188:191], v[144:147], v[68:71]
    v_max3_f32 v216, v64, v65, v66
    s_nop 6
    v_max3_f32 v216, v216, v67, v68
    v_max3_f32 v216, v216, v69, v70
    v_max3_f32 v216, v216, v71, v224
    v_mov_b32 v220, v216
    s_nop 1
    v_permlane32_swap_b32 v220, v216
    v_max_f32 v216, v216, v220
    v_mov_b32 v220, v216
    s_nop 1
    v_permlane16_swap_b32 v220, v216
    v_max_f32 v216, v216, v220
    v_sub_f32 v228, v224, v216
    v_exp_f32 v228, v228
    v_mov_b32 v224, v216
    v_mul_f32 v32, v32, v228
    v_sub_f32 v64, v64, v216
    v_exp_f32 v64, v64
    v_sub_f32 v65, v65, v216
    v_exp_f32 v65, v65
    v_sub_f32 v66, v66, v216
    v_exp_f32 v66, v66
    v_sub_f32 v67, v67, v216
    v_exp_f32 v67, v67
    v_sub_f32 v68, v68, v216
    v_exp_f32 v68, v68
    v_sub_f32 v69, v69, v216
    v_exp_f32 v69, v69
    v_sub_f32 v70, v70, v216
    v_exp_f32 v70, v70
    v_sub_f32 v71, v71, v216
    v_exp_f32 v71, v71
    v_add_f32 v32, v32, v64
    v_add_f32 v32, v32, v65
    v_add_f32 v32, v32, v66
    v_add_f32 v32, v32, v67
    v_add_f32 v32, v32, v68
    v_add_f32 v32, v32, v69
    v_add_f32 v32, v32, v70
    v_add_f32 v32, v32, v71
    v_cvt_pk_bf16_f32 v160, v64, v65
    v_cvt_pk_bf16_f32 v161, v66, v67
    v_cvt_pk_bf16_f32 v162, v68, v69
    v_cvt_pk_bf16_f32 v163, v70, v71
    v_accvgpr_read_b32 v232, a0
    v_accvgpr_read_b32 v233, a1
    v_accvgpr_read_b32 v234, a2
    v_accvgpr_read_b32 v235, a3
    v_mul_f32 v232, v232, v228
    v_mul_f32 v233, v233, v228
    v_mul_f32 v234, v234, v228
    v_mul_f32 v235, v235, v228
    v_accvgpr_write_b32 a0, v232
    v_accvgpr_write_b32 a1, v233
    v_accvgpr_write_b32 a2, v234
    v_accvgpr_write_b32 a3, v235
    v_accvgpr_read_b32 v232, a16
    v_accvgpr_read_b32 v233, a17
    v_accvgpr_read_b32 v234, a18
    v_accvgpr_read_b32 v235, a19
    v_mul_f32 v232, v232, v228
    v_mul_f32 v233, v233, v228
    v_mul_f32 v234, v234, v228
    v_mul_f32 v235, v235, v228
    v_accvgpr_write_b32 a16, v232
    v_accvgpr_write_b32 a17, v233
    v_accvgpr_write_b32 a18, v234
    v_accvgpr_write_b32 a19, v235
    v_accvgpr_read_b32 v232, a32
    v_accvgpr_read_b32 v233, a33
    v_accvgpr_read_b32 v234, a34
    v_accvgpr_read_b32 v235, a35
    v_mul_f32 v232, v232, v228
    v_mul_f32 v233, v233, v228
    v_mul_f32 v234, v234, v228
    v_mul_f32 v235, v235, v228
    v_accvgpr_write_b32 a32, v232
    v_accvgpr_write_b32 a33, v233
    v_accvgpr_write_b32 a34, v234
    v_accvgpr_write_b32 a35, v235
    v_accvgpr_read_b32 v232, a48
    v_accvgpr_read_b32 v233, a49
    v_accvgpr_read_b32 v234, a50
    v_accvgpr_read_b32 v235, a51
    v_mul_f32 v232, v232, v228
    v_mul_f32 v233, v233, v228
    v_mul_f32 v234, v234, v228
    v_mul_f32 v235, v235, v228
    v_accvgpr_write_b32 a48, v232
    v_accvgpr_write_b32 a49, v233
    v_accvgpr_write_b32 a50, v234
    v_accvgpr_write_b32 a51, v235
    v_accvgpr_read_b32 v232, a64
    v_accvgpr_read_b32 v233, a65
    v_accvgpr_read_b32 v234, a66
    v_accvgpr_read_b32 v235, a67
    v_mul_f32 v232, v232, v228
    v_mul_f32 v233, v233, v228
    v_mul_f32 v234, v234, v228
    v_mul_f32 v235, v235, v228
    v_accvgpr_write_b32 a64, v232
    v_accvgpr_write_b32 a65, v233
    v_accvgpr_write_b32 a66, v234
    v_accvgpr_write_b32 a67, v235
    v_accvgpr_read_b32 v232, a80
    v_accvgpr_read_b32 v233, a81
    v_accvgpr_read_b32 v234, a82
    v_accvgpr_read_b32 v235, a83
    v_mul_f32 v232, v232, v228
    v_mul_f32 v233, v233, v228
    v_mul_f32 v234, v234, v228
    v_mul_f32 v235, v235, v228
    v_accvgpr_write_b32 a80, v232
    v_accvgpr_write_b32 a81, v233
    v_accvgpr_write_b32 a82, v234
    v_accvgpr_write_b32 a83, v235
    v_accvgpr_read_b32 v232, a96
    v_accvgpr_read_b32 v233, a97
    v_accvgpr_read_b32 v234, a98
    v_accvgpr_read_b32 v235, a99
    v_mul_f32 v232, v232, v228
    v_mul_f32 v233, v233, v228
    v_mul_f32 v234, v234, v228
    v_mul_f32 v235, v235, v228
    v_accvgpr_write_b32 a96, v232
    v_accvgpr_write_b32 a97, v233
    v_accvgpr_write_b32 a98, v234
    v_accvgpr_write_b32 a99, v235
    v_accvgpr_read_b32 v232, a112
    v_accvgpr_read_b32 v233, a113
    v_accvgpr_read_b32 v234, a114
    v_accvgpr_read_b32 v235, a115
    v_mul_f32 v232, v232, v228
    v_mul_f32 v233, v233, v228
    v_mul_f32 v234, v234, v228
    v_mul_f32 v235, v235, v228
    v_accvgpr_write_b32 a112, v232
    v_accvgpr_write_b32 a113, v233
    v_accvgpr_write_b32 a114, v234
    v_accvgpr_write_b32 a115, v235
    s_waitcnt vmcnt(7)
    v_mfma_f32_16x16x32_bf16 a[0:3], a[224:227], v[160:163], a[0:3]
    s_waitcnt vmcnt(6)
    v_mfma_f32_16x16x32_bf16 a[16:19], a[228:231], v[160:163], a[16:19]
    s_waitcnt vmcnt(5)
    v_mfma_f32_16x16x32_bf16 a[32:35], a[232:235], v[160:163], a[32:35]
    s_waitcnt vmcnt(4)
    v_mfma_f32_16x16x32_bf16 a[48:51], a[236:239], v[160:163], a[48:51]
    s_waitcnt vmcnt(3)
    v_mfma_f32_16x16x32_bf16 a[64:67], a[240:243], v[160:163], a[64:67]
    s_waitcnt vmcnt(2)
    v_mfma_f32_16x16x32_bf16 a[80:83], a[244:247], v[160:163], a[80:83]
    s_waitcnt vmcnt(1)
    v_mfma_f32_16x16x32_bf16 a[96:99], a[248:251], v[160:163], a[96:99]
    s_waitcnt vmcnt(0)
    v_mfma_f32_16x16x32_bf16 a[112:115], a[252:255], v[160:163], a[112:115]
    v_mfma_f32_16x16x32_bf16 v[72:75], a[160:163], v[52:55], 0
    v_mfma_f32_16x16x32_bf16 v[72:75], a[164:167], v[84:87], v[72:75]
    v_mfma_f32_16x16x32_bf16 v[72:75], a[168:171], v[116:119], v[72:75]
    v_mfma_f32_16x16x32_bf16 v[72:75], a[172:175], v[148:151], v[72:75]
    v_mfma_f32_16x16x32_bf16 v[76:79], a[176:179], v[52:55], 0
    v_mfma_f32_16x16x32_bf16 v[76:79], a[180:183], v[84:87], v[76:79]
    v_mfma_f32_16x16x32_bf16 v[76:79], a[184:187], v[116:119], v[76:79]
    v_mfma_f32_16x16x32_bf16 v[76:79], a[188:191], v[148:151], v[76:79]
    s_nop 3
    v_max3_f32 v217, v72, v73, v74
    s_nop 2
    v_max3_f32 v217, v217, v75, v76
    v_max3_f32 v217, v217, v77, v78
    v_max3_f32 v217, v217, v79, v225
    v_mov_b32 v220, v217
    s_nop 1
    v_permlane32_swap_b32 v220, v217
    v_max_f32 v217, v217, v220
    v_mov_b32 v220, v217
    s_nop 1
    v_permlane16_swap_b32 v220, v217
    v_max_f32 v217, v217, v220
    v_sub_f32 v228, v225, v217
    v_exp_f32 v228, v228
    v_mov_b32 v225, v217
    v_mul_f32 v33, v33, v228
    v_sub_f32 v72, v72, v217
    v_exp_f32 v72, v72
    v_sub_f32 v73, v73, v217
    v_exp_f32 v73, v73
    v_sub_f32 v74, v74, v217
    v_exp_f32 v74, v74
    v_sub_f32 v75, v75, v217
    v_exp_f32 v75, v75
    v_sub_f32 v76, v76, v217
    v_exp_f32 v76, v76
    v_sub_f32 v77, v77, v217
    v_exp_f32 v77, v77
    v_sub_f32 v78, v78, v217
    v_exp_f32 v78, v78
    v_sub_f32 v79, v79, v217
    v_exp_f32 v79, v79
    v_add_f32 v33, v33, v72
    v_add_f32 v33, v33, v73
    v_add_f32 v33, v33, v74
    v_add_f32 v33, v33, v75
    v_add_f32 v33, v33, v76
    v_add_f32 v33, v33, v77
    v_add_f32 v33, v33, v78
    v_add_f32 v33, v33, v79
    v_cvt_pk_bf16_f32 v160, v72, v73
    v_cvt_pk_bf16_f32 v161, v74, v75
    v_cvt_pk_bf16_f32 v162, v76, v77
    v_cvt_pk_bf16_f32 v163, v78, v79
    v_accvgpr_read_b32 v232, a4
    v_accvgpr_read_b32 v233, a5
    v_accvgpr_read_b32 v234, a6
    v_accvgpr_read_b32 v235, a7
    v_mul_f32 v232, v232, v228
    v_mul_f32 v233, v233, v228
    v_mul_f32 v234, v234, v228
    v_mul_f32 v235, v235, v228
    v_accvgpr_write_b32 a4, v232
    v_accvgpr_write_b32 a5, v233
    v_accvgpr_write_b32 a6, v234
    v_accvgpr_write_b32 a7, v235
    v_accvgpr_read_b32 v232, a20
    v_accvgpr_read_b32 v233, a21
    v_accvgpr_read_b32 v234, a22
    v_accvgpr_read_b32 v235, a23
    v_mul_f32 v232, v232, v228
    v_mul_f32 v233, v233, v228
    v_mul_f32 v234, v234, v228
    v_mul_f32 v235, v235, v228
    v_accvgpr_write_b32 a20, v232
    v_accvgpr_write_b32 a21, v233
    v_accvgpr_write_b32 a22, v234
    v_accvgpr_write_b32 a23, v235
    v_accvgpr_read_b32 v232, a36
    v_accvgpr_read_b32 v233, a37
    v_accvgpr_read_b32 v234, a38
    v_accvgpr_read_b32 v235, a39
    v_mul_f32 v232, v232, v228
    v_mul_f32 v233, v233, v228
    v_mul_f32 v234, v234, v228
    v_mul_f32 v235, v235, v228
    v_accvgpr_write_b32 a36, v232
    v_accvgpr_write_b32 a37, v233
    v_accvgpr_write_b32 a38, v234
    v_accvgpr_write_b32 a39, v235
    v_accvgpr_read_b32 v232, a52
    v_accvgpr_read_b32 v233, a53
    v_accvgpr_read_b32 v234, a54
    v_accvgpr_read_b32 v235, a55
    v_mul_f32 v232, v232, v228
    v_mul_f32 v233, v233, v228
    v_mul_f32 v234, v234, v228
    v_mul_f32 v235, v235, v228
    v_accvgpr_write_b32 a52, v232
    v_accvgpr_write_b32 a53, v233
    v_accvgpr_write_b32 a54, v234
    v_accvgpr_write_b32 a55, v235
    v_accvgpr_read_b32 v232, a68
    v_accvgpr_read_b32 v233, a69
    v_accvgpr_read_b32 v234, a70
    v_accvgpr_read_b32 v235, a71
    v_mul_f32 v232, v232, v228
    v_mul_f32 v233, v233, v228
    v_mul_f32 v234, v234, v228
    v_mul_f32 v235, v235, v228
    v_accvgpr_write_b32 a68, v232
    v_accvgpr_write_b32 a69, v233
    v_accvgpr_write_b32 a70, v234
    v_accvgpr_write_b32 a71, v235
    v_accvgpr_read_b32 v232, a84
    v_accvgpr_read_b32 v233, a85
    v_accvgpr_read_b32 v234, a86
    v_accvgpr_read_b32 v235, a87
    v_mul_f32 v232, v232, v228
    v_mul_f32 v233, v233, v228
    v_mul_f32 v234, v234, v228
    v_mul_f32 v235, v235, v228
    v_accvgpr_write_b32 a84, v232
    v_accvgpr_write_b32 a85, v233
    v_accvgpr_write_b32 a86, v234
    v_accvgpr_write_b32 a87, v235
    v_accvgpr_read_b32 v232, a100
    v_accvgpr_read_b32 v233, a101
    v_accvgpr_read_b32 v234, a102
    v_accvgpr_read_b32 v235, a103
    v_mul_f32 v232, v232, v228
    v_mul_f32 v233, v233, v228
    v_mul_f32 v234, v234, v228
    v_mul_f32 v235, v235, v228
    v_accvgpr_write_b32 a100, v232
    v_accvgpr_write_b32 a101, v233
    v_accvgpr_write_b32 a102, v234
    v_accvgpr_write_b32 a103, v235
    v_accvgpr_read_b32 v232, a116
    v_accvgpr_read_b32 v233, a117
    v_accvgpr_read_b32 v234, a118
    v_accvgpr_read_b32 v235, a119
    v_mul_f32 v232, v232, v228
    v_mul_f32 v233, v233, v228
    v_mul_f32 v234, v234, v228
    v_mul_f32 v235, v235, v228
    v_accvgpr_write_b32 a116, v232
    v_accvgpr_write_b32 a117, v233
    v_accvgpr_write_b32 a118, v234
    v_accvgpr_write_b32 a119, v235
    v_mfma_f32_16x16x32_bf16 a[4:7], a[224:227], v[160:163], a[4:7]
    v_mfma_f32_16x16x32_bf16 a[20:23], a[228:231], v[160:163], a[20:23]
    v_mfma_f32_16x16x32_bf16 a[36:39], a[232:235], v[160:163], a[36:39]
    v_mfma_f32_16x16x32_bf16 a[52:55], a[236:239], v[160:163], a[52:55]
    v_mfma_f32_16x16x32_bf16 a[68:71], a[240:243], v[160:163], a[68:71]
    v_mfma_f32_16x16x32_bf16 a[84:87], a[244:247], v[160:163], a[84:87]
    v_mfma_f32_16x16x32_bf16 a[100:103], a[248:251], v[160:163], a[100:103]
    v_mfma_f32_16x16x32_bf16 a[116:119], a[252:255], v[160:163], a[116:119]
    v_mfma_f32_16x16x32_bf16 v[96:99], a[160:163], v[56:59], 0
    v_mfma_f32_16x16x32_bf16 v[96:99], a[164:167], v[88:91], v[96:99]
    v_mfma_f32_16x16x32_bf16 v[96:99], a[168:171], v[120:123], v[96:99]
    v_mfma_f32_16x16x32_bf16 v[96:99], a[172:175], v[152:155], v[96:99]
    v_mfma_f32_16x16x32_bf16 v[100:103], a[176:179], v[56:59], 0
    v_mfma_f32_16x16x32_bf16 v[100:103], a[180:183], v[88:91], v[100:103]
    v_mfma_f32_16x16x32_bf16 v[100:103], a[184:187], v[120:123], v[100:103]
    v_mfma_f32_16x16x32_bf16 v[100:103], a[188:191], v[152:155], v[100:103]
    s_nop 3
    v_max3_f32 v218, v96, v97, v98
    s_nop 2
    v_max3_f32 v218, v218, v99, v100
    v_max3_f32 v218, v218, v101, v102
    v_max3_f32 v218, v218, v103, v226
    v_mov_b32 v220, v218
    s_nop 1
    v_permlane32_swap_b32 v220, v218
    v_max_f32 v218, v218, v220
    v_mov_b32 v220, v218
    s_nop 1
    v_permlane16_swap_b32 v220, v218
    v_max_f32 v218, v218, v220
    v_sub_f32 v228, v226, v218
    v_exp_f32 v228, v228
    v_mov_b32 v226, v218
    v_mul_f32 v34, v34, v228
    v_sub_f32 v96, v96, v218
    v_exp_f32 v96, v96
    v_sub_f32 v97, v97, v218
    v_exp_f32 v97, v97
    v_sub_f32 v98, v98, v218
    v_exp_f32 v98, v98
    v_sub_f32 v99, v99, v218
    v_exp_f32 v99, v99
    v_sub_f32 v100, v100, v218
    v_exp_f32 v100, v100
    v_sub_f32 v101, v101, v218
    v_exp_f32 v101, v101
    v_sub_f32 v102, v102, v218
    v_exp_f32 v102, v102
    v_sub_f32 v103, v103, v218
    v_exp_f32 v103, v103
    v_add_f32 v34, v34, v96
    v_add_f32 v34, v34, v97
    v_add_f32 v34, v34, v98
    v_add_f32 v34, v34, v99
    v_add_f32 v34, v34, v100
    v_add_f32 v34, v34, v101
    v_add_f32 v34, v34, v102
    v_add_f32 v34, v34, v103
    v_cvt_pk_bf16_f32 v160, v96, v97
    v_cvt_pk_bf16_f32 v161, v98, v99
    v_cvt_pk_bf16_f32 v162, v100, v101
    v_cvt_pk_bf16_f32 v163, v102, v103
    v_accvgpr_read_b32 v232, a8
    v_accvgpr_read_b32 v233, a9
    v_accvgpr_read_b32 v234, a10
    v_accvgpr_read_b32 v235, a11
    v_mul_f32 v232, v232, v228
    v_mul_f32 v233, v233, v228
    v_mul_f32 v234, v234, v228
    v_mul_f32 v235, v235, v228
    v_accvgpr_write_b32 a8, v232
    v_accvgpr_write_b32 a9, v233
    v_accvgpr_write_b32 a10, v234
    v_accvgpr_write_b32 a11, v235
    v_accvgpr_read_b32 v232, a24
    v_accvgpr_read_b32 v233, a25
    v_accvgpr_read_b32 v234, a26
    v_accvgpr_read_b32 v235, a27
    v_mul_f32 v232, v232, v228
    v_mul_f32 v233, v233, v228
    v_mul_f32 v234, v234, v228
    v_mul_f32 v235, v235, v228
    v_accvgpr_write_b32 a24, v232
    v_accvgpr_write_b32 a25, v233
    v_accvgpr_write_b32 a26, v234
    v_accvgpr_write_b32 a27, v235
    v_accvgpr_read_b32 v232, a40
    v_accvgpr_read_b32 v233, a41
    v_accvgpr_read_b32 v234, a42
    v_accvgpr_read_b32 v235, a43
    v_mul_f32 v232, v232, v228
    v_mul_f32 v233, v233, v228
    v_mul_f32 v234, v234, v228
    v_mul_f32 v235, v235, v228
    v_accvgpr_write_b32 a40, v232
    v_accvgpr_write_b32 a41, v233
    v_accvgpr_write_b32 a42, v234
    v_accvgpr_write_b32 a43, v235
    v_accvgpr_read_b32 v232, a56
    v_accvgpr_read_b32 v233, a57
    v_accvgpr_read_b32 v234, a58
    v_accvgpr_read_b32 v235, a59
    v_mul_f32 v232, v232, v228
    v_mul_f32 v233, v233, v228
    v_mul_f32 v234, v234, v228
    v_mul_f32 v235, v235, v228
    v_accvgpr_write_b32 a56, v232
    v_accvgpr_write_b32 a57, v233
    v_accvgpr_write_b32 a58, v234
    v_accvgpr_write_b32 a59, v235
    v_accvgpr_read_b32 v232, a72
    v_accvgpr_read_b32 v233, a73
    v_accvgpr_read_b32 v234, a74
    v_accvgpr_read_b32 v235, a75
    v_mul_f32 v232, v232, v228
    v_mul_f32 v233, v233, v228
    v_mul_f32 v234, v234, v228
    v_mul_f32 v235, v235, v228
    v_accvgpr_write_b32 a72, v232
    v_accvgpr_write_b32 a73, v233
    v_accvgpr_write_b32 a74, v234
    v_accvgpr_write_b32 a75, v235
    v_accvgpr_read_b32 v232, a88
    v_accvgpr_read_b32 v233, a89
    v_accvgpr_read_b32 v234, a90
    v_accvgpr_read_b32 v235, a91
    v_mul_f32 v232, v232, v228
    v_mul_f32 v233, v233, v228
    v_mul_f32 v234, v234, v228
    v_mul_f32 v235, v235, v228
    v_accvgpr_write_b32 a88, v232
    v_accvgpr_write_b32 a89, v233
    v_accvgpr_write_b32 a90, v234
    v_accvgpr_write_b32 a91, v235
    v_accvgpr_read_b32 v232, a104
    v_accvgpr_read_b32 v233, a105
    v_accvgpr_read_b32 v234, a106
    v_accvgpr_read_b32 v235, a107
    v_mul_f32 v232, v232, v228
    v_mul_f32 v233, v233, v228
    v_mul_f32 v234, v234, v228
    v_mul_f32 v235, v235, v228
    v_accvgpr_write_b32 a104, v232
    v_accvgpr_write_b32 a105, v233
    v_accvgpr_write_b32 a106, v234
    v_accvgpr_write_b32 a107, v235
    v_accvgpr_read_b32 v232, a120
    v_accvgpr_read_b32 v233, a121
    v_accvgpr_read_b32 v234, a122
    v_accvgpr_read_b32 v235, a123
    v_mul_f32 v232, v232, v228
    v_mul_f32 v233, v233, v228
    v_mul_f32 v234, v234, v228
    v_mul_f32 v235, v235, v228
    v_accvgpr_write_b32 a120, v232
    v_accvgpr_write_b32 a121, v233
    v_accvgpr_write_b32 a122, v234
    v_accvgpr_write_b32 a123, v235
    v_mfma_f32_16x16x32_bf16 a[8:11], a[224:227], v[160:163], a[8:11]
    v_mfma_f32_16x16x32_bf16 a[24:27], a[228:231], v[160:163], a[24:27]
    v_mfma_f32_16x16x32_bf16 a[40:43], a[232:235], v[160:163], a[40:43]
    v_mfma_f32_16x16x32_bf16 a[56:59], a[236:239], v[160:163], a[56:59]
    v_mfma_f32_16x16x32_bf16 a[72:75], a[240:243], v[160:163], a[72:75]
    v_mfma_f32_16x16x32_bf16 a[88:91], a[244:247], v[160:163], a[88:91]
    v_mfma_f32_16x16x32_bf16 a[104:107], a[248:251], v[160:163], a[104:107]
    v_mfma_f32_16x16x32_bf16 a[120:123], a[252:255], v[160:163], a[120:123]
    v_mfma_f32_16x16x32_bf16 v[104:107], a[160:163], v[60:63], 0
    v_mfma_f32_16x16x32_bf16 v[104:107], a[164:167], v[92:95], v[104:107]
    v_mfma_f32_16x16x32_bf16 v[104:107], a[168:171], v[124:127], v[104:107]
    v_mfma_f32_16x16x32_bf16 v[104:107], a[172:175], v[156:159], v[104:107]
    v_mfma_f32_16x16x32_bf16 v[108:111], a[176:179], v[60:63], 0
    v_mfma_f32_16x16x32_bf16 v[108:111], a[180:183], v[92:95], v[108:111]
    v_mfma_f32_16x16x32_bf16 v[108:111], a[184:187], v[124:127], v[108:111]
    v_mfma_f32_16x16x32_bf16 v[108:111], a[188:191], v[156:159], v[108:111]
    s_nop 3
    v_max3_f32 v219, v104, v105, v106
    s_nop 2
    v_max3_f32 v219, v219, v107, v108
    v_max3_f32 v219, v219, v109, v110
    v_max3_f32 v219, v219, v111, v227
    v_mov_b32 v220, v219
    s_nop 1
    v_permlane32_swap_b32 v220, v219
    v_max_f32 v219, v219, v220
    v_mov_b32 v220, v219
    s_nop 1
    v_permlane16_swap_b32 v220, v219
    v_max_f32 v219, v219, v220
    v_sub_f32 v228, v227, v219
    v_exp_f32 v228, v228
    v_mov_b32 v227, v219
    v_mul_f32 v35, v35, v228
    v_sub_f32 v104, v104, v219
    v_exp_f32 v104, v104
    v_sub_f32 v105, v105, v219
    v_exp_f32 v105, v105
    v_sub_f32 v106, v106, v219
    v_exp_f32 v106, v106
    v_sub_f32 v107, v107, v219
    v_exp_f32 v107, v107
    v_sub_f32 v108, v108, v219
    v_exp_f32 v108, v108
    v_sub_f32 v109, v109, v219
    v_exp_f32 v109, v109
    v_sub_f32 v110, v110, v219
    v_exp_f32 v110, v110
    v_sub_f32 v111, v111, v219
    v_exp_f32 v111, v111
    v_add_f32 v35, v35, v104
    v_add_f32 v35, v35, v105
    v_add_f32 v35, v35, v106
    v_add_f32 v35, v35, v107
    v_add_f32 v35, v35, v108
    v_add_f32 v35, v35, v109
    v_add_f32 v35, v35, v110
    v_add_f32 v35, v35, v111
    v_cvt_pk_bf16_f32 v160, v104, v105
    v_cvt_pk_bf16_f32 v161, v106, v107
    v_cvt_pk_bf16_f32 v162, v108, v109
    v_cvt_pk_bf16_f32 v163, v110, v111
    v_accvgpr_read_b32 v232, a12
    v_accvgpr_read_b32 v233, a13
    v_accvgpr_read_b32 v234, a14
    v_accvgpr_read_b32 v235, a15
    v_mul_f32 v232, v232, v228
    v_mul_f32 v233, v233, v228
    v_mul_f32 v234, v234, v228
    v_mul_f32 v235, v235, v228
    v_accvgpr_write_b32 a12, v232
    v_accvgpr_write_b32 a13, v233
    v_accvgpr_write_b32 a14, v234
    v_accvgpr_write_b32 a15, v235
    v_accvgpr_read_b32 v232, a28
    v_accvgpr_read_b32 v233, a29
    v_accvgpr_read_b32 v234, a30
    v_accvgpr_read_b32 v235, a31
    v_mul_f32 v232, v232, v228
    v_mul_f32 v233, v233, v228
    v_mul_f32 v234, v234, v228
    v_mul_f32 v235, v235, v228
    v_accvgpr_write_b32 a28, v232
    v_accvgpr_write_b32 a29, v233
    v_accvgpr_write_b32 a30, v234
    v_accvgpr_write_b32 a31, v235
    v_accvgpr_read_b32 v232, a44
    v_accvgpr_read_b32 v233, a45
    v_accvgpr_read_b32 v234, a46
    v_accvgpr_read_b32 v235, a47
    v_mul_f32 v232, v232, v228
    v_mul_f32 v233, v233, v228
    v_mul_f32 v234, v234, v228
    v_mul_f32 v235, v235, v228
    v_accvgpr_write_b32 a44, v232
    v_accvgpr_write_b32 a45, v233
    v_accvgpr_write_b32 a46, v234
    v_accvgpr_write_b32 a47, v235
    v_accvgpr_read_b32 v232, a60
    v_accvgpr_read_b32 v233, a61
    v_accvgpr_read_b32 v234, a62
    v_accvgpr_read_b32 v235, a63
    v_mul_f32 v232, v232, v228
    v_mul_f32 v233, v233, v228
    v_mul_f32 v234, v234, v228
    v_mul_f32 v235, v235, v228
    v_accvgpr_write_b32 a60, v232
    v_accvgpr_write_b32 a61, v233
    v_accvgpr_write_b32 a62, v234
    v_accvgpr_write_b32 a63, v235
    v_accvgpr_read_b32 v232, a76
    v_accvgpr_read_b32 v233, a77
    v_accvgpr_read_b32 v234, a78
    v_accvgpr_read_b32 v235, a79
    v_mul_f32 v232, v232, v228
    v_mul_f32 v233, v233, v228
    v_mul_f32 v234, v234, v228
    v_mul_f32 v235, v235, v228
    v_accvgpr_write_b32 a76, v232
    v_accvgpr_write_b32 a77, v233
    v_accvgpr_write_b32 a78, v234
    v_accvgpr_write_b32 a79, v235
    v_accvgpr_read_b32 v232, a92
    v_accvgpr_read_b32 v233, a93
    v_accvgpr_read_b32 v234, a94
    v_accvgpr_read_b32 v235, a95
    v_mul_f32 v232, v232, v228
    v_mul_f32 v233, v233, v228
    v_mul_f32 v234, v234, v228
    v_mul_f32 v235, v235, v228
    v_accvgpr_write_b32 a92, v232
    v_accvgpr_write_b32 a93, v233
    v_accvgpr_write_b32 a94, v234
    v_accvgpr_write_b32 a95, v235
    v_accvgpr_read_b32 v232, a108
    v_accvgpr_read_b32 v233, a109
    v_accvgpr_read_b32 v234, a110
    v_accvgpr_read_b32 v235, a111
    v_mul_f32 v232, v232, v228
    v_mul_f32 v233, v233, v228
    v_mul_f32 v234, v234, v228
    v_mul_f32 v235, v235, v228
    v_accvgpr_write_b32 a108, v232
    v_accvgpr_write_b32 a109, v233
    v_accvgpr_write_b32 a110, v234
    v_accvgpr_write_b32 a111, v235
    v_accvgpr_read_b32 v232, a124
    v_accvgpr_read_b32 v233, a125
    v_accvgpr_read_b32 v234, a126
    v_accvgpr_read_b32 v235, a127
    v_mul_f32 v232, v232, v228
    v_mul_f32 v233, v233, v228
    v_mul_f32 v234, v234, v228
    v_mul_f32 v235, v235, v228
    v_accvgpr_write_b32 a124, v232
    v_accvgpr_write_b32 a125, v233
    v_accvgpr_write_b32 a126, v234
    v_accvgpr_write_b32 a127, v235
    v_mfma_f32_16x16x32_bf16 a[12:15], a[224:227], v[160:163], a[12:15]
    v_mfma_f32_16x16x32_bf16 a[28:31], a[228:231], v[160:163], a[28:31]
    v_mfma_f32_16x16x32_bf16 a[44:47], a[232:235], v[160:163], a[44:47]
    v_mfma_f32_16x16x32_bf16 a[60:63], a[236:239], v[160:163], a[60:63]
    v_mfma_f32_16x16x32_bf16 a[76:79], a[240:243], v[160:163], a[76:79]
    v_mfma_f32_16x16x32_bf16 a[92:95], a[244:247], v[160:163], a[92:95]
    v_mfma_f32_16x16x32_bf16 a[108:111], a[248:251], v[160:163], a[108:111]
    v_mfma_f32_16x16x32_bf16 a[124:127], a[252:255], v[160:163], a[124:127]
    s_add_u32 s72, s72, 1
    s_cmp_lt_u32 s72, 16
    s_cbranch_scc1 KF_sloop
    s_nop 15
    v_mov_b32 v220, v32
    s_nop 1
    v_permlane32_swap_b32 v220, v32
    v_add_f32 v32, v32, v220
    v_mov_b32 v220, v32
    s_nop 1
    v_permlane16_swap_b32 v220, v32
    v_add_f32 v32, v32, v220
    v_mov_b32 v220, v33
    s_nop 1
    v_permlane32_swap_b32 v220, v33
    v_add_f32 v33, v33, v220
    v_mov_b32 v220, v33
    s_nop 1
    v_permlane16_swap_b32 v220, v33
    v_add_f32 v33, v33, v220
    v_mov_b32 v220, v34
    s_nop 1
    v_permlane32_swap_b32 v220, v34
    v_add_f32 v34, v34, v220
    v_mov_b32 v220, v34
    s_nop 1
    v_permlane16_swap_b32 v220, v34
    v_add_f32 v34, v34, v220
    v_mov_b32 v220, v35
    s_nop 1
    v_permlane32_swap_b32 v220, v35
    v_add_f32 v35, v35, v220
    v_mov_b32 v220, v35
    s_nop 1
    v_permlane16_swap_b32 v220, v35
    v_add_f32 v35, v35, v220
    s_nop 15
    s_branch KF_epi
.section .rodata,"a"
.p2align 6
.amdhsa_kernel recurrent_scan__sliding_block_cached__dense_activation_relu__prompt_kernel
  .amdhsa_next_free_vgpr 512
  .amdhsa_next_free_sgpr 102
  .amdhsa_accum_offset 256
  .amdhsa_group_segment_fixed_size 0
  .amdhsa_kernarg_size 88
  .amdhsa_user_sgpr_count 2
  .amdhsa_user_sgpr_kernarg_segment_ptr 1
  .amdhsa_system_sgpr_workgroup_id_x 1
  .amdhsa_float_denorm_mode_32 3
.end_amdhsa_kernel
```
